```python
import torch

def _softmax(x, axis=-1):
    return torch.softmax(x, dim=axis)
def _gelu(x):
    return torch.nn.functional.gelu(x, approximate="tanh")
def _silu(x):
    return torch.nn.functional.silu(x)
def _sigmoid(x):
    return torch.sigmoid(x)
def _layernorm(x, axis=-1, eps=1e-5):
    m = x.mean(dim=axis, keepdim=True)
    v = x.var(dim=axis, keepdim=True, unbiased=False)
    return (x - m) / torch.sqrt(v + eps)
def _scatter_add(tgt, idx, src, axis=0):
    return tgt.clone().index_add_(axis, idx, src)
def _segment_sum(src, seg, n):
    out = torch.zeros((n,) + src.shape[1:], dtype=src.dtype)
    return out.index_add_(0, seg, src)
def _pad(x, pw):
    flat = tuple(v for pair in reversed(pw) for v in pair)
    return torch.nn.functional.pad(x, flat)

kernel_name = 'gated_mix__grouped_kv_mqa__dense_activation_relu__prompt'

def setup_inputs():

    _w = (lambda a: (lambda t: t.to(torch.bfloat16) if t.is_floating_point() else t)(torch.as_tensor(a)))
    def _A_setup():
        B, S, D, H = 1, 2048, 640, 32
        Dh = D // H
        return {
            "x": _w((lambda *s: torch.randn(*s, dtype=torch.bfloat16) * 0.05)(B, S, D)),
            "wq": _w((lambda *s: torch.randn(*s, dtype=torch.bfloat16) * 0.8)(D, H * Dh)),
            "wk": _w((lambda *s: torch.randn(*s, dtype=torch.bfloat16) * 0.8)(D, Dh)),
            "wv": _w((lambda *s: torch.randn(*s, dtype=torch.bfloat16) * 0.2)(D, Dh)),
            "wo": _w((lambda *s: torch.randn(*s, dtype=torch.bfloat16) * 0.2)(H * Dh, D)),
        }
    _A_in = _A_setup()

    def _B_setup():
        B, S, D, Dff = 1, 2048, 640, 1536
        return {
            "x": _w((lambda *s: torch.randn(*s, dtype=torch.bfloat16) * 0.05)(B, S, D)),
            "w1": _w((lambda *s: torch.randn(*s, dtype=torch.bfloat16) * 0.05)(D, Dff)),
            "w2": _w((lambda *s: torch.randn(*s, dtype=torch.bfloat16) * 0.05)(Dff, D)),
        }
    _B_in = _B_setup()

    return {
        "A_x": _A_in["x"],
        "A_wq": _A_in["wq"],
        "A_wk": _A_in["wk"],
        "A_wv": _A_in["wv"],
        "A_wo": _A_in["wo"],
        "B_x": _B_in["x"],
        "B_w1": _B_in["w1"],
        "B_w2": _B_in["w2"],
        "gate_w": _w((lambda *s: torch.randn(*s, dtype=torch.bfloat16) * 0.05)(640) * 16.0),
    }

def reference(A_x, A_wq, A_wk, A_wv, A_wo, B_x, B_w1, B_w2, gate_w):
    def _A_ref(x, wq, wk, wv, wo):
        B, S, D = x.shape
        H = 32
        Dh = D // H
        q = (lambda x, *d: x.permute(*d))((x @ wq).reshape(B, S, H, Dh), 0, 2, 1, 3)
        k = x @ wk
        v = x @ wv
        scores = torch.einsum("bhqd,bkd->bhqk", q, k) * (Dh ** -0.5)
        p = _softmax(scores, axis=-1)
        o = torch.einsum("bhqk,bkd->bhqd", p, v)
        return (lambda x, *d: x.permute(*d))(o, 0, 2, 1, 3).reshape(B, S, H * Dh) @ wo

    def _B_ref(x, w1, w2):
        h = torch.einsum("bsd,df->bsf", x, w1)
        zero = torch.zeros_like(h)
        h = torch.maximum(h, zero)
        return torch.einsum("bsf,fd->bsd", h, w2)

    x = A_x
    g = _sigmoid((x * gate_w).sum(-1, keepdims=True))
    a = _A_ref(x, A_wq, A_wk, A_wv, A_wo)
    b = _B_ref(x, B_w1, B_w2)
    return g * a + (1 - g) * b
```

```asm
; @launch grid=(256,1,1) block=(256,1,1) lds=150528
.amdgcn_target "amdgcn-amd-amdhsa--gfx950"
.text
.globl gated_mix__grouped_kv_mqa__dense_activation_relu__prompt_kernel
.p2align 8
.type gated_mix__grouped_kv_mqa__dense_activation_relu__prompt_kernel,@function
gated_mix__grouped_kv_mqa__dense_activation_relu__prompt_kernel:
    s_cmp_ge_u32 s2, 0x100
    s_cbranch_scc1 L_end
    s_load_dwordx8 s[44:51], s[0:1], 0
    s_load_dwordx8 s[60:67], s[0:1], 64
    s_load_dwordx8 s[52:59], s[0:1], 32
    v_lshrrev_b32 v30, 6, v0
    v_and_b32 v1, 63, v0
    v_readfirstlane_b32 s70, v30
    s_and_b32 s68, s2, 31
    s_lshr_b32 s69, s2, 5
    s_lshr_b32 s96, s68, 3
    s_mov_b32 s97, s69
    s_and_b32 s98, s68, 7
    s_and_b32 s96, s96, 1
    s_mul_i32 s96, s96, 2
    s_add_u32 s96, s96, s97
    s_add_u32 s96, s96, s98
    s_mul_i32 s97, s96, 205
    s_lshr_b32 s97, s97, 10
    s_mul_i32 s97, s97, 5
    s_sub_u32 s74, s96, s97
    s_lshl_b32 s74, s74, 1
    s_and_b32 s71, s70, 1
    s_lshr_b32 s72, s70, 1
    v_lshlrev_b32 v6, 4, v1
    s_lshl_b32 s96, s70, 2
    v_lshrrev_b32 v30, 4, v1
    v_add_u32 v30, s96, v30
    v_xor_b32 v30, v30, v1
    v_and_b32 v30, 7, v30
    s_mul_i32 s96, s68, 81920
    s_mul_i32 s99, s70, 10240
    s_add_u32 s96, s96, s99
    v_lshl_add_u32 v30, v30, 4, s96
    v_lshrrev_b32 v31, 3, v1
    s_movk_i32 s97, 1280
    v_mad_u32_u24 v2, v31, s97, v30
    v_add_u32 v7, 39936, v2
    s_mul_i32 s75, s70, 6144
    s_mov_b32 s6, 2621440
    s_mov_b32 s7, 0x20000
    s_add_u32 m0, s75, 0
    s_mul_i32 s81, s74, 128
    s_waitcnt lgkmcnt(0)
    s_add_u32 s4, s44, s81
    s_addc_u32 s5, s45, 0
    buffer_load_dwordx4 v2, s[4:7], 0 offen nt lds
    buffer_load_dwordx4 v7, s[4:7], 0 offen offset:1024 nt lds
    s_add_u32 m0, s75, 1920
    s_nop 0
    buffer_load_dwordx4 v2, s[4:7], 0 offen offset:128 nt lds
    buffer_load_dwordx4 v7, s[4:7], 0 offen offset:1152 nt lds
    s_mul_i32 s96, s70, 1280
    v_cmp_gt_u32 vcc, 16, v1
    v_add_u32 v8, s96, v6
    v_mov_b32 v30, 0x80000000
    s_mov_b32 s34, 1280
    v_cndmask_b32 v9, v30, v8, vcc
    s_mov_b32 s35, 0x20000
    s_bitcmp0_b32 s69, 0
    s_cselect_b32 s14, 25600, 0
    s_mov_b32 s15, 0x20000
    s_mul_i32 s98, s70, 320
    s_lshl_b32 s97, s74, 7
    s_add_u32 s79, s97, 122880
    s_bitcmp1_b32 s69, 1
    s_cselect_b64 s[48:49], s[50:51], s[48:49]
    s_mov_b64 s[32:33], s[60:61]
    s_add_u32 m0, s75, 4096
    s_mul_i32 s81, s74, 2560
    s_add_u32 s12, s48, s81
    s_addc_u32 s13, s49, 0
    buffer_load_dwordx4 v8, s[12:15], 0 offen lds
    buffer_load_dwordx4 v9, s[12:15], 0 offen offset:1024 lds
    s_add_u32 s74, s74, 2
    s_cmp_eq_u32 s74, 10
    s_cselect_b32 s74, 0, s74
    s_add_u32 m0, s98, 122880
    s_mov_b64 exec, 0xfffff
    buffer_load_dwordx4 v6, s[32:35], s98 offen lds
    s_add_u32 m0, s98, 124160
    s_nop 0
    buffer_load_dwordx4 v6, s[32:35], s98 offen lds
    s_mov_b64 exec, -1
    s_getpc_b64 s[96:97]
    s_mov_b32 s98, L_code_end-.-4
    s_lshr_b32 s99, s2, 3
    s_lshl_b32 s99, s99, 11
    v_lshl_add_u32 v30, v0, 7, s99
    v_min_u32 v30, s98, v30
    v_mov_b32 v211, s97
    v_add_co_u32 v212, vcc, s96, v30
    s_nop 1
    v_addc_co_u32 v213, vcc, 0, v211, vcc
    v_cmp_gt_u32 vcc, 16, v0
    s_and_saveexec_b64 s[96:97], vcc
    s_cbranch_execz L_nopf
    global_load_dword v208, v[212:213], off
L_nopf:
    s_mov_b64 exec, -1
    s_mov_b64 s[8:9], s[46:47]
    s_mov_b32 s10, 819200
    s_mov_b32 s11, 0x20000
    s_mov_b64 s[16:17], s[56:57]
    s_mul_i32 s96, s2, 4
    s_add_u32 s96, s96, s70
    s_mul_i32 s97, s96, 896
    s_mul_i32 s96, s96, 1920
    v_lshl_add_u32 v30, v1, 7, s97
    v_lshl_add_u32 v210, v1, 7, s96
    v_cmp_gt_u32 vcc, 15, v1
    v_mov_b32 v31, 0x80000000
    s_mov_b64 exec, 0x7f
    buffer_load_dword v209, v30, s[8:11], 0 offen
    s_mov_b64 exec, -1
    v_cndmask_b32 v210, v31, v210, vcc
    s_mov_b32 s20, s66
    s_mov_b32 s21, s67
    s_mov_b32 s22, 268435456
    s_mov_b32 s23, 0x20000
    s_lshr_b32 s96, s69, 2
    s_add_u32 s96, s96, 2
    s_bfe_u32 s97, s69, 0x10001
    s_add_u32 s97, s97, 1
    s_cmp_eq_u32 s96, s70
    s_cselect_b32 s73, s97, 3
    s_bitcmp1_b32 s69, 0
    s_cselect_b32 s73, 3, s73
    s_cmp_eq_u32 s72, 0
    s_cselect_b32 s73, 0, s73
    v_and_b32 v30, 31, v1
    s_mul_i32 s96, s71, 128
    s_add_u32 s96, s96, 125440
    v_lshl_add_u32 v242, v30, 2, s96
    v_lshrrev_b32 v30, 3, v30
    v_mul_u32_u24 v30, 6144, v30
    v_and_b32 v31, 7, v1
    v_lshl_add_u32 v30, v31, 7, v30
    v_bfe_u32 v31, v1, 1, 3
    v_lshrrev_b32 v28, 5, v1
    v_xor_b32 v31, v31, v28
    v_lshl_add_u32 v30, v31, 4, v30
    s_mul_i32 s96, s71, 1024
    v_add_u32 v10, s96, v30
    v_xor_b32 v11, 32, v10
    v_xor_b32 v12, 64, v10
    v_xor_b32 v13, 96, v10
    v_add_u32 v14, 57344, v10
    v_add_u32 v15, 57344, v11
    v_add_u32 v16, 57344, v12
    v_add_u32 v17, 57344, v13
    v_bfe_u32 v30, v1, 2, 2
    v_lshl_add_u32 v30, v28, 3, v30
    v_bfe_u32 v31, v1, 4, 1
    v_and_b32 v29, 3, v1
    v_lshl_add_u32 v31, v31, 2, v29
    v_min_u32 v29, 4, v31
    v_lshlrev_b32 v29, 3, v29
    v_mul_u32_u24 v18, 160, v30
    s_mul_i32 s96, s72, 80
    v_add3_u32 v18, v18, v29, s96
    v_mad_u32_u24 v20, v30, 40, v29
    v_cmp_lt_u32 vcc, 4, v31
    v_mov_b32 v244, 0x40000
    s_nop 0
    v_cndmask_b32 v18, v18, v244, vcc
    v_cndmask_b32 v20, v20, v244, vcc
    v_add_u32 v19, 57344, v18
    v_add_u32 v21, 57344, v20
    v_mul_u32_u24 v29, 384, v30
    v_lshl_add_u32 v29, v31, 3, v29
    v_lshl_add_u32 v28, v28, 4, s79
    v_and_b32 v30, 27, v1
    v_cmp_ne_u32 vcc, 0, v30
    s_nop 1
    v_cndmask_b32 v28, v28, v244, vcc
    v_mov_b32 v30, 125696
    v_mov_b32 v31, 0
    ds_write_b32 v30, v31
    s_mov_b32 s18, 1966080
    s_mov_b32 s19, 0x20000
    s_add_u32 m0, s75, 24576
    s_mul_i32 s81, s74, 128
    s_add_u32 s4, s44, s81
    s_addc_u32 s5, s45, 0
    buffer_load_dwordx4 v2, s[4:7], 0 offen nt lds
    buffer_load_dwordx4 v7, s[4:7], 0 offen offset:1024 nt lds
    s_add_u32 m0, s75, 26496
    s_nop 0
    buffer_load_dwordx4 v2, s[4:7], 0 offen offset:128 nt lds
    buffer_load_dwordx4 v7, s[4:7], 0 offen offset:1152 nt lds
    s_add_u32 m0, s75, 28672
    s_mul_i32 s81, s74, 2560
    s_add_u32 s12, s48, s81
    s_addc_u32 s13, s49, 0
    buffer_load_dwordx4 v8, s[12:15], 0 offen lds
    buffer_load_dwordx4 v9, s[12:15], 0 offen offset:1024 lds
    s_add_u32 s74, s74, 2
    s_cmp_eq_u32 s74, 10
    s_cselect_b32 s74, 0, s74
    s_mov_b32 s90, 0
    s_mov_b32 s91, -1
    s_mov_b32 s10, 819200
    s_mov_b32 s11, 0x20000
    s_mul_i32 s96, s70, 40960
    s_mul_i32 s99, s69, 160
    s_add_u32 s96, s96, s99
    v_add_u32 v244, s96, v6
    v_add_u32 v30, 0, v1
    v_mul_u32_u24 v31, 0xcd, v30
    v_lshrrev_b32 v31, 11, v31
    v_mul_u32_u24 v31, 1120, v31
    v_add_u32 v80, v244, v31
    v_add_u32 v30, 64, v1
    v_mul_u32_u24 v31, 0xcd, v30
    v_lshrrev_b32 v31, 11, v31
    v_mul_u32_u24 v31, 1120, v31
    v_add_u32 v81, v244, v31
    v_add_u32 v30, 128, v1
    v_mul_u32_u24 v31, 0xcd, v30
    v_lshrrev_b32 v31, 11, v31
    v_mul_u32_u24 v31, 1120, v31
    v_add_u32 v82, v244, v31
    v_add_u32 v30, 192, v1
    v_mul_u32_u24 v31, 0xcd, v30
    v_lshrrev_b32 v31, 11, v31
    v_mul_u32_u24 v31, 1120, v31
    v_add_u32 v83, v244, v31
    v_add_u32 v30, 256, v1
    v_mul_u32_u24 v31, 0xcd, v30
    v_lshrrev_b32 v31, 11, v31
    v_mul_u32_u24 v31, 1120, v31
    v_add_u32 v84, v244, v31
    v_add_u32 v84, 4096, v84
    s_mov_b64 exec, 0
    s_cmp_eq_u32 s70, 0
    s_cbranch_scc1 L_pad0
    s_cmp_eq_u32 s70, 1
    s_cbranch_scc1 L_pad1
    s_cmp_eq_u32 s70, 2
    s_cbranch_scc1 L_pad2
    s_branch L_pad3
L_back:
    s_mov_b64 exec, -1
    s_cmp_eq_u32 s73, 1
    s_cbranch_scc1 L_qpass_1
    s_cmp_eq_u32 s73, 2
    s_cbranch_scc1 L_qpass_2
    s_cmp_eq_u32 s73, 3
    s_cbranch_scc1 L_qpass_3
    s_branch L_qpass_0
.p2align 12
L_qpass_0:
    s_waitcnt vmcnt(7) lgkmcnt(0)
    s_barrier
    ds_read_b128 a[64:67], v10 offset:0
    ds_read_b128 v[144:147], v28 offset:0
    ds_read_b128 a[68:71], v11 offset:0
    ds_read_b128 v[148:151], v28 offset:32
    ds_read_b128 a[72:75], v12 offset:0
    ds_read_b128 v[152:155], v28 offset:64
    s_waitcnt lgkmcnt(4)
    v_mfma_f32_32x32x16_bf16 v[64:79], v[144:147], a[64:67], 0
    ds_read_b128 a[76:79], v13 offset:0
    ds_read_b128 v[156:159], v28 offset:96
    s_add_u32 m0, s75, 49152
    s_mul_i32 s81, s74, 128
    s_add_u32 s4, s44, s81
    s_addc_u32 s5, s45, 0
    buffer_load_dwordx4 v2, s[4:7], 0 offen nt lds
    buffer_load_dwordx4 v7, s[4:7], 0 offen offset:1024 nt lds
    s_waitcnt lgkmcnt(4)
    v_mfma_f32_32x32x16_bf16 v[64:79], v[148:151], a[68:71], v[64:79]
    ds_read_b128 a[80:83], v10 offset:2048
    ds_read_b128 v[144:147], v28 offset:128
    s_add_u32 m0, s75, 51072
    s_nop 0
    buffer_load_dwordx4 v2, s[4:7], 0 offen offset:128 nt lds
    buffer_load_dwordx4 v7, s[4:7], 0 offen offset:1152 nt lds
    s_add_u32 m0, s75, 53248
    s_mul_i32 s81, s74, 2560
    s_waitcnt lgkmcnt(4)
    v_mfma_f32_32x32x16_bf16 v[64:79], v[152:155], a[72:75], v[64:79]
    ds_read_b128 a[84:87], v11 offset:2048
    ds_read_b128 v[148:151], v28 offset:160
    s_add_u32 s12, s48, s81
    s_addc_u32 s13, s49, 0
    buffer_load_dwordx4 v8, s[12:15], 0 offen lds
    buffer_load_dwordx4 v9, s[12:15], 0 offen offset:1024 lds
    s_add_u32 s74, s74, 2
    s_cmp_eq_u32 s74, 10
    s_cselect_b32 s74, 0, s74
    s_waitcnt lgkmcnt(4)
    v_mfma_f32_32x32x16_bf16 v[64:79], v[156:159], a[76:79], v[64:79]
    ds_read_b128 a[88:91], v12 offset:2048
    ds_read_b128 v[152:155], v28 offset:192
    s_add_u32 m0, s75, 73728
    s_mul_i32 s81, s74, 128
    s_add_u32 s4, s44, s81
    s_addc_u32 s5, s45, 0
    buffer_load_dwordx4 v2, s[4:7], 0 offen nt lds
    buffer_load_dwordx4 v7, s[4:7], 0 offen offset:1024 nt lds
    s_waitcnt lgkmcnt(4)
    v_mfma_f32_32x32x16_bf16 v[64:79], v[144:147], a[80:83], v[64:79]
    ds_read_b128 a[92:95], v13 offset:2048
    ds_read_b128 v[156:159], v28 offset:224
    s_add_u32 m0, s75, 75648
    s_nop 0
    buffer_load_dwordx4 v2, s[4:7], 0 offen offset:128 nt lds
    buffer_load_dwordx4 v7, s[4:7], 0 offen offset:1152 nt lds
    s_add_u32 m0, s75, 77824
    s_mul_i32 s81, s74, 2560
    s_waitcnt lgkmcnt(4)
    v_mfma_f32_32x32x16_bf16 v[64:79], v[148:151], a[84:87], v[64:79]
    s_waitcnt vmcnt(10)
    s_barrier
    ds_read_b128 a[96:99], v10 offset:24576
    ds_read_b128 v[144:147], v28 offset:256
    s_add_u32 s12, s48, s81
    s_addc_u32 s13, s49, 0
    s_waitcnt lgkmcnt(4)
    v_mfma_f32_32x32x16_bf16 v[64:79], v[152:155], a[88:91], v[64:79]
    ds_read_b128 a[100:103], v11 offset:24576
    ds_read_b128 v[148:151], v28 offset:288
    buffer_load_dwordx4 v8, s[12:15], 0 offen lds
    buffer_load_dwordx4 v9, s[12:15], 0 offen offset:1024 lds
    s_add_u32 s74, s74, 2
    s_cmp_eq_u32 s74, 10
    s_cselect_b32 s74, 0, s74
    s_add_u32 m0, s75, 98304
    s_waitcnt lgkmcnt(4)
    v_mfma_f32_32x32x16_bf16 v[64:79], v[156:159], a[92:95], v[64:79]
    ds_read_b128 a[104:107], v12 offset:24576
    ds_read_b128 v[152:155], v28 offset:320
    s_mul_i32 s81, s74, 128
    s_add_u32 s4, s44, s81
    s_addc_u32 s5, s45, 0
    s_waitcnt lgkmcnt(4)
    v_mfma_f32_32x32x16_bf16 v[64:79], v[144:147], a[96:99], v[64:79]
    ds_read_b128 a[108:111], v13 offset:24576
    ds_read_b128 v[156:159], v28 offset:352
    buffer_load_dwordx4 v2, s[4:7], 0 offen nt lds
    buffer_load_dwordx4 v7, s[4:7], 0 offen offset:1024 nt lds
    s_add_u32 m0, s75, 100224
    s_nop 0
    s_waitcnt lgkmcnt(4)
    v_mfma_f32_32x32x16_bf16 v[64:79], v[148:151], a[100:103], v[64:79]
    ds_read_b128 a[112:115], v10 offset:26624
    ds_read_b128 v[144:147], v28 offset:384
    buffer_load_dwordx4 v2, s[4:7], 0 offen offset:128 nt lds
    s_waitcnt lgkmcnt(4)
    v_mfma_f32_32x32x16_bf16 v[64:79], v[152:155], a[104:107], v[64:79]
    ds_read_b128 a[116:119], v11 offset:26624
    ds_read_b128 v[148:151], v28 offset:416
    buffer_load_dwordx4 v7, s[4:7], 0 offen offset:1152 nt lds
    s_add_u32 m0, s75, 102400
    s_mul_i32 s81, s74, 2560
    s_waitcnt lgkmcnt(4)
    v_mfma_f32_32x32x16_bf16 v[64:79], v[156:159], a[108:111], v[64:79]
    ds_read_b128 a[120:123], v12 offset:26624
    ds_read_b128 v[152:155], v28 offset:448
    s_add_u32 s12, s48, s81
    s_addc_u32 s13, s49, 0
    buffer_load_dwordx4 v8, s[12:15], 0 offen lds
    s_waitcnt lgkmcnt(4)
    v_mfma_f32_32x32x16_bf16 v[64:79], v[144:147], a[112:115], v[64:79]
    ds_read_b128 a[124:127], v13 offset:26624
    ds_read_b128 v[156:159], v28 offset:480
    buffer_load_dwordx4 v9, s[12:15], 0 offen offset:1024 lds
    s_add_u32 s74, s74, 2
    s_cmp_eq_u32 s74, 10
    s_cselect_b32 s74, 0, s74
    s_waitcnt lgkmcnt(4)
    v_mfma_f32_32x32x16_bf16 v[64:79], v[148:151], a[116:119], v[64:79]
    s_waitcnt vmcnt(12)
    s_barrier
    ds_read_b128 a[128:131], v10 offset:49152
    ds_read_b128 v[144:147], v28 offset:512
    s_add_u32 m0, s75, 0
    s_waitcnt lgkmcnt(4)
    v_mfma_f32_32x32x16_bf16 v[64:79], v[152:155], a[120:123], v[64:79]
    ds_read_b128 a[132:135], v11 offset:49152
    ds_read_b128 v[148:151], v28 offset:544
    s_mul_i32 s81, s74, 81920
    s_add_u32 s8, s46, s81
    s_addc_u32 s9, s47, 0
    s_waitcnt lgkmcnt(4)
    v_mfma_f32_32x32x16_bf16 v[64:79], v[156:159], a[124:127], v[64:79]
    ds_read_b128 a[136:139], v12 offset:49152
    ds_read_b128 v[152:155], v28 offset:576
    buffer_load_dwordx4 v80, s[8:11], 0 offen lds
    s_waitcnt lgkmcnt(4)
    v_mfma_f32_32x32x16_bf16 v[64:79], v[144:147], a[128:131], v[64:79]
    ds_read_b128 a[140:143], v13 offset:49152
    ds_read_b128 v[156:159], v28 offset:608
    buffer_load_dwordx4 v81, s[8:11], 0 offen offset:1024 lds
    s_waitcnt lgkmcnt(4)
    v_mfma_f32_32x32x16_bf16 v[64:79], v[148:151], a[132:135], v[64:79]
    ds_read_b128 a[144:147], v10 offset:51200
    ds_read_b128 v[144:147], v28 offset:640
    buffer_load_dwordx4 v82, s[8:11], 0 offen offset:2048 lds
    s_waitcnt lgkmcnt(4)
    v_mfma_f32_32x32x16_bf16 v[64:79], v[152:155], a[136:139], v[64:79]
    ds_read_b128 a[148:151], v11 offset:51200
    ds_read_b128 v[148:151], v28 offset:672
    s_waitcnt lgkmcnt(4)
    v_mfma_f32_32x32x16_bf16 v[64:79], v[156:159], a[140:143], v[64:79]
    ds_read_b128 a[152:155], v12 offset:51200
    ds_read_b128 v[152:155], v28 offset:704
    buffer_load_dwordx4 v83, s[8:11], 0 offen offset:3072 lds
    s_add_u32 m0, s75, 4096
    s_add_u32 s74, s74, 2
    s_waitcnt lgkmcnt(4)
    v_mfma_f32_32x32x16_bf16 v[64:79], v[144:147], a[144:147], v[64:79]
    ds_read_b128 a[156:159], v13 offset:51200
    ds_read_b128 v[156:159], v28 offset:736
    buffer_load_dwordx4 v84, s[8:11], 0 offen lds
    s_cmp_eq_u32 s74, 10
    s_cselect_b32 s74, 0, s74
    s_waitcnt lgkmcnt(4)
    v_mfma_f32_32x32x16_bf16 v[64:79], v[148:151], a[148:151], v[64:79]
    s_waitcnt vmcnt(11)
    s_barrier
    ds_read_b128 a[160:163], v14 offset:16384
    ds_read_b128 v[144:147], v28 offset:768
    s_add_u32 m0, s75, 24576
    s_waitcnt lgkmcnt(4)
    v_mfma_f32_32x32x16_bf16 v[64:79], v[152:155], a[152:155], v[64:79]
    ds_read_b128 a[164:167], v15 offset:16384
    ds_read_b128 v[148:151], v28 offset:800
    s_mul_i32 s81, s74, 81920
    s_add_u32 s8, s46, s81
    s_addc_u32 s9, s47, 0
    s_waitcnt lgkmcnt(4)
    v_mfma_f32_32x32x16_bf16 v[64:79], v[156:159], a[156:159], v[64:79]
    ds_read_b128 a[168:171], v16 offset:16384
    ds_read_b128 v[152:155], v28 offset:832
    buffer_load_dwordx4 v80, s[8:11], 0 offen lds
    s_waitcnt lgkmcnt(4)
    v_mfma_f32_32x32x16_bf16 v[64:79], v[144:147], a[160:163], v[64:79]
    ds_read_b128 a[172:175], v17 offset:16384
    ds_read_b128 v[156:159], v28 offset:864
    buffer_load_dwordx4 v81, s[8:11], 0 offen offset:1024 lds
    s_waitcnt lgkmcnt(4)
    v_mfma_f32_32x32x16_bf16 v[64:79], v[148:151], a[164:167], v[64:79]
    ds_read_b128 a[176:179], v14 offset:18432
    ds_read_b128 v[144:147], v28 offset:896
    buffer_load_dwordx4 v82, s[8:11], 0 offen offset:2048 lds
    s_waitcnt lgkmcnt(4)
    v_mfma_f32_32x32x16_bf16 v[64:79], v[152:155], a[168:171], v[64:79]
    ds_read_b128 a[180:183], v15 offset:18432
    ds_read_b128 v[148:151], v28 offset:928
    s_waitcnt lgkmcnt(4)
    v_mfma_f32_32x32x16_bf16 v[64:79], v[156:159], a[172:175], v[64:79]
    ds_read_b128 a[184:187], v16 offset:18432
    ds_read_b128 v[152:155], v28 offset:960
    buffer_load_dwordx4 v83, s[8:11], 0 offen offset:3072 lds
    s_add_u32 m0, s75, 28672
    s_add_u32 s74, s74, 2
    s_waitcnt lgkmcnt(4)
    v_mfma_f32_32x32x16_bf16 v[64:79], v[144:147], a[176:179], v[64:79]
    ds_read_b128 a[188:191], v17 offset:18432
    ds_read_b128 v[156:159], v28 offset:992
    buffer_load_dwordx4 v84, s[8:11], 0 offen lds
    s_cmp_eq_u32 s74, 10
    s_cselect_b32 s74, 0, s74
    s_waitcnt lgkmcnt(4)
    v_mfma_f32_32x32x16_bf16 v[64:79], v[148:151], a[180:183], v[64:79]
    s_waitcnt vmcnt(10)
    s_barrier
    ds_read_b128 a[192:195], v14 offset:40960
    ds_read_b128 v[144:147], v28 offset:1024
    s_add_u32 m0, s75, 49152
    s_waitcnt lgkmcnt(4)
    v_mfma_f32_32x32x16_bf16 v[64:79], v[152:155], a[184:187], v[64:79]
    ds_read_b128 a[196:199], v15 offset:40960
    ds_read_b128 v[148:151], v28 offset:1056
    s_mul_i32 s81, s74, 81920
    s_add_u32 s8, s46, s81
    s_addc_u32 s9, s47, 0
    s_waitcnt lgkmcnt(4)
    v_mfma_f32_32x32x16_bf16 v[64:79], v[156:159], a[188:191], v[64:79]
    ds_read_b128 a[200:203], v16 offset:40960
    ds_read_b128 v[152:155], v28 offset:1088
    s_waitcnt lgkmcnt(4)
    v_mfma_f32_32x32x16_bf16 v[64:79], v[144:147], a[192:195], v[64:79]
    ds_read_b128 a[204:207], v17 offset:40960
    ds_read_b128 v[156:159], v28 offset:1120
    buffer_load_dwordx4 v80, s[8:11], 0 offen lds
    s_waitcnt lgkmcnt(4)
    v_mfma_f32_32x32x16_bf16 v[64:79], v[148:151], a[196:199], v[64:79]
    ds_read_b128 a[208:211], v14 offset:43008
    ds_read_b128 v[144:147], v28 offset:1152
    buffer_load_dwordx4 v81, s[8:11], 0 offen offset:1024 lds
    s_waitcnt lgkmcnt(4)
    v_mfma_f32_32x32x16_bf16 v[64:79], v[152:155], a[200:203], v[64:79]
    ds_read_b128 a[212:215], v15 offset:43008
    ds_read_b128 v[148:151], v28 offset:1184
    buffer_load_dwordx4 v82, s[8:11], 0 offen offset:2048 lds
    s_waitcnt lgkmcnt(4)
    v_mfma_f32_32x32x16_bf16 v[64:79], v[156:159], a[204:207], v[64:79]
    ds_read_b128 a[216:219], v16 offset:43008
    ds_read_b128 v[152:155], v28 offset:1216
    s_waitcnt lgkmcnt(4)
    v_mfma_f32_32x32x16_bf16 v[64:79], v[144:147], a[208:211], v[64:79]
    ds_read_b128 a[220:223], v17 offset:43008
    ds_read_b128 v[156:159], v28 offset:1248
    buffer_load_dwordx4 v83, s[8:11], 0 offen offset:3072 lds
    s_add_u32 m0, s75, 53248
    s_add_u32 s74, s74, 2
    s_waitcnt lgkmcnt(4)
    v_mfma_f32_32x32x16_bf16 v[64:79], v[148:151], a[212:215], v[64:79]
    buffer_load_dwordx4 v84, s[8:11], 0 offen lds
    s_cmp_eq_u32 s74, 10
    s_cselect_b32 s74, 0, s74
    s_waitcnt lgkmcnt(2)
    v_mfma_f32_32x32x16_bf16 v[64:79], v[152:155], a[216:219], v[64:79]
    s_waitcnt vmcnt(10)
    s_barrier
    ds_read_b64_tr_b16 v[108:109], v18 offset:0
    ds_read_b64_tr_b16 v[110:111], v18 offset:640
    ds_read_b64_tr_b16 v[112:113], v18 offset:40
    ds_read_b64_tr_b16 v[114:115], v18 offset:680
    buffer_load_dword v209, v210, s[16:19], 0 offen
    s_waitcnt lgkmcnt(4)
    v_mfma_f32_32x32x16_bf16 v[64:79], v[156:159], a[220:223], v[64:79]
    ds_read_b64_tr_b16 v[120:121], v18 offset:2560
    ds_read_b64_tr_b16 v[122:123], v18 offset:3200
    ds_read_b64_tr_b16 v[124:125], v18 offset:2600
    ds_read_b64_tr_b16 v[126:127], v18 offset:3240
    s_add_u32 m0, s75, 73728
    s_mul_i32 s81, s74, 81920
    s_add_u32 s8, s46, s81
    s_addc_u32 s9, s47, 0
    s_nop 7
    v_mul_f32 v64, 0x3fb8aa3b, v64
    v_min_f32 v64, 0x42800000, v64
    v_exp_f32 v64, v64
    s_waitcnt lgkmcnt(4)
    s_branch L_ffn1
L_qpass_1:
    v_and_b32 v138, 0x33, v1
    v_bfe_u32 v139, v1, 2, 1
    v_lshl_or_b32 v138, v139, 3, v138
    v_bfe_u32 v139, v1, 3, 1
    v_lshl_or_b32 v138, v139, 2, v138
    v_lshlrev_b32 v139, 3, v138
    v_lshlrev_b32 v138, 4, v138
    v_mov_b32 v140, 0x3f803f80
    v_mov_b32 v141, 0x3f80
    v_mov_b32 v142, 0x3ea52b5c
    s_cmp_lg_u32 s69, 0
    s_cbranch_scc1 L_noclear
    s_mul_i32 s96, s68, 128
    s_add_u32 s96, s96, 16777216
    v_mov_b32 v31, 0
    v_lshlrev_b32 v30, 2, v1
    s_mov_b64 exec, 0xff
    buffer_store_dword v31, v30, s[20:23], s96 offen sc1
    s_mov_b64 exec, -1
L_noclear:
    s_mul_i32 s83, s68, 8192
    s_mul_i32 s99, s71, 4096
    s_add_u32 s83, s83, s99
    s_waitcnt vmcnt(7) lgkmcnt(0)
    s_barrier
    ds_read_b128 a[64:67], v10 offset:0
    ds_read_b64_tr_b16 v[144:145], v20 offset:4096
    ds_read_b64_tr_b16 v[146:147], v20 offset:4256
    ds_read_b128 a[68:71], v11 offset:0
    ds_read_b64_tr_b16 v[148:149], v20 offset:4736
    ds_read_b64_tr_b16 v[150:151], v20 offset:4896
    ds_read_b128 a[72:75], v12 offset:0
    ds_read_b64_tr_b16 v[152:153], v20 offset:10240
    ds_read_b64_tr_b16 v[154:155], v20 offset:10400
    s_waitcnt lgkmcnt(6)
    v_mfma_f32_32x32x16_bf16 v[64:79], v[144:147], a[64:67], 0
    ds_read_b128 a[76:79], v13 offset:0
    ds_read_b64_tr_b16 v[156:157], v20 offset:10880
    ds_read_b64_tr_b16 v[158:159], v20 offset:11040
    s_add_u32 m0, s75, 49152
    s_mul_i32 s81, s74, 128
    s_add_u32 s4, s44, s81
    s_addc_u32 s5, s45, 0
    buffer_load_dwordx4 v2, s[4:7], 0 offen nt lds
    buffer_load_dwordx4 v7, s[4:7], 0 offen offset:1024 nt lds
    s_waitcnt lgkmcnt(6)
    v_mfma_f32_32x32x16_bf16 v[64:79], v[148:151], a[68:71], v[64:79]
    ds_read_b128 a[80:83], v10 offset:2048
    ds_read_b64_tr_b16 v[144:145], v20 offset:16384
    ds_read_b64_tr_b16 v[146:147], v20 offset:16544
    s_add_u32 m0, s75, 51072
    s_nop 0
    buffer_load_dwordx4 v2, s[4:7], 0 offen offset:128 nt lds
    buffer_load_dwordx4 v7, s[4:7], 0 offen offset:1152 nt lds
    s_add_u32 m0, s75, 53248
    s_mul_i32 s81, s74, 2560
    s_waitcnt lgkmcnt(6)
    v_mfma_f32_32x32x16_bf16 v[64:79], v[152:155], a[72:75], v[64:79]
    ds_read_b128 a[84:87], v11 offset:2048
    ds_read_b64_tr_b16 v[148:149], v20 offset:17024
    ds_read_b64_tr_b16 v[150:151], v20 offset:17184
    s_add_u32 s12, s48, s81
    s_addc_u32 s13, s49, 0
    buffer_load_dwordx4 v8, s[12:15], 0 offen lds
    buffer_load_dwordx4 v9, s[12:15], 0 offen offset:1024 lds
    s_add_u32 s74, s74, 2
    s_cmp_eq_u32 s74, 10
    s_cselect_b32 s74, 0, s74
    s_waitcnt lgkmcnt(6)
    v_mfma_f32_32x32x16_bf16 v[64:79], v[156:159], a[76:79], v[64:79]
    ds_read_b128 a[88:91], v12 offset:2048
    ds_read_b64_tr_b16 v[152:153], v20 offset:22528
    ds_read_b64_tr_b16 v[154:155], v20 offset:22688
    s_add_u32 m0, s75, 73728
    s_mul_i32 s81, s74, 128
    s_add_u32 s4, s44, s81
    s_addc_u32 s5, s45, 0
    buffer_load_dwordx4 v2, s[4:7], 0 offen nt lds
    buffer_load_dwordx4 v7, s[4:7], 0 offen offset:1024 nt lds
    s_waitcnt lgkmcnt(6)
    v_mfma_f32_32x32x16_bf16 v[64:79], v[144:147], a[80:83], v[64:79]
    ds_read_b128 a[92:95], v13 offset:2048
    ds_read_b64_tr_b16 v[156:157], v20 offset:23168
    ds_read_b64_tr_b16 v[158:159], v20 offset:23328
    s_add_u32 m0, s75, 75648
    s_nop 0
    buffer_load_dwordx4 v2, s[4:7], 0 offen offset:128 nt lds
    buffer_load_dwordx4 v7, s[4:7], 0 offen offset:1152 nt lds
    s_add_u32 m0, s75, 77824
    s_mul_i32 s81, s74, 2560
    s_waitcnt lgkmcnt(6)
    v_mfma_f32_32x32x16_bf16 v[64:79], v[148:151], a[84:87], v[64:79]
    s_waitcnt vmcnt(10)
    s_barrier
    ds_read_b128 a[96:99], v10 offset:24576
    ds_read_b64_tr_b16 v[144:145], v20 offset:28672
    ds_read_b64_tr_b16 v[146:147], v20 offset:28832
    s_add_u32 s12, s48, s81
    s_addc_u32 s13, s49, 0
    s_waitcnt lgkmcnt(6)
    v_mfma_f32_32x32x16_bf16 v[64:79], v[152:155], a[88:91], v[64:79]
    ds_read_b128 a[100:103], v11 offset:24576
    ds_read_b64_tr_b16 v[148:149], v20 offset:29312
    ds_read_b64_tr_b16 v[150:151], v20 offset:29472
    buffer_load_dwordx4 v8, s[12:15], 0 offen lds
    buffer_load_dwordx4 v9, s[12:15], 0 offen offset:1024 lds
    s_add_u32 s74, s74, 2
    s_cmp_eq_u32 s74, 10
    s_cselect_b32 s74, 0, s74
    s_add_u32 m0, s75, 98304
    s_waitcnt lgkmcnt(6)
    v_mfma_f32_32x32x16_bf16 v[64:79], v[156:159], a[92:95], v[64:79]
    ds_read_b128 a[104:107], v12 offset:24576
    ds_read_b64_tr_b16 v[152:153], v20 offset:34816
    ds_read_b64_tr_b16 v[154:155], v20 offset:34976
    s_mul_i32 s81, s74, 128
    s_add_u32 s4, s44, s81
    s_addc_u32 s5, s45, 0
    s_waitcnt lgkmcnt(6)
    v_mfma_f32_32x32x16_bf16 v[64:79], v[144:147], a[96:99], v[64:79]
    ds_read_b128 a[108:111], v13 offset:24576
    ds_read_b64_tr_b16 v[156:157], v20 offset:35456
    ds_read_b64_tr_b16 v[158:159], v20 offset:35616
    buffer_load_dwordx4 v2, s[4:7], 0 offen nt lds
    buffer_load_dwordx4 v7, s[4:7], 0 offen offset:1024 nt lds
    s_add_u32 m0, s75, 100224
    s_nop 0
    s_waitcnt lgkmcnt(6)
    v_mfma_f32_32x32x16_bf16 v[64:79], v[148:151], a[100:103], v[64:79]
    ds_read_b128 a[112:115], v10 offset:26624
    ds_read_b64_tr_b16 v[144:145], v20 offset:40960
    ds_read_b64_tr_b16 v[146:147], v20 offset:41120
    buffer_load_dwordx4 v2, s[4:7], 0 offen offset:128 nt lds
    s_waitcnt lgkmcnt(6)
    v_mfma_f32_32x32x16_bf16 v[64:79], v[152:155], a[104:107], v[64:79]
    ds_read_b128 a[116:119], v11 offset:26624
    ds_read_b64_tr_b16 v[148:149], v20 offset:41600
    ds_read_b64_tr_b16 v[150:151], v20 offset:41760
    buffer_load_dwordx4 v7, s[4:7], 0 offen offset:1152 nt lds
    s_add_u32 m0, s75, 102400
    s_mul_i32 s81, s74, 2560
    s_waitcnt lgkmcnt(6)
    v_mfma_f32_32x32x16_bf16 v[64:79], v[156:159], a[108:111], v[64:79]
    ds_read_b128 a[120:123], v12 offset:26624
    ds_read_b64_tr_b16 v[152:153], v20 offset:47104
    ds_read_b64_tr_b16 v[154:155], v20 offset:47264
    s_add_u32 s12, s48, s81
    s_addc_u32 s13, s49, 0
    buffer_load_dwordx4 v8, s[12:15], 0 offen lds
    s_waitcnt lgkmcnt(6)
    v_mfma_f32_32x32x16_bf16 v[64:79], v[144:147], a[112:115], v[64:79]
    ds_read_b128 a[124:127], v13 offset:26624
    ds_read_b64_tr_b16 v[156:157], v20 offset:47744
    ds_read_b64_tr_b16 v[158:159], v20 offset:47904
    buffer_load_dwordx4 v9, s[12:15], 0 offen offset:1024 lds
    s_add_u32 s74, s74, 2
    s_cmp_eq_u32 s74, 10
    s_cselect_b32 s74, 0, s74
    s_waitcnt lgkmcnt(6)
    v_mfma_f32_32x32x16_bf16 v[64:79], v[148:151], a[116:119], v[64:79]
    s_waitcnt vmcnt(12)
    s_barrier
    ds_read_b128 a[128:131], v10 offset:49152
    ds_read_b64_tr_b16 v[144:145], v20 offset:53248
    ds_read_b64_tr_b16 v[146:147], v20 offset:53408
    s_add_u32 m0, s75, 0
    s_waitcnt lgkmcnt(6)
    v_mfma_f32_32x32x16_bf16 v[64:79], v[152:155], a[120:123], v[64:79]
    ds_read_b128 a[132:135], v11 offset:49152
    ds_read_b64_tr_b16 v[148:149], v20 offset:53888
    ds_read_b64_tr_b16 v[150:151], v20 offset:54048
    s_mul_i32 s81, s74, 81920
    s_add_u32 s8, s46, s81
    s_addc_u32 s9, s47, 0
    s_waitcnt lgkmcnt(6)
    v_mfma_f32_32x32x16_bf16 v[64:79], v[156:159], a[124:127], v[64:79]
    ds_read_b128 a[136:139], v12 offset:49152
    ds_read_b64_tr_b16 v[152:153], v20 offset:59392
    ds_read_b64_tr_b16 v[154:155], v20 offset:59552
    buffer_load_dwordx4 v80, s[8:11], 0 offen lds
    s_waitcnt lgkmcnt(6)
    v_mfma_f32_32x32x16_bf16 v[64:79], v[144:147], a[128:131], v[64:79]
    ds_read_b128 a[140:143], v13 offset:49152
    ds_read_b64_tr_b16 v[156:157], v20 offset:60032
    ds_read_b64_tr_b16 v[158:159], v20 offset:60192
    buffer_load_dwordx4 v81, s[8:11], 0 offen offset:1024 lds
    s_waitcnt lgkmcnt(6)
    v_mfma_f32_32x32x16_bf16 v[64:79], v[148:151], a[132:135], v[64:79]
    ds_read_b128 a[144:147], v10 offset:51200
    ds_read_b64_tr_b16 v[144:145], v21 offset:8192
    ds_read_b64_tr_b16 v[146:147], v21 offset:8352
    buffer_load_dwordx4 v82, s[8:11], 0 offen offset:2048 lds
    s_waitcnt lgkmcnt(6)
    v_mfma_f32_32x32x16_bf16 v[64:79], v[152:155], a[136:139], v[64:79]
    ds_read_b128 a[148:151], v11 offset:51200
    ds_read_b64_tr_b16 v[148:149], v21 offset:8832
    ds_read_b64_tr_b16 v[150:151], v21 offset:8992
    s_waitcnt lgkmcnt(6)
    v_mfma_f32_32x32x16_bf16 v[64:79], v[156:159], a[140:143], v[64:79]
    ds_read_b128 a[152:155], v12 offset:51200
    ds_read_b64_tr_b16 v[152:153], v21 offset:14336
    ds_read_b64_tr_b16 v[154:155], v21 offset:14496
    buffer_load_dwordx4 v83, s[8:11], 0 offen offset:3072 lds
    s_add_u32 m0, s75, 4096
    s_add_u32 s74, s74, 2
    s_waitcnt lgkmcnt(6)
    v_mfma_f32_32x32x16_bf16 v[64:79], v[144:147], a[144:147], v[64:79]
    ds_read_b128 a[156:159], v13 offset:51200
    ds_read_b64_tr_b16 v[156:157], v21 offset:14976
    ds_read_b64_tr_b16 v[158:159], v21 offset:15136
    buffer_load_dwordx4 v84, s[8:11], 0 offen lds
    s_cmp_eq_u32 s74, 10
    s_cselect_b32 s74, 0, s74
    s_waitcnt lgkmcnt(6)
    v_mfma_f32_32x32x16_bf16 v[64:79], v[148:151], a[148:151], v[64:79]
    s_waitcnt vmcnt(11)
    s_barrier
    ds_read_b128 a[160:163], v14 offset:16384
    ds_read_b64_tr_b16 v[144:145], v21 offset:20480
    ds_read_b64_tr_b16 v[146:147], v21 offset:20640
    s_add_u32 m0, s75, 24576
    s_waitcnt lgkmcnt(6)
    v_mfma_f32_32x32x16_bf16 v[64:79], v[152:155], a[152:155], v[64:79]
    ds_read_b128 a[164:167], v15 offset:16384
    ds_read_b64_tr_b16 v[148:149], v21 offset:21120
    ds_read_b64_tr_b16 v[150:151], v21 offset:21280
    s_mul_i32 s81, s74, 81920
    s_add_u32 s8, s46, s81
    s_addc_u32 s9, s47, 0
    s_waitcnt lgkmcnt(6)
    v_mfma_f32_32x32x16_bf16 v[64:79], v[156:159], a[156:159], v[64:79]
    ds_read_b128 a[168:171], v16 offset:16384
    ds_read_b64_tr_b16 v[152:153], v21 offset:26624
    ds_read_b64_tr_b16 v[154:155], v21 offset:26784
    buffer_load_dwordx4 v80, s[8:11], 0 offen lds
    s_waitcnt lgkmcnt(6)
    v_mfma_f32_32x32x16_bf16 v[64:79], v[144:147], a[160:163], v[64:79]
    ds_read_b128 a[172:175], v17 offset:16384
    ds_read_b64_tr_b16 v[156:157], v21 offset:27264
    ds_read_b64_tr_b16 v[158:159], v21 offset:27424
    buffer_load_dwordx4 v81, s[8:11], 0 offen offset:1024 lds
    s_waitcnt lgkmcnt(6)
    v_mfma_f32_32x32x16_bf16 v[64:79], v[148:151], a[164:167], v[64:79]
    ds_read_b128 a[176:179], v14 offset:18432
    ds_read_b64_tr_b16 v[144:145], v21 offset:32768
    ds_read_b64_tr_b16 v[146:147], v21 offset:32928
    buffer_load_dwordx4 v82, s[8:11], 0 offen offset:2048 lds
    s_waitcnt lgkmcnt(6)
    v_mfma_f32_32x32x16_bf16 v[64:79], v[152:155], a[168:171], v[64:79]
    ds_read_b128 a[180:183], v15 offset:18432
    ds_read_b64_tr_b16 v[148:149], v21 offset:33408
    ds_read_b64_tr_b16 v[150:151], v21 offset:33568
    s_waitcnt lgkmcnt(6)
    v_mfma_f32_32x32x16_bf16 v[64:79], v[156:159], a[172:175], v[64:79]
    ds_read_b128 a[184:187], v16 offset:18432
    ds_read_b64_tr_b16 v[152:153], v21 offset:38912
    ds_read_b64_tr_b16 v[154:155], v21 offset:39072
    buffer_load_dwordx4 v83, s[8:11], 0 offen offset:3072 lds
    s_add_u32 m0, s75, 28672
    s_add_u32 s74, s74, 2
    s_waitcnt lgkmcnt(6)
    v_mfma_f32_32x32x16_bf16 v[64:79], v[144:147], a[176:179], v[64:79]
    ds_read_b128 a[188:191], v17 offset:18432
    ds_read_b64_tr_b16 v[156:157], v21 offset:39552
    ds_read_b64_tr_b16 v[158:159], v21 offset:39712
    buffer_load_dwordx4 v84, s[8:11], 0 offen lds
    s_cmp_eq_u32 s74, 10
    s_cselect_b32 s74, 0, s74
    s_waitcnt lgkmcnt(6)
    v_mfma_f32_32x32x16_bf16 v[64:79], v[148:151], a[180:183], v[64:79]
    s_waitcnt vmcnt(10)
    s_barrier
    ds_read_b128 a[192:195], v14 offset:40960
    ds_read_b64_tr_b16 v[144:145], v21 offset:45056
    ds_read_b64_tr_b16 v[146:147], v21 offset:45216
    s_add_u32 m0, s75, 49152
    s_waitcnt lgkmcnt(6)
    v_mfma_f32_32x32x16_bf16 v[64:79], v[152:155], a[184:187], v[64:79]
    ds_read_b128 a[196:199], v15 offset:40960
    ds_read_b64_tr_b16 v[148:149], v21 offset:45696
    ds_read_b64_tr_b16 v[150:151], v21 offset:45856
    s_mul_i32 s81, s74, 81920
    s_add_u32 s8, s46, s81
    s_addc_u32 s9, s47, 0
    s_waitcnt lgkmcnt(6)
    v_mfma_f32_32x32x16_bf16 v[64:79], v[156:159], a[188:191], v[64:79]
    ds_read_b128 a[200:203], v16 offset:40960
    ds_read_b64_tr_b16 v[152:153], v21 offset:51200
    ds_read_b64_tr_b16 v[154:155], v21 offset:51360
    s_waitcnt lgkmcnt(6)
    v_mfma_f32_32x32x16_bf16 v[64:79], v[144:147], a[192:195], v[64:79]
    ds_read_b128 a[204:207], v17 offset:40960
    ds_read_b64_tr_b16 v[156:157], v21 offset:51840
    ds_read_b64_tr_b16 v[158:159], v21 offset:52000
    buffer_load_dwordx4 v80, s[8:11], 0 offen lds
    s_waitcnt lgkmcnt(6)
    v_mfma_f32_32x32x16_bf16 v[64:79], v[148:151], a[196:199], v[64:79]
    ds_read_b128 a[208:211], v14 offset:43008
    ds_read_b64_tr_b16 v[144:145], v21 offset:57344
    ds_read_b64_tr_b16 v[146:147], v21 offset:57504
    buffer_load_dwordx4 v81, s[8:11], 0 offen offset:1024 lds
    s_waitcnt lgkmcnt(6)
    v_mfma_f32_32x32x16_bf16 v[64:79], v[152:155], a[200:203], v[64:79]
    ds_read_b128 a[212:215], v15 offset:43008
    ds_read_b64_tr_b16 v[148:149], v21 offset:57984
    ds_read_b64_tr_b16 v[150:151], v21 offset:58144
    buffer_load_dwordx4 v82, s[8:11], 0 offen offset:2048 lds
    s_waitcnt lgkmcnt(6)
    v_mfma_f32_32x32x16_bf16 v[64:79], v[156:159], a[204:207], v[64:79]
    ds_read_b128 a[216:219], v16 offset:43008
    ds_read_b64_tr_b16 v[152:153], v21 offset:63488
    ds_read_b64_tr_b16 v[154:155], v21 offset:63648
    s_waitcnt lgkmcnt(6)
    v_mfma_f32_32x32x16_bf16 v[64:79], v[144:147], a[208:211], v[64:79]
    ds_read_b128 a[220:223], v17 offset:43008
    ds_read_b64_tr_b16 v[156:157], v21 offset:64128
    ds_read_b64_tr_b16 v[158:159], v21 offset:64288
    buffer_load_dwordx4 v83, s[8:11], 0 offen offset:3072 lds
    s_add_u32 m0, s75, 53248
    s_add_u32 s74, s74, 2
    s_waitcnt lgkmcnt(6)
    v_mfma_f32_32x32x16_bf16 v[64:79], v[148:151], a[212:215], v[64:79]
    buffer_load_dwordx4 v84, s[8:11], 0 offen lds
L_pad0:
    s_cbranch_execz L_pad4
    s_cmp_eq_u32 s74, 10
    s_cselect_b32 s74, 0, s74
    s_waitcnt lgkmcnt(3)
    v_mfma_f32_32x32x16_bf16 v[64:79], v[152:155], a[216:219], v[64:79]
    s_waitcnt vmcnt(10)
    s_barrier
    ds_read_b64_tr_b16 v[108:109], v18 offset:0
    ds_read_b64_tr_b16 v[110:111], v18 offset:640
    ds_read_b64_tr_b16 v[112:113], v18 offset:40
    ds_read_b64_tr_b16 v[114:115], v18 offset:680
    buffer_load_dword v209, v210, s[16:19], 0 offen
    s_waitcnt lgkmcnt(4)
    v_mfma_f32_32x32x16_bf16 v[64:79], v[156:159], a[220:223], v[64:79]
    ds_read_b64_tr_b16 v[120:121], v18 offset:2560
    ds_read_b64_tr_b16 v[122:123], v18 offset:3200
    ds_read_b64_tr_b16 v[124:125], v18 offset:2600
    ds_read_b64_tr_b16 v[126:127], v18 offset:3240
    s_add_u32 m0, s75, 73728
    s_mul_i32 s81, s74, 81920
    s_add_u32 s8, s46, s81
    s_addc_u32 s9, s47, 0
    s_nop 7
    v_pk_mul_f32 v[64:65], v[64:65], v[142:143] op_sel_hi:[1,0]
    v_pk_mul_f32 v[66:67], v[66:67], v[142:143] op_sel_hi:[1,0]
    v_pk_mul_f32 v[68:69], v[68:69], v[142:143] op_sel_hi:[1,0]
    v_pk_mul_f32 v[70:71], v[70:71], v[142:143] op_sel_hi:[1,0]
    v_pk_mul_f32 v[72:73], v[72:73], v[142:143] op_sel_hi:[1,0]
    v_pk_mul_f32 v[74:75], v[74:75], v[142:143] op_sel_hi:[1,0]
    v_cvt_pk_bf16_f32 v64, v64, v65
    v_cvt_pk_bf16_f32 v65, v66, v67
    v_cvt_pk_bf16_f32 v66, v68, v69
    v_cvt_pk_bf16_f32 v67, v70, v71
    v_cvt_pk_bf16_f32 v68, v72, v73
    v_cvt_pk_bf16_f32 v69, v74, v75
    buffer_store_dwordx4 v[64:67], v138, s[20:23], s83 offen sc1
    v_cndmask_b32_e64 v68, v68, v140, s[90:91]
    v_cndmask_b32_e64 v69, v69, v141, s[90:91]
    buffer_store_dwordx2 v[68:69], v139, s[20:23], s83 offen offset:3072 sc1
    s_waitcnt lgkmcnt(4)
    s_branch L_ffn1
L_qpass_2:
    v_and_b32 v30, 31, v1
    v_cmp_gt_u32 vcc, 20, v30
    v_cmp_eq_u32_e64 s[92:93], 20, v30
    v_mov_b32 v139, 0x3f803f80
    v_cndmask_b32_e64 v138, 0, -1, vcc
    v_cndmask_b32_e64 v139, 0, v139, s[92:93]
    s_mul_i32 s83, s68, 8192
    s_mul_i32 s99, s71, 4096
    s_add_u32 s83, s83, s99
    s_waitcnt vmcnt(7) lgkmcnt(0)
    s_barrier
    ds_read_b128 a[64:67], v10 offset:0
    ds_read_b64_tr_b16 v[144:145], v20 offset:4096
    ds_read_b64_tr_b16 v[146:147], v20 offset:4256
    ds_read_b128 a[68:71], v11 offset:0
    ds_read_b64_tr_b16 v[148:149], v20 offset:4736
    ds_read_b64_tr_b16 v[150:151], v20 offset:4896
    ds_read_b128 a[72:75], v12 offset:0
    ds_read_b64_tr_b16 v[152:153], v20 offset:10240
    ds_read_b64_tr_b16 v[154:155], v20 offset:10400
    s_waitcnt lgkmcnt(6)
    v_mfma_f32_32x32x16_bf16 v[64:79], a[64:67], v[144:147], 0
    ds_read_b128 a[76:79], v13 offset:0
    ds_read_b64_tr_b16 v[156:157], v20 offset:10880
    ds_read_b64_tr_b16 v[158:159], v20 offset:11040
    s_add_u32 m0, s75, 49152
    s_mul_i32 s81, s74, 128
    s_add_u32 s4, s44, s81
    s_addc_u32 s5, s45, 0
    buffer_load_dwordx4 v2, s[4:7], 0 offen nt lds
    buffer_load_dwordx4 v7, s[4:7], 0 offen offset:1024 nt lds
    s_waitcnt lgkmcnt(6)
    v_mfma_f32_32x32x16_bf16 v[64:79], a[68:71], v[148:151], v[64:79]
    ds_read_b128 a[80:83], v10 offset:2048
    ds_read_b64_tr_b16 v[144:145], v20 offset:16384
    ds_read_b64_tr_b16 v[146:147], v20 offset:16544
    s_add_u32 m0, s75, 51072
    s_nop 0
    buffer_load_dwordx4 v2, s[4:7], 0 offen offset:128 nt lds
    buffer_load_dwordx4 v7, s[4:7], 0 offen offset:1152 nt lds
    s_add_u32 m0, s75, 53248
    s_mul_i32 s81, s74, 2560
    s_waitcnt lgkmcnt(6)
    v_mfma_f32_32x32x16_bf16 v[64:79], a[72:75], v[152:155], v[64:79]
    ds_read_b128 a[84:87], v11 offset:2048
    ds_read_b64_tr_b16 v[148:149], v20 offset:17024
    ds_read_b64_tr_b16 v[150:151], v20 offset:17184
    s_add_u32 s12, s48, s81
    s_addc_u32 s13, s49, 0
    buffer_load_dwordx4 v8, s[12:15], 0 offen lds
    buffer_load_dwordx4 v9, s[12:15], 0 offen offset:1024 lds
    s_add_u32 s74, s74, 2
    s_cmp_eq_u32 s74, 10
    s_cselect_b32 s74, 0, s74
    s_waitcnt lgkmcnt(6)
    v_mfma_f32_32x32x16_bf16 v[64:79], a[76:79], v[156:159], v[64:79]
    ds_read_b128 a[88:91], v12 offset:2048
    ds_read_b64_tr_b16 v[152:153], v20 offset:22528
    ds_read_b64_tr_b16 v[154:155], v20 offset:22688
    s_add_u32 m0, s75, 73728
    s_mul_i32 s81, s74, 128
    s_add_u32 s4, s44, s81
    s_addc_u32 s5, s45, 0
    buffer_load_dwordx4 v2, s[4:7], 0 offen nt lds
    buffer_load_dwordx4 v7, s[4:7], 0 offen offset:1024 nt lds
    s_waitcnt lgkmcnt(6)
    v_mfma_f32_32x32x16_bf16 v[64:79], a[80:83], v[144:147], v[64:79]
    ds_read_b128 a[92:95], v13 offset:2048
    ds_read_b64_tr_b16 v[156:157], v20 offset:23168
    ds_read_b64_tr_b16 v[158:159], v20 offset:23328
    s_add_u32 m0, s75, 75648
    s_nop 0
    buffer_load_dwordx4 v2, s[4:7], 0 offen offset:128 nt lds
    buffer_load_dwordx4 v7, s[4:7], 0 offen offset:1152 nt lds
    s_add_u32 m0, s75, 77824
    s_mul_i32 s81, s74, 2560
    s_waitcnt lgkmcnt(6)
    v_mfma_f32_32x32x16_bf16 v[64:79], a[84:87], v[148:151], v[64:79]
    s_waitcnt vmcnt(10)
    s_barrier
    ds_read_b128 a[96:99], v10 offset:24576
    ds_read_b64_tr_b16 v[144:145], v20 offset:28672
    ds_read_b64_tr_b16 v[146:147], v20 offset:28832
    s_add_u32 s12, s48, s81
    s_addc_u32 s13, s49, 0
    s_waitcnt lgkmcnt(6)
    v_mfma_f32_32x32x16_bf16 v[64:79], a[88:91], v[152:155], v[64:79]
    ds_read_b128 a[100:103], v11 offset:24576
    ds_read_b64_tr_b16 v[148:149], v20 offset:29312
    ds_read_b64_tr_b16 v[150:151], v20 offset:29472
    buffer_load_dwordx4 v8, s[12:15], 0 offen lds
    buffer_load_dwordx4 v9, s[12:15], 0 offen offset:1024 lds
    s_add_u32 s74, s74, 2
    s_cmp_eq_u32 s74, 10
    s_cselect_b32 s74, 0, s74
    s_add_u32 m0, s75, 98304
    s_waitcnt lgkmcnt(6)
    v_mfma_f32_32x32x16_bf16 v[64:79], a[92:95], v[156:159], v[64:79]
    ds_read_b128 a[104:107], v12 offset:24576
    ds_read_b64_tr_b16 v[152:153], v20 offset:34816
    ds_read_b64_tr_b16 v[154:155], v20 offset:34976
    s_mul_i32 s81, s74, 128
    s_add_u32 s4, s44, s81
    s_addc_u32 s5, s45, 0
    s_waitcnt lgkmcnt(6)
    v_mfma_f32_32x32x16_bf16 v[64:79], a[96:99], v[144:147], v[64:79]
    ds_read_b128 a[108:111], v13 offset:24576
    ds_read_b64_tr_b16 v[156:157], v20 offset:35456
    ds_read_b64_tr_b16 v[158:159], v20 offset:35616
    buffer_load_dwordx4 v2, s[4:7], 0 offen nt lds
    buffer_load_dwordx4 v7, s[4:7], 0 offen offset:1024 nt lds
    s_add_u32 m0, s75, 100224
    s_nop 0
    s_waitcnt lgkmcnt(6)
    v_mfma_f32_32x32x16_bf16 v[64:79], a[100:103], v[148:151], v[64:79]
    ds_read_b128 a[112:115], v10 offset:26624
    ds_read_b64_tr_b16 v[144:145], v20 offset:40960
    ds_read_b64_tr_b16 v[146:147], v20 offset:41120
    buffer_load_dwordx4 v2, s[4:7], 0 offen offset:128 nt lds
    s_waitcnt lgkmcnt(6)
    v_mfma_f32_32x32x16_bf16 v[64:79], a[104:107], v[152:155], v[64:79]
    ds_read_b128 a[116:119], v11 offset:26624
    ds_read_b64_tr_b16 v[148:149], v20 offset:41600
    ds_read_b64_tr_b16 v[150:151], v20 offset:41760
    buffer_load_dwordx4 v7, s[4:7], 0 offen offset:1152 nt lds
    s_add_u32 m0, s75, 102400
    s_mul_i32 s81, s74, 2560
    s_waitcnt lgkmcnt(6)
    v_mfma_f32_32x32x16_bf16 v[64:79], a[108:111], v[156:159], v[64:79]
    ds_read_b128 a[120:123], v12 offset:26624
    ds_read_b64_tr_b16 v[152:153], v20 offset:47104
    ds_read_b64_tr_b16 v[154:155], v20 offset:47264
    s_add_u32 s12, s48, s81
    s_addc_u32 s13, s49, 0
    buffer_load_dwordx4 v8, s[12:15], 0 offen lds
    s_waitcnt lgkmcnt(6)
    v_mfma_f32_32x32x16_bf16 v[64:79], a[112:115], v[144:147], v[64:79]
    ds_read_b128 a[124:127], v13 offset:26624
    ds_read_b64_tr_b16 v[156:157], v20 offset:47744
    ds_read_b64_tr_b16 v[158:159], v20 offset:47904
    buffer_load_dwordx4 v9, s[12:15], 0 offen offset:1024 lds
    s_add_u32 s74, s74, 2
    s_cmp_eq_u32 s74, 10
    s_cselect_b32 s74, 0, s74
    s_waitcnt lgkmcnt(6)
    v_mfma_f32_32x32x16_bf16 v[64:79], a[116:119], v[148:151], v[64:79]
    s_waitcnt vmcnt(12)
    s_barrier
    ds_read_b128 a[128:131], v10 offset:49152
    ds_read_b64_tr_b16 v[144:145], v20 offset:53248
    ds_read_b64_tr_b16 v[146:147], v20 offset:53408
    s_add_u32 m0, s75, 0
    s_waitcnt lgkmcnt(6)
    v_mfma_f32_32x32x16_bf16 v[64:79], a[120:123], v[152:155], v[64:79]
    ds_read_b128 a[132:135], v11 offset:49152
    ds_read_b64_tr_b16 v[148:149], v20 offset:53888
    ds_read_b64_tr_b16 v[150:151], v20 offset:54048
    s_mul_i32 s81, s74, 81920
    s_add_u32 s8, s46, s81
    s_addc_u32 s9, s47, 0
    s_waitcnt lgkmcnt(6)
    v_mfma_f32_32x32x16_bf16 v[64:79], a[124:127], v[156:159], v[64:79]
    ds_read_b128 a[136:139], v12 offset:49152
    ds_read_b64_tr_b16 v[152:153], v20 offset:59392
    ds_read_b64_tr_b16 v[154:155], v20 offset:59552
    buffer_load_dwordx4 v80, s[8:11], 0 offen lds
    s_waitcnt lgkmcnt(6)
    v_mfma_f32_32x32x16_bf16 v[64:79], a[128:131], v[144:147], v[64:79]
    ds_read_b128 a[140:143], v13 offset:49152
    ds_read_b64_tr_b16 v[156:157], v20 offset:60032
    ds_read_b64_tr_b16 v[158:159], v20 offset:60192
    buffer_load_dwordx4 v81, s[8:11], 0 offen offset:1024 lds
    s_waitcnt lgkmcnt(6)
    v_mfma_f32_32x32x16_bf16 v[64:79], a[132:135], v[148:151], v[64:79]
    ds_read_b128 a[144:147], v10 offset:51200
    ds_read_b64_tr_b16 v[144:145], v21 offset:8192
    ds_read_b64_tr_b16 v[146:147], v21 offset:8352
    buffer_load_dwordx4 v82, s[8:11], 0 offen offset:2048 lds
    s_waitcnt lgkmcnt(6)
    v_mfma_f32_32x32x16_bf16 v[64:79], a[136:139], v[152:155], v[64:79]
    ds_read_b128 a[148:151], v11 offset:51200
    ds_read_b64_tr_b16 v[148:149], v21 offset:8832
    ds_read_b64_tr_b16 v[150:151], v21 offset:8992
    s_waitcnt lgkmcnt(6)
    v_mfma_f32_32x32x16_bf16 v[64:79], a[140:143], v[156:159], v[64:79]
    ds_read_b128 a[152:155], v12 offset:51200
    ds_read_b64_tr_b16 v[152:153], v21 offset:14336
    ds_read_b64_tr_b16 v[154:155], v21 offset:14496
    buffer_load_dwordx4 v83, s[8:11], 0 offen offset:3072 lds
    s_add_u32 m0, s75, 4096
    s_add_u32 s74, s74, 2
    s_waitcnt lgkmcnt(6)
    v_mfma_f32_32x32x16_bf16 v[64:79], a[144:147], v[144:147], v[64:79]
    ds_read_b128 a[156:159], v13 offset:51200
    ds_read_b64_tr_b16 v[156:157], v21 offset:14976
    ds_read_b64_tr_b16 v[158:159], v21 offset:15136
    buffer_load_dwordx4 v84, s[8:11], 0 offen lds
    s_cmp_eq_u32 s74, 10
    s_cselect_b32 s74, 0, s74
    s_waitcnt lgkmcnt(6)
    v_mfma_f32_32x32x16_bf16 v[64:79], a[148:151], v[148:151], v[64:79]
    s_waitcnt vmcnt(11)
    s_barrier
    ds_read_b128 a[160:163], v14 offset:16384
    ds_read_b64_tr_b16 v[144:145], v21 offset:20480
    ds_read_b64_tr_b16 v[146:147], v21 offset:20640
    s_add_u32 m0, s75, 24576
    s_waitcnt lgkmcnt(6)
    v_mfma_f32_32x32x16_bf16 v[64:79], a[152:155], v[152:155], v[64:79]
    ds_read_b128 a[164:167], v15 offset:16384
    ds_read_b64_tr_b16 v[148:149], v21 offset:21120
    ds_read_b64_tr_b16 v[150:151], v21 offset:21280
    s_mul_i32 s81, s74, 81920
    s_add_u32 s8, s46, s81
    s_addc_u32 s9, s47, 0
    s_waitcnt lgkmcnt(6)
    v_mfma_f32_32x32x16_bf16 v[64:79], a[156:159], v[156:159], v[64:79]
    ds_read_b128 a[168:171], v16 offset:16384
    ds_read_b64_tr_b16 v[152:153], v21 offset:26624
    ds_read_b64_tr_b16 v[154:155], v21 offset:26784
    buffer_load_dwordx4 v80, s[8:11], 0 offen lds
    s_waitcnt lgkmcnt(6)
    v_mfma_f32_32x32x16_bf16 v[64:79], a[160:163], v[144:147], v[64:79]
    ds_read_b128 a[172:175], v17 offset:16384
    ds_read_b64_tr_b16 v[156:157], v21 offset:27264
    ds_read_b64_tr_b16 v[158:159], v21 offset:27424
    buffer_load_dwordx4 v81, s[8:11], 0 offen offset:1024 lds
    s_waitcnt lgkmcnt(6)
    v_mfma_f32_32x32x16_bf16 v[64:79], a[164:167], v[148:151], v[64:79]
    ds_read_b128 a[176:179], v14 offset:18432
    ds_read_b64_tr_b16 v[144:145], v21 offset:32768
    ds_read_b64_tr_b16 v[146:147], v21 offset:32928
    buffer_load_dwordx4 v82, s[8:11], 0 offen offset:2048 lds
    s_waitcnt lgkmcnt(6)
    v_mfma_f32_32x32x16_bf16 v[64:79], a[168:171], v[152:155], v[64:79]
    ds_read_b128 a[180:183], v15 offset:18432
    ds_read_b64_tr_b16 v[148:149], v21 offset:33408
    ds_read_b64_tr_b16 v[150:151], v21 offset:33568
    s_waitcnt lgkmcnt(6)
    v_mfma_f32_32x32x16_bf16 v[64:79], a[172:175], v[156:159], v[64:79]
    ds_read_b128 a[184:187], v16 offset:18432
    ds_read_b64_tr_b16 v[152:153], v21 offset:38912
    ds_read_b64_tr_b16 v[154:155], v21 offset:39072
    buffer_load_dwordx4 v83, s[8:11], 0 offen offset:3072 lds
    s_add_u32 m0, s75, 28672
    s_add_u32 s74, s74, 2
    s_waitcnt lgkmcnt(6)
    v_mfma_f32_32x32x16_bf16 v[64:79], a[176:179], v[144:147], v[64:79]
    ds_read_b128 a[188:191], v17 offset:18432
    ds_read_b64_tr_b16 v[156:157], v21 offset:39552
    ds_read_b64_tr_b16 v[158:159], v21 offset:39712
    buffer_load_dwordx4 v84, s[8:11], 0 offen lds
    s_cmp_eq_u32 s74, 10
    s_cselect_b32 s74, 0, s74
    s_waitcnt lgkmcnt(6)
    v_mfma_f32_32x32x16_bf16 v[64:79], a[180:183], v[148:151], v[64:79]
    s_waitcnt vmcnt(10)
    s_barrier
    ds_read_b128 a[192:195], v14 offset:40960
    ds_read_b64_tr_b16 v[144:145], v21 offset:45056
    ds_read_b64_tr_b16 v[146:147], v21 offset:45216
    s_add_u32 m0, s75, 49152
    s_waitcnt lgkmcnt(6)
    v_mfma_f32_32x32x16_bf16 v[64:79], a[184:187], v[152:155], v[64:79]
    ds_read_b128 a[196:199], v15 offset:40960
    ds_read_b64_tr_b16 v[148:149], v21 offset:45696
    ds_read_b64_tr_b16 v[150:151], v21 offset:45856
    s_mul_i32 s81, s74, 81920
    s_add_u32 s8, s46, s81
    s_addc_u32 s9, s47, 0
    s_waitcnt lgkmcnt(6)
    v_mfma_f32_32x32x16_bf16 v[64:79], a[188:191], v[156:159], v[64:79]
    ds_read_b128 a[200:203], v16 offset:40960
    ds_read_b64_tr_b16 v[152:153], v21 offset:51200
    ds_read_b64_tr_b16 v[154:155], v21 offset:51360
    s_waitcnt lgkmcnt(6)
    v_mfma_f32_32x32x16_bf16 v[64:79], a[192:195], v[144:147], v[64:79]
    ds_read_b128 a[204:207], v17 offset:40960
    ds_read_b64_tr_b16 v[156:157], v21 offset:51840
    ds_read_b64_tr_b16 v[158:159], v21 offset:52000
    buffer_load_dwordx4 v80, s[8:11], 0 offen lds
    s_waitcnt lgkmcnt(6)
    v_mfma_f32_32x32x16_bf16 v[64:79], a[196:199], v[148:151], v[64:79]
    ds_read_b128 a[208:211], v14 offset:43008
    ds_read_b64_tr_b16 v[144:145], v21 offset:57344
    ds_read_b64_tr_b16 v[146:147], v21 offset:57504
    buffer_load_dwordx4 v81, s[8:11], 0 offen offset:1024 lds
    s_waitcnt lgkmcnt(6)
    v_mfma_f32_32x32x16_bf16 v[64:79], a[200:203], v[152:155], v[64:79]
    ds_read_b128 a[212:215], v15 offset:43008
    ds_read_b64_tr_b16 v[148:149], v21 offset:57984
    ds_read_b64_tr_b16 v[150:151], v21 offset:58144
    buffer_load_dwordx4 v82, s[8:11], 0 offen offset:2048 lds
    s_waitcnt lgkmcnt(6)
    v_mfma_f32_32x32x16_bf16 v[64:79], a[204:207], v[156:159], v[64:79]
    ds_read_b128 a[216:219], v16 offset:43008
    ds_read_b64_tr_b16 v[152:153], v21 offset:63488
    ds_read_b64_tr_b16 v[154:155], v21 offset:63648
    s_waitcnt lgkmcnt(6)
    v_mfma_f32_32x32x16_bf16 v[64:79], a[208:211], v[144:147], v[64:79]
    ds_read_b128 a[220:223], v17 offset:43008
    ds_read_b64_tr_b16 v[156:157], v21 offset:64128
    ds_read_b64_tr_b16 v[158:159], v21 offset:64288
    buffer_load_dwordx4 v83, s[8:11], 0 offen offset:3072 lds
    s_add_u32 m0, s75, 53248
    s_add_u32 s74, s74, 2
    s_waitcnt lgkmcnt(6)
    v_mfma_f32_32x32x16_bf16 v[64:79], a[212:215], v[148:151], v[64:79]
    buffer_load_dwordx4 v84, s[8:11], 0 offen lds
    s_cmp_eq_u32 s74, 10
    s_cselect_b32 s74, 0, s74
    s_waitcnt lgkmcnt(3)
    v_mfma_f32_32x32x16_bf16 v[64:79], a[216:219], v[152:155], v[64:79]
    s_waitcnt vmcnt(10)
    s_barrier
    ds_read_b64_tr_b16 v[108:109], v18 offset:0
    ds_read_b64_tr_b16 v[110:111], v18 offset:640
    ds_read_b64_tr_b16 v[112:113], v18 offset:40
    ds_read_b64_tr_b16 v[114:115], v18 offset:680
    buffer_load_dword v209, v210, s[16:19], 0 offen
    s_waitcnt lgkmcnt(4)
    v_mfma_f32_32x32x16_bf16 v[64:79], a[220:223], v[156:159], v[64:79]
    ds_read_b64_tr_b16 v[120:121], v18 offset:2560
    ds_read_b64_tr_b16 v[122:123], v18 offset:3200
    ds_read_b64_tr_b16 v[124:125], v18 offset:2600
    ds_read_b64_tr_b16 v[126:127], v18 offset:3240
    s_add_u32 m0, s75, 73728
    s_mul_i32 s81, s74, 81920
    s_add_u32 s8, s46, s81
    s_addc_u32 s9, s47, 0
    s_nop 7
    v_cvt_pk_bf16_f32 v64, v64, v65
    v_cvt_pk_bf16_f32 v65, v66, v67
    v_cvt_pk_bf16_f32 v66, v68, v69
    v_cvt_pk_bf16_f32 v67, v70, v71
    v_and_or_b32 v64, v64, v138, v139
    v_and_or_b32 v65, v65, v138, v139
    v_and_or_b32 v66, v66, v138, v139
    v_and_or_b32 v67, v67, v138, v139
    buffer_store_dwordx4 v[64:67], v6, s[20:23], s83 offen offset:1024 sc1
    v_cvt_pk_bf16_f32 v68, v72, v73
    v_cvt_pk_bf16_f32 v69, v74, v75
    v_cvt_pk_bf16_f32 v70, v76, v77
    v_cvt_pk_bf16_f32 v71, v78, v79
    v_and_or_b32 v68, v68, v138, v139
    v_and_or_b32 v69, v69, v138, v139
    v_and_or_b32 v70, v70, v138, v139
    v_and_or_b32 v71, v71, v138, v139
    buffer_store_dwordx4 v[68:71], v6, s[20:23], s83 offen offset:2048 sc1
    s_waitcnt lgkmcnt(4)
    s_branch L_ffn1
L_qpass_3:
    s_waitcnt vmcnt(7) lgkmcnt(0)
    s_barrier
    ds_read_b128 a[64:67], v10 offset:0
    ds_read_b128 a[68:71], v11 offset:0
    ds_read_b128 a[72:75], v12 offset:0
    s_waitcnt lgkmcnt(2)
    ds_read_b128 a[76:79], v13 offset:0
    s_add_u32 m0, s75, 49152
    s_mul_i32 s81, s74, 128
    s_add_u32 s4, s44, s81
    s_addc_u32 s5, s45, 0
    buffer_load_dwordx4 v2, s[4:7], 0 offen nt lds
    buffer_load_dwordx4 v7, s[4:7], 0 offen offset:1024 nt lds
    s_waitcnt lgkmcnt(2)
    ds_read_b128 a[80:83], v10 offset:2048
    s_add_u32 m0, s75, 51072
    s_nop 0
    buffer_load_dwordx4 v2, s[4:7], 0 offen offset:128 nt lds
    buffer_load_dwordx4 v7, s[4:7], 0 offen offset:1152 nt lds
    s_add_u32 m0, s75, 53248
    s_mul_i32 s81, s74, 2560
    s_waitcnt lgkmcnt(2)
    ds_read_b128 a[84:87], v11 offset:2048
    s_add_u32 s12, s48, s81
    s_addc_u32 s13, s49, 0
    buffer_load_dwordx4 v8, s[12:15], 0 offen lds
    buffer_load_dwordx4 v9, s[12:15], 0 offen offset:1024 lds
    s_add_u32 s74, s74, 2
    s_cmp_eq_u32 s74, 10
    s_cselect_b32 s74, 0, s74
    s_waitcnt lgkmcnt(2)
    ds_read_b128 a[88:91], v12 offset:2048
    s_add_u32 m0, s75, 73728
    s_mul_i32 s81, s74, 128
    s_add_u32 s4, s44, s81
    s_addc_u32 s5, s45, 0
    buffer_load_dwordx4 v2, s[4:7], 0 offen nt lds
    buffer_load_dwordx4 v7, s[4:7], 0 offen offset:1024 nt lds
    s_waitcnt lgkmcnt(2)
    ds_read_b128 a[92:95], v13 offset:2048
    s_add_u32 m0, s75, 75648
    s_nop 0
    buffer_load_dwordx4 v2, s[4:7], 0 offen offset:128 nt lds
    buffer_load_dwordx4 v7, s[4:7], 0 offen offset:1152 nt lds
    s_add_u32 m0, s75, 77824
    s_mul_i32 s81, s74, 2560
    s_waitcnt lgkmcnt(2)
    s_waitcnt vmcnt(10)
    s_barrier
    ds_read_b128 a[96:99], v10 offset:24576
    s_add_u32 s12, s48, s81
    s_addc_u32 s13, s49, 0
    s_waitcnt lgkmcnt(2)
    ds_read_b128 a[100:103], v11 offset:24576
    buffer_load_dwordx4 v8, s[12:15], 0 offen lds
    buffer_load_dwordx4 v9, s[12:15], 0 offen offset:1024 lds
    s_add_u32 s74, s74, 2
    s_cmp_eq_u32 s74, 10
    s_cselect_b32 s74, 0, s74
    s_add_u32 m0, s75, 98304
    s_waitcnt lgkmcnt(2)
    ds_read_b128 a[104:107], v12 offset:24576
    s_mul_i32 s81, s74, 128
    s_add_u32 s4, s44, s81
    s_addc_u32 s5, s45, 0
    s_waitcnt lgkmcnt(2)
    ds_read_b128 a[108:111], v13 offset:24576
    buffer_load_dwordx4 v2, s[4:7], 0 offen nt lds
    buffer_load_dwordx4 v7, s[4:7], 0 offen offset:1024 nt lds
    s_add_u32 m0, s75, 100224
    s_nop 0
    s_waitcnt lgkmcnt(2)
    ds_read_b128 a[112:115], v10 offset:26624
    buffer_load_dwordx4 v2, s[4:7], 0 offen offset:128 nt lds
    s_waitcnt lgkmcnt(2)
    ds_read_b128 a[116:119], v11 offset:26624
    buffer_load_dwordx4 v7, s[4:7], 0 offen offset:1152 nt lds
    s_add_u32 m0, s75, 102400
    s_mul_i32 s81, s74, 2560
    s_waitcnt lgkmcnt(2)
    ds_read_b128 a[120:123], v12 offset:26624
    s_add_u32 s12, s48, s81
    s_addc_u32 s13, s49, 0
    buffer_load_dwordx4 v8, s[12:15], 0 offen lds
    s_waitcnt lgkmcnt(2)
    ds_read_b128 a[124:127], v13 offset:26624
    buffer_load_dwordx4 v9, s[12:15], 0 offen offset:1024 lds
    s_add_u32 s74, s74, 2
    s_cmp_eq_u32 s74, 10
    s_cselect_b32 s74, 0, s74
    s_waitcnt lgkmcnt(2)
    s_waitcnt vmcnt(12)
    s_barrier
    ds_read_b128 a[128:131], v10 offset:49152
    s_add_u32 m0, s75, 0
    s_waitcnt lgkmcnt(2)
    ds_read_b128 a[132:135], v11 offset:49152
    s_mul_i32 s81, s74, 81920
    s_add_u32 s8, s46, s81
    s_addc_u32 s9, s47, 0
    s_waitcnt lgkmcnt(2)
    ds_read_b128 a[136:139], v12 offset:49152
    buffer_load_dwordx4 v80, s[8:11], 0 offen lds
    s_waitcnt lgkmcnt(2)
    ds_read_b128 a[140:143], v13 offset:49152
    buffer_load_dwordx4 v81, s[8:11], 0 offen offset:1024 lds
    s_waitcnt lgkmcnt(2)
    ds_read_b128 a[144:147], v10 offset:51200
    buffer_load_dwordx4 v82, s[8:11], 0 offen offset:2048 lds
    s_waitcnt lgkmcnt(2)
    ds_read_b128 a[148:151], v11 offset:51200
    s_waitcnt lgkmcnt(2)
    ds_read_b128 a[152:155], v12 offset:51200
    buffer_load_dwordx4 v83, s[8:11], 0 offen offset:3072 lds
    s_add_u32 m0, s75, 4096
    s_add_u32 s74, s74, 2
    s_waitcnt lgkmcnt(2)
    ds_read_b128 a[156:159], v13 offset:51200
    buffer_load_dwordx4 v84, s[8:11], 0 offen lds
    s_cmp_eq_u32 s74, 10
    s_cselect_b32 s74, 0, s74
    s_waitcnt lgkmcnt(2)
    s_waitcnt vmcnt(11)
    s_barrier
    ds_read_b128 a[160:163], v14 offset:16384
    s_add_u32 m0, s75, 24576
    s_waitcnt lgkmcnt(2)
    ds_read_b128 a[164:167], v15 offset:16384
    s_mul_i32 s81, s74, 81920
    s_add_u32 s8, s46, s81
    s_addc_u32 s9, s47, 0
    s_waitcnt lgkmcnt(2)
    ds_read_b128 a[168:171], v16 offset:16384
    buffer_load_dwordx4 v80, s[8:11], 0 offen lds
    s_waitcnt lgkmcnt(2)
    ds_read_b128 a[172:175], v17 offset:16384
    buffer_load_dwordx4 v81, s[8:11], 0 offen offset:1024 lds
    s_waitcnt lgkmcnt(2)
    ds_read_b128 a[176:179], v14 offset:18432
    buffer_load_dwordx4 v82, s[8:11], 0 offen offset:2048 lds
    s_waitcnt lgkmcnt(2)
    ds_read_b128 a[180:183], v15 offset:18432
    s_waitcnt lgkmcnt(2)
    ds_read_b128 a[184:187], v16 offset:18432
    buffer_load_dwordx4 v83, s[8:11], 0 offen offset:3072 lds
    s_add_u32 m0, s75, 28672
    s_add_u32 s74, s74, 2
    s_waitcnt lgkmcnt(2)
    ds_read_b128 a[188:191], v17 offset:18432
    buffer_load_dwordx4 v84, s[8:11], 0 offen lds
    s_cmp_eq_u32 s74, 10
    s_cselect_b32 s74, 0, s74
    s_waitcnt lgkmcnt(2)
    s_waitcnt vmcnt(10)
    s_barrier
    ds_read_b128 a[192:195], v14 offset:40960
    s_add_u32 m0, s75, 49152
    s_waitcnt lgkmcnt(2)
    ds_read_b128 a[196:199], v15 offset:40960
    s_mul_i32 s81, s74, 81920
    s_add_u32 s8, s46, s81
    s_addc_u32 s9, s47, 0
    s_waitcnt lgkmcnt(2)
    ds_read_b128 a[200:203], v16 offset:40960
    s_waitcnt lgkmcnt(2)
    ds_read_b128 a[204:207], v17 offset:40960
    buffer_load_dwordx4 v80, s[8:11], 0 offen lds
    s_waitcnt lgkmcnt(2)
    ds_read_b128 a[208:211], v14 offset:43008
    buffer_load_dwordx4 v81, s[8:11], 0 offen offset:1024 lds
    s_waitcnt lgkmcnt(2)
    ds_read_b128 a[212:215], v15 offset:43008
    buffer_load_dwordx4 v82, s[8:11], 0 offen offset:2048 lds
    s_waitcnt lgkmcnt(2)
    ds_read_b128 a[216:219], v16 offset:43008
    s_waitcnt lgkmcnt(2)
    ds_read_b128 a[220:223], v17 offset:43008
    buffer_load_dwordx4 v83, s[8:11], 0 offen offset:3072 lds
    s_add_u32 m0, s75, 53248
    s_add_u32 s74, s74, 2
    s_waitcnt lgkmcnt(2)
    buffer_load_dwordx4 v84, s[8:11], 0 offen lds
    s_cmp_eq_u32 s74, 10
    s_cselect_b32 s74, 0, s74
    s_waitcnt lgkmcnt(1)
    s_waitcnt vmcnt(10)
    s_barrier
    ds_read_b64_tr_b16 v[108:109], v18 offset:0
    ds_read_b64_tr_b16 v[110:111], v18 offset:640
    ds_read_b64_tr_b16 v[112:113], v18 offset:40
    ds_read_b64_tr_b16 v[114:115], v18 offset:680
    buffer_load_dword v209, v210, s[16:19], 0 offen
    s_waitcnt lgkmcnt(4)
    ds_read_b64_tr_b16 v[120:121], v18 offset:2560
    ds_read_b64_tr_b16 v[122:123], v18 offset:3200
    ds_read_b64_tr_b16 v[124:125], v18 offset:2600
    ds_read_b64_tr_b16 v[126:127], v18 offset:3240
    s_add_u32 m0, s75, 73728
    s_mul_i32 s81, s74, 81920
    s_add_u32 s8, s46, s81
    s_addc_u32 s9, s47, 0
    s_waitcnt lgkmcnt(4)
L_ffn1:
L_pad1:
    s_cbranch_execz L_pad5
    v_mfma_f32_32x32x16_bf16 v[32:47], v[108:111], a[64:67], 0
    ds_read_b64_tr_b16 v[96:97], v18 offset:6144
    ds_read_b64_tr_b16 v[98:99], v18 offset:6784
    buffer_load_dwordx4 v80, s[8:11], 0 offen lds
    s_mov_b32 s24, s64
    s_mov_b32 s25, s65
    v_mfma_f32_32x32x16_bf16 v[48:63], v[112:115], a[64:67], 0
    ds_read_b64_tr_b16 v[100:101], v18 offset:6184
    ds_read_b64_tr_b16 v[102:103], v18 offset:6824
    s_mov_b32 s26, 256
    s_mov_b32 s27, 0x20000
    s_waitcnt lgkmcnt(4)
    v_mfma_f32_32x32x16_bf16 v[32:47], v[120:123], a[68:71], v[32:47]
    ds_read_b64_tr_b16 v[108:109], v18 offset:8704
    ds_read_b64_tr_b16 v[110:111], v18 offset:9344
    buffer_load_dwordx4 v81, s[8:11], 0 offen offset:1024 lds
    s_movk_i32 s97, 3072
    s_mul_i32 s96, s70, 49152
    v_mfma_f32_32x32x16_bf16 v[48:63], v[124:127], a[68:71], v[48:63]
    ds_read_b64_tr_b16 v[112:113], v18 offset:8744
    ds_read_b64_tr_b16 v[114:115], v18 offset:9384
    s_mul_i32 s99, s69, 384
    s_add_u32 s96, s96, s99
L_pad2:
    s_cbranch_execz L_pad6
    s_waitcnt lgkmcnt(4)
    v_mfma_f32_32x32x16_bf16 v[32:47], v[96:99], a[72:75], v[32:47]
    ds_read_b64_tr_b16 v[120:121], v18 offset:12288
    ds_read_b64_tr_b16 v[122:123], v18 offset:12928
    buffer_load_dwordx4 v82, s[8:11], 0 offen offset:2048 lds
    v_add_u32 v30, 0, v1
    v_mul_u32_u24 v31, 0xab, v30
    v_mfma_f32_32x32x16_bf16 v[48:63], v[100:103], a[72:75], v[48:63]
    ds_read_b64_tr_b16 v[124:125], v18 offset:12328
    ds_read_b64_tr_b16 v[126:127], v18 offset:12968
    v_lshrrev_b32 v31, 12, v31
    v_mul_u32_u24 v244, 24, v31
    s_waitcnt lgkmcnt(4)
    v_mfma_f32_32x32x16_bf16 v[32:47], v[108:111], a[76:79], v[32:47]
    ds_read_b64_tr_b16 v[96:97], v18 offset:14848
    ds_read_b64_tr_b16 v[98:99], v18 offset:15488
    buffer_load_dwordx4 v83, s[8:11], 0 offen offset:3072 lds
    s_add_u32 m0, s75, 77824
    s_add_u32 s74, s74, 2
    v_mfma_f32_32x32x16_bf16 v[48:63], v[112:115], a[76:79], v[48:63]
    ds_read_b64_tr_b16 v[100:101], v18 offset:14888
    ds_read_b64_tr_b16 v[102:103], v18 offset:15528
    v_sub_u32 v30, v30, v244
    v_lshlrev_b32 v244, 1, v31
    s_waitcnt lgkmcnt(4)
    v_mfma_f32_32x32x16_bf16 v[32:47], v[120:123], a[80:83], v[32:47]
    ds_read_b64_tr_b16 v[108:109], v18 offset:18432
    ds_read_b64_tr_b16 v[110:111], v18 offset:19072
    v_and_b32 v244, 4, v244
    v_xor_b32 v30, v30, v244
    v_lshl_add_u32 v30, v30, 4, s96
    v_mfma_f32_32x32x16_bf16 v[48:63], v[124:127], a[80:83], v[48:63]
    ds_read_b64_tr_b16 v[112:113], v18 offset:18472
    ds_read_b64_tr_b16 v[114:115], v18 offset:19112
    buffer_load_dwordx4 v84, s[8:11], 0 offen lds
    s_cmp_eq_u32 s74, 10
    s_cselect_b32 s74, 0, s74
    s_waitcnt lgkmcnt(4)
    v_mfma_f32_32x32x16_bf16 v[32:47], v[96:99], a[84:87], v[32:47]
    ds_read_b64_tr_b16 v[120:121], v18 offset:20992
    ds_read_b64_tr_b16 v[122:123], v18 offset:21632
    v_mad_u32_u24 v132, v31, s97, v30
    v_add_u32 v135, 21504, v132
    v_add_u32 v30, 64, v1
    v_mfma_f32_32x32x16_bf16 v[48:63], v[100:103], a[84:87], v[48:63]
    ds_read_b64_tr_b16 v[124:125], v18 offset:21032
    ds_read_b64_tr_b16 v[126:127], v18 offset:21672
    v_mul_u32_u24 v31, 0xab, v30
    v_lshrrev_b32 v31, 12, v31
    s_waitcnt lgkmcnt(4)
    v_mfma_f32_32x32x16_bf16 v[32:47], v[108:111], a[88:91], v[32:47]
    s_waitcnt vmcnt(11)
    s_barrier
    ds_read_b64_tr_b16 v[96:97], v18 offset:24576
    ds_read_b64_tr_b16 v[98:99], v18 offset:25216
    s_add_u32 m0, s75, 98304
    v_mfma_f32_32x32x16_bf16 v[48:63], v[112:115], a[88:91], v[48:63]
    ds_read_b64_tr_b16 v[100:101], v18 offset:24616
    ds_read_b64_tr_b16 v[102:103], v18 offset:25256
    s_mul_i32 s81, s74, 81920
    s_add_u32 s8, s46, s81
    s_addc_u32 s9, s47, 0
    s_waitcnt lgkmcnt(4)
    v_mfma_f32_32x32x16_bf16 v[32:47], v[120:123], a[92:95], v[32:47]
    ds_read_b64_tr_b16 v[108:109], v18 offset:27136
    ds_read_b64_tr_b16 v[110:111], v18 offset:27776
    buffer_load_dwordx4 v80, s[8:11], 0 offen lds
    v_mul_u32_u24 v244, 24, v31
    v_sub_u32 v30, v30, v244
    v_mfma_f32_32x32x16_bf16 v[48:63], v[124:127], a[92:95], v[48:63]
    ds_read_b64_tr_b16 v[112:113], v18 offset:27176
    ds_read_b64_tr_b16 v[114:115], v18 offset:27816
    v_lshlrev_b32 v244, 1, v31
    v_and_b32 v244, 4, v244
    s_waitcnt lgkmcnt(4)
    v_mfma_f32_32x32x16_bf16 v[32:47], v[96:99], a[96:99], v[32:47]
    ds_read_b64_tr_b16 v[120:121], v18 offset:30720
    ds_read_b64_tr_b16 v[122:123], v18 offset:31360
    buffer_load_dwordx4 v81, s[8:11], 0 offen offset:1024 lds
    v_xor_b32 v30, v30, v244
    v_lshl_add_u32 v30, v30, 4, s96
    v_mfma_f32_32x32x16_bf16 v[48:63], v[100:103], a[96:99], v[48:63]
    ds_read_b64_tr_b16 v[124:125], v18 offset:30760
    ds_read_b64_tr_b16 v[126:127], v18 offset:31400
    v_mad_u32_u24 v133, v31, s97, v30
    v_add_u32 v136, 24576, v133
    s_waitcnt lgkmcnt(4)
    v_mfma_f32_32x32x16_bf16 v[32:47], v[108:111], a[100:103], v[32:47]
    ds_read_b64_tr_b16 v[96:97], v18 offset:33280
    ds_read_b64_tr_b16 v[98:99], v18 offset:33920
    v_subrev_u32 v133, 1024, v133
    v_add_u32 v30, 128, v1
    v_mul_u32_u24 v31, 0xab, v30
    v_mfma_f32_32x32x16_bf16 v[48:63], v[112:115], a[100:103], v[48:63]
    ds_read_b64_tr_b16 v[100:101], v18 offset:33320
    ds_read_b64_tr_b16 v[102:103], v18 offset:33960
    buffer_load_dwordx4 v82, s[8:11], 0 offen offset:2048 lds
    v_lshrrev_b32 v31, 12, v31
    s_waitcnt lgkmcnt(4)
    v_mfma_f32_32x32x16_bf16 v[32:47], v[120:123], a[104:107], v[32:47]
    ds_read_b64_tr_b16 v[108:109], v18 offset:36864
    ds_read_b64_tr_b16 v[110:111], v18 offset:37504
    v_mul_u32_u24 v244, 24, v31
    v_sub_u32 v30, v30, v244
    v_lshlrev_b32 v244, 1, v31
    v_mfma_f32_32x32x16_bf16 v[48:63], v[124:127], a[104:107], v[48:63]
    ds_read_b64_tr_b16 v[112:113], v18 offset:36904
    ds_read_b64_tr_b16 v[114:115], v18 offset:37544
    v_and_b32 v244, 4, v244
    v_xor_b32 v30, v30, v244
    s_waitcnt lgkmcnt(4)
    v_mfma_f32_32x32x16_bf16 v[32:47], v[96:99], a[108:111], v[32:47]
    ds_read_b64_tr_b16 v[120:121], v18 offset:39424
    ds_read_b64_tr_b16 v[122:123], v18 offset:40064
    buffer_load_dwordx4 v83, s[8:11], 0 offen offset:3072 lds
    s_add_u32 m0, s75, 102400
    s_add_u32 s74, s74, 2
    v_mfma_f32_32x32x16_bf16 v[48:63], v[100:103], a[108:111], v[48:63]
    ds_read_b64_tr_b16 v[124:125], v18 offset:39464
    ds_read_b64_tr_b16 v[126:127], v18 offset:40104
    v_lshl_add_u32 v30, v30, 4, s96
    v_mad_u32_u24 v134, v31, s97, v30
    s_waitcnt lgkmcnt(4)
    v_mfma_f32_32x32x16_bf16 v[32:47], v[108:111], a[112:115], v[32:47]
    ds_read_b64_tr_b16 v[96:97], v18 offset:43008
    ds_read_b64_tr_b16 v[98:99], v18 offset:43648
    v_add_u32 v137, 23552, v134
    v_subrev_u32 v134, 2048, v134
    v_bfe_u32 v31, v1, 3, 1
    v_mfma_f32_32x32x16_bf16 v[48:63], v[112:115], a[112:115], v[48:63]
    ds_read_b64_tr_b16 v[100:101], v18 offset:43048
    ds_read_b64_tr_b16 v[102:103], v18 offset:43688
    buffer_load_dwordx4 v84, s[8:11], 0 offen lds
    s_cmp_eq_u32 s74, 10
    s_cselect_b32 s74, 0, s74
    s_waitcnt lgkmcnt(4)
    v_mfma_f32_32x32x16_bf16 v[32:47], v[120:123], a[116:119], v[32:47]
    ds_read_b64_tr_b16 v[108:109], v18 offset:45568
    ds_read_b64_tr_b16 v[110:111], v18 offset:46208
    s_mul_i32 s96, s72, 3
    s_add_u32 s97, s96, 0
    v_xor_b32 v30, s97, v31
    v_mfma_f32_32x32x16_bf16 v[48:63], v[124:127], a[116:119], v[48:63]
    ds_read_b64_tr_b16 v[112:113], v18 offset:45608
    ds_read_b64_tr_b16 v[114:115], v18 offset:46248
    v_lshl_add_u32 v22, v30, 6, v29
    v_add_u32 v25, 57344, v22
    s_waitcnt lgkmcnt(4)
    v_mfma_f32_32x32x16_bf16 v[32:47], v[96:99], a[120:123], v[32:47]
    s_waitcnt vmcnt(11)
    s_barrier
    ds_read_b64_tr_b16 v[120:121], v18 offset:49152
    ds_read_b64_tr_b16 v[122:123], v18 offset:49792
    s_add_u32 m0, s75, 0
    v_mfma_f32_32x32x16_bf16 v[48:63], v[100:103], a[120:123], v[48:63]
    ds_read_b64_tr_b16 v[124:125], v18 offset:49192
    ds_read_b64_tr_b16 v[126:127], v18 offset:49832
    s_mul_i32 s81, s74, 196608
    s_add_u32 s16, s56, s81
    s_addc_u32 s17, s57, 0
    s_waitcnt lgkmcnt(4)
    v_mfma_f32_32x32x16_bf16 v[32:47], v[108:111], a[124:127], v[32:47]
    ds_read_b64_tr_b16 v[96:97], v18 offset:51712
    ds_read_b64_tr_b16 v[98:99], v18 offset:52352
    buffer_load_dwordx4 v132, s[16:19], 0 offen lds
    s_add_u32 s97, s96, 1
    v_xor_b32 v30, s97, v31
    v_mfma_f32_32x32x16_bf16 v[48:63], v[112:115], a[124:127], v[48:63]
    ds_read_b64_tr_b16 v[100:101], v18 offset:51752
    ds_read_b64_tr_b16 v[102:103], v18 offset:52392
    v_lshl_add_u32 v23, v30, 6, v29
    v_add_u32 v26, 57344, v23
    s_waitcnt lgkmcnt(4)
    v_mfma_f32_32x32x16_bf16 v[32:47], v[120:123], a[128:131], v[32:47]
    ds_read_b64_tr_b16 v[108:109], v18 offset:55296
    ds_read_b64_tr_b16 v[110:111], v18 offset:55936
    buffer_load_dwordx4 v133, s[16:19], 0 offen offset:1024 lds
    s_add_u32 s97, s96, 2
    v_xor_b32 v30, s97, v31
    v_mfma_f32_32x32x16_bf16 v[48:63], v[124:127], a[128:131], v[48:63]
    ds_read_b64_tr_b16 v[112:113], v18 offset:55336
    ds_read_b64_tr_b16 v[114:115], v18 offset:55976
    v_lshl_add_u32 v24, v30, 6, v29
    v_add_u32 v27, 57344, v24
    s_waitcnt lgkmcnt(4)
    v_mfma_f32_32x32x16_bf16 v[32:47], v[96:99], a[132:135], v[32:47]
    ds_read_b64_tr_b16 v[120:121], v18 offset:57856
    ds_read_b64_tr_b16 v[122:123], v18 offset:58496
    buffer_load_dwordx4 v134, s[16:19], 0 offen offset:2048 lds
    s_mul_i32 s96, s70, 6144
    s_add_u32 s96, s96, 125952
    v_mfma_f32_32x32x16_bf16 v[48:63], v[100:103], a[132:135], v[48:63]
    ds_read_b64_tr_b16 v[124:125], v18 offset:57896
    ds_read_b64_tr_b16 v[126:127], v18 offset:58536
    v_add_u32 v238, s96, v6
    s_xor_b32 s97, s70, 2
    s_waitcnt lgkmcnt(4)
    v_mfma_f32_32x32x16_bf16 v[32:47], v[108:111], a[136:139], v[32:47]
    ds_read_b64_tr_b16 v[96:97], v18 offset:61440
    ds_read_b64_tr_b16 v[98:99], v18 offset:62080
    buffer_load_dwordx4 v135, s[16:19], 0 offen offset:3072 lds
    s_add_u32 m0, s75, 4096
    s_add_u32 s74, s74, 1
    v_mfma_f32_32x32x16_bf16 v[48:63], v[112:115], a[136:139], v[48:63]
    ds_read_b64_tr_b16 v[100:101], v18 offset:61480
    ds_read_b64_tr_b16 v[102:103], v18 offset:62120
    s_mul_i32 s96, s97, 6144
    s_add_u32 s96, s96, 125952
    s_waitcnt lgkmcnt(4)
    v_mfma_f32_32x32x16_bf16 v[32:47], v[120:123], a[140:143], v[32:47]
    ds_read_b64_tr_b16 v[108:109], v18 offset:64000
    ds_read_b64_tr_b16 v[110:111], v18 offset:64640
    buffer_load_dwordx4 v136, s[16:19], 0 offen lds
    v_add_u32 v239, s96, v6
    v_lshlrev_b32 v244, 2, v1
    v_mfma_f32_32x32x16_bf16 v[48:63], v[124:127], a[140:143], v[48:63]
    ds_read_b64_tr_b16 v[112:113], v18 offset:64040
    ds_read_b64_tr_b16 v[114:115], v18 offset:64680
    s_mul_i32 s96, s71, 128
    s_add_u32 s96, s96, 125440
    s_waitcnt lgkmcnt(4)
    v_mfma_f32_32x32x16_bf16 v[32:47], v[96:99], a[144:147], v[32:47]
    ds_read_b64_tr_b16 v[120:121], v19 offset:10240
    ds_read_b64_tr_b16 v[122:123], v19 offset:10880
    s_cmp_eq_u32 s72, 0
    s_cselect_b32 s96, s96, 125824
    v_and_b32 v9, 31, v1
    v_mfma_f32_32x32x16_bf16 v[48:63], v[100:103], a[144:147], v[48:63]
    ds_read_b64_tr_b16 v[124:125], v19 offset:10280
    ds_read_b64_tr_b16 v[126:127], v19 offset:10920
    buffer_load_dwordx4 v137, s[16:19], 0 offen offset:1024 lds
    s_cmp_eq_u32 s74, 10
    s_cselect_b32 s74, 0, s74
    s_waitcnt lgkmcnt(4)
    v_mfma_f32_32x32x16_bf16 v[32:47], v[108:111], a[148:151], v[32:47]
    ds_read_b64_tr_b16 v[96:97], v19 offset:12800
    ds_read_b64_tr_b16 v[98:99], v19 offset:13440
    v_lshl_add_u32 v9, v9, 2, s96
    v_mov_b32 v2, 0xdddd
    v_lshlrev_b32 v4, 3, v1
    v_mfma_f32_32x32x16_bf16 v[48:63], v[112:115], a[148:151], v[48:63]
    ds_read_b64_tr_b16 v[100:101], v19 offset:12840
    ds_read_b64_tr_b16 v[102:103], v19 offset:13480
    v_and_b32 v3, 31, v1
    v_min_u32 v3, 21, v3
    s_waitcnt lgkmcnt(4)
    v_mfma_f32_32x32x16_bf16 v[32:47], v[120:123], a[152:155], v[32:47]
    s_waitcnt vmcnt(11)
    s_barrier
    s_add_u32 s84, s73, 1
    s_bitcmp0_b32 s84, 1
    s_cbranch_scc1 L_nosig
    s_lshl_b32 s84, s68, 1
    s_add_u32 s84, s84, s71
    s_lshl_b32 s84, s84, 2
    v_mov_b32 v138, 1
    s_mov_b64 exec, 1
    buffer_atomic_add v138, off, s[24:27], s84 sc1
    s_mov_b64 exec, -1
L_nosig:
    ds_read_b64_tr_b16 v[108:109], v19 offset:16384
    ds_read_b64_tr_b16 v[110:111], v19 offset:17024
    s_add_u32 m0, s75, 24576
    v_mfma_f32_32x32x16_bf16 v[48:63], v[124:127], a[152:155], v[48:63]
    ds_read_b64_tr_b16 v[112:113], v19 offset:16424
    ds_read_b64_tr_b16 v[114:115], v19 offset:17064
    s_mul_i32 s81, s74, 196608
    s_add_u32 s16, s56, s81
    s_addc_u32 s17, s57, 0
    s_waitcnt lgkmcnt(4)
    v_mfma_f32_32x32x16_bf16 v[32:47], v[96:99], a[156:159], v[32:47]
    ds_read_b64_tr_b16 v[120:121], v19 offset:18944
    ds_read_b64_tr_b16 v[122:123], v19 offset:19584
    buffer_load_dwordx4 v132, s[16:19], 0 offen lds
    v_and_or_b32 v3, v1, 32, v3
    v_lshlrev_b32 v3, 4, v3
    v_mfma_f32_32x32x16_bf16 v[48:63], v[100:103], a[156:159], v[48:63]
    ds_read_b64_tr_b16 v[124:125], v19 offset:18984
    ds_read_b64_tr_b16 v[126:127], v19 offset:19624
    s_mul_i32 s83, s68, 8192
    s_mul_i32 s99, s72, 4096
    s_waitcnt lgkmcnt(4)
    v_mfma_f32_32x32x16_bf16 v[32:47], v[108:111], a[160:163], v[32:47]
    ds_read_b64_tr_b16 v[96:97], v19 offset:22528
    ds_read_b64_tr_b16 v[98:99], v19 offset:23168
    buffer_load_dwordx4 v133, s[16:19], 0 offen offset:1024 lds
    s_add_u32 s83, s83, s99
    v_lshrrev_b32 v31, 5, v1
    v_mfma_f32_32x32x16_bf16 v[48:63], v[112:115], a[160:163], v[48:63]
    ds_read_b64_tr_b16 v[100:101], v19 offset:22568
    ds_read_b64_tr_b16 v[102:103], v19 offset:23208
    v_and_b32 v30, 15, v1
    v_lshlrev_b32 v241, 4, v30
    s_waitcnt lgkmcnt(4)
    v_mfma_f32_32x32x16_bf16 v[32:47], v[120:123], a[164:167], v[32:47]
    ds_read_b64_tr_b16 v[108:109], v19 offset:25088
    ds_read_b64_tr_b16 v[110:111], v19 offset:25728
    buffer_load_dwordx4 v134, s[16:19], 0 offen offset:2048 lds
    v_lshl_add_u32 v241, v31, 8, v241
    v_bfe_u32 v31, v1, 4, 1
    v_mfma_f32_32x32x16_bf16 v[48:63], v[124:127], a[164:167], v[48:63]
    ds_read_b64_tr_b16 v[112:113], v19 offset:25128
    ds_read_b64_tr_b16 v[114:115], v19 offset:25768
    v_mul_u32_u24 v236, 49152, v31
    v_add_u32 v236, v236, v241
    s_waitcnt lgkmcnt(4)
    v_mfma_f32_32x32x16_bf16 v[32:47], v[96:99], a[168:171], v[32:47]
    ds_read_b64_tr_b16 v[120:121], v19 offset:28672
    ds_read_b64_tr_b16 v[122:123], v19 offset:29312
    buffer_load_dwordx4 v135, s[16:19], 0 offen offset:3072 lds
    s_add_u32 m0, s75, 28672
    s_add_u32 s74, s74, 1
    v_mfma_f32_32x32x16_bf16 v[48:63], v[100:103], a[168:171], v[48:63]
    ds_read_b64_tr_b16 v[124:125], v19 offset:28712
    ds_read_b64_tr_b16 v[126:127], v19 offset:29352
    v_mul_u32_u24 v237, 20480, v31
    v_add_u32 v237, v237, v241
    s_waitcnt lgkmcnt(4)
    v_mfma_f32_32x32x16_bf16 v[32:47], v[108:111], a[172:175], v[32:47]
    ds_read_b64_tr_b16 v[96:97], v19 offset:31232
    ds_read_b64_tr_b16 v[98:99], v19 offset:31872
    buffer_load_dwordx4 v136, s[16:19], 0 offen lds
    s_mul_i32 s85, s68, 196608
    s_mul_i32 s99, s71, 98304
    v_mfma_f32_32x32x16_bf16 v[48:63], v[112:115], a[172:175], v[48:63]
    ds_read_b64_tr_b16 v[100:101], v19 offset:31272
    ds_read_b64_tr_b16 v[102:103], v19 offset:31912
    s_add_u32 s85, s85, s99
    s_mul_i32 s99, s69, 6144
    s_waitcnt lgkmcnt(4)
    v_mfma_f32_32x32x16_bf16 v[32:47], v[120:123], a[176:179], v[32:47]
    ds_read_b64_tr_b16 v[108:109], v19 offset:34816
    ds_read_b64_tr_b16 v[110:111], v19 offset:35456
    s_add_u32 s85, s85, s99
    s_mul_i32 s99, s72, 3072
    s_add_u32 s85, s85, s99
    v_mfma_f32_32x32x16_bf16 v[48:63], v[124:127], a[176:179], v[48:63]
    ds_read_b64_tr_b16 v[112:113], v19 offset:34856
    ds_read_b64_tr_b16 v[114:115], v19 offset:35496
    buffer_load_dwordx4 v137, s[16:19], 0 offen offset:1024 lds
    s_cmp_eq_u32 s74, 10
    s_cselect_b32 s74, 0, s74
    s_waitcnt lgkmcnt(4)
    v_mfma_f32_32x32x16_bf16 v[32:47], v[96:99], a[180:183], v[32:47]
    ds_read_b64_tr_b16 v[120:121], v19 offset:37376
    ds_read_b64_tr_b16 v[122:123], v19 offset:38016
    s_add_u32 s85, s85, 1048576
    s_mul_i32 s96, s71, 2
    s_add_u32 s96, s96, s72
    v_mfma_f32_32x32x16_bf16 v[48:63], v[100:103], a[180:183], v[48:63]
    ds_read_b64_tr_b16 v[124:125], v19 offset:37416
    ds_read_b64_tr_b16 v[126:127], v19 offset:38056
    s_xor_b32 s97, s96, 1
    s_mul_i32 s99, s96, 49152
    s_waitcnt lgkmcnt(4)
    v_mfma_f32_32x32x16_bf16 v[32:47], v[108:111], a[184:187], v[32:47]
    s_waitcnt vmcnt(12)
    s_barrier
    ds_read_b64_tr_b16 v[96:97], v19 offset:40960
    ds_read_b64_tr_b16 v[98:99], v19 offset:41600
    s_add_u32 m0, s75, 49152
    v_mfma_f32_32x32x16_bf16 v[48:63], v[112:115], a[184:187], v[48:63]
    ds_read_b64_tr_b16 v[100:101], v19 offset:41000
    ds_read_b64_tr_b16 v[102:103], v19 offset:41640
    s_mul_i32 s81, s74, 196608
    s_add_u32 s16, s56, s81
    s_addc_u32 s17, s57, 0
    s_waitcnt lgkmcnt(4)
    v_mfma_f32_32x32x16_bf16 v[32:47], v[120:123], a[188:191], v[32:47]
    ds_read_b64_tr_b16 v[108:109], v19 offset:43520
    ds_read_b64_tr_b16 v[110:111], v19 offset:44160
    buffer_load_dwordx4 v132, s[16:19], 0 offen lds
    v_add_u32 v245, s99, v6
    s_mul_i32 s99, s97, 49152
    v_mfma_f32_32x32x16_bf16 v[48:63], v[124:127], a[188:191], v[48:63]
    ds_read_b64_tr_b16 v[112:113], v19 offset:43560
    ds_read_b64_tr_b16 v[114:115], v19 offset:44200
    v_add_u32 v246, s99, v6
    s_mul_i32 s99, s96, 20480
    s_waitcnt lgkmcnt(4)
    v_mfma_f32_32x32x16_bf16 v[32:47], v[96:99], a[192:195], v[32:47]
    ds_read_b64_tr_b16 v[120:121], v19 offset:47104
    ds_read_b64_tr_b16 v[122:123], v19 offset:47744
    buffer_load_dwordx4 v133, s[16:19], 0 offen offset:1024 lds
    v_add_u32 v247, s99, v6
    s_mul_i32 s99, s97, 20480
    v_mfma_f32_32x32x16_bf16 v[48:63], v[100:103], a[192:195], v[48:63]
    ds_read_b64_tr_b16 v[124:125], v19 offset:47144
    ds_read_b64_tr_b16 v[126:127], v19 offset:47784
    v_add_u32 v248, s99, v6
    v_add_u32 v249, 4096, v6
    s_waitcnt lgkmcnt(4)
    v_mfma_f32_32x32x16_bf16 v[32:47], v[108:111], a[196:199], v[32:47]
    ds_read_b64_tr_b16 v[96:97], v19 offset:49664
    ds_read_b64_tr_b16 v[98:99], v19 offset:50304
    buffer_load_dwordx4 v134, s[16:19], 0 offen offset:2048 lds
    s_mul_i32 s97, s96, 64
    s_add_u32 s97, s97, 125440
    v_mfma_f32_32x32x16_bf16 v[48:63], v[112:115], a[196:199], v[48:63]
    ds_read_b64_tr_b16 v[100:101], v19 offset:49704
    ds_read_b64_tr_b16 v[102:103], v19 offset:50344
    v_lshl_add_u32 v243, v30, 2, s97
    v_mul_u32_u24 v30, 1280, v30
    s_waitcnt lgkmcnt(4)
    v_mfma_f32_32x32x16_bf16 v[32:47], v[120:123], a[200:203], v[32:47]
    ds_read_b64_tr_b16 v[108:109], v19 offset:53248
    ds_read_b64_tr_b16 v[110:111], v19 offset:53888
    buffer_load_dwordx4 v135, s[16:19], 0 offen offset:3072 lds
    s_add_u32 m0, s75, 53248
    s_add_u32 s74, s74, 1
    v_mfma_f32_32x32x16_bf16 v[48:63], v[124:127], a[200:203], v[48:63]
    ds_read_b64_tr_b16 v[112:113], v19 offset:53288
    ds_read_b64_tr_b16 v[114:115], v19 offset:53928
    v_lshrrev_b32 v31, 4, v1
    v_mad_u32_u24 v241, v31, 40, v30
    s_waitcnt lgkmcnt(4)
    v_mfma_f32_32x32x16_bf16 v[32:47], v[96:99], a[204:207], v[32:47]
    ds_read_b64_tr_b16 v[120:121], v19 offset:55808
    ds_read_b64_tr_b16 v[122:123], v19 offset:56448
    buffer_load_dwordx4 v136, s[16:19], 0 offen lds
    s_add_u32 s4, s20, s83
    s_addc_u32 s5, s21, 0
    v_mfma_f32_32x32x16_bf16 v[48:63], v[100:103], a[204:207], v[48:63]
    ds_read_b64_tr_b16 v[124:125], v19 offset:55848
    ds_read_b64_tr_b16 v[126:127], v19 offset:56488
    s_mov_b32 s6, 4096
    v_lshrrev_b32 v30, 5, v1
    s_waitcnt lgkmcnt(4)
    v_mfma_f32_32x32x16_bf16 v[32:47], v[108:111], a[208:211], v[32:47]
    ds_read_b64_tr_b16 v[96:97], v19 offset:59392
    ds_read_b64_tr_b16 v[98:99], v19 offset:60032
    v_bfe_u32 v31, v1, 2, 3
    v_lshl_add_u32 v30, v30, 4, v31
    v_mul_u32_u24 v30, 160, v30
    v_mfma_f32_32x32x16_bf16 v[48:63], v[112:115], a[208:211], v[48:63]
    ds_read_b64_tr_b16 v[100:101], v19 offset:59432
    ds_read_b64_tr_b16 v[102:103], v19 offset:60072
    buffer_load_dwordx4 v137, s[16:19], 0 offen offset:1024 lds
    s_cmp_eq_u32 s74, 10
    s_cselect_b32 s74, 0, s74
    s_waitcnt lgkmcnt(4)
    v_mfma_f32_32x32x16_bf16 v[32:47], v[120:123], a[212:215], v[32:47]
    ds_read_b64_tr_b16 v[108:109], v19 offset:61952
    ds_read_b64_tr_b16 v[110:111], v19 offset:62592
    v_and_b32 v31, 3, v1
    v_mad_u32_u24 v30, v31, 40, v30
    s_mul_i32 s96, s72, 61440
    v_mfma_f32_32x32x16_bf16 v[48:63], v[124:127], a[212:215], v[48:63]
    ds_read_b64_tr_b16 v[112:113], v19 offset:61992
    ds_read_b64_tr_b16 v[114:115], v19 offset:62632
    v_add_u32 v240, s96, v30
    s_mul_i32 s96, s72, 10240
    s_waitcnt lgkmcnt(4)
    v_mfma_f32_32x32x16_bf16 v[32:47], v[96:99], a[216:219], v[32:47]
    s_waitcnt vmcnt(12)
    s_barrier
    ds_read_b64_tr_b16 v[120:121], v22 offset:0
    ds_read_b64_tr_b16 v[122:123], v22 offset:1536
    s_add_u32 m0, s75, 73728
    v_mfma_f32_32x32x16_bf16 v[48:63], v[100:103], a[216:219], v[48:63]
    ds_read_b64_tr_b16 v[124:125], v23 offset:0
    ds_read_b64_tr_b16 v[126:127], v23 offset:1536
    ds_read_b64_tr_b16 v[128:129], v24 offset:0
    ds_read_b64_tr_b16 v[130:131], v24 offset:1536
    s_mul_i32 s81, s74, 196608
    s_add_u32 s16, s56, s81
    s_addc_u32 s17, s57, 0
    s_waitcnt lgkmcnt(6)
    v_mfma_f32_32x32x16_bf16 v[32:47], v[108:111], a[220:223], v[32:47]
    ds_read_b64_tr_b16 v[96:97], v22 offset:6144
    ds_read_b64_tr_b16 v[98:99], v22 offset:7680
    buffer_load_dwordx4 v132, s[16:19], 0 offen lds
    s_add_u32 s96, s96, 125952
    v_add_u32 v7, s96, v30
    v_mfma_f32_32x32x16_bf16 v[48:63], v[112:115], a[220:223], v[48:63]
    ds_read_b64_tr_b16 v[100:101], v23 offset:6144
    ds_read_b64_tr_b16 v[102:103], v23 offset:7680
    ds_read_b64_tr_b16 v[104:105], v24 offset:6144
    ds_read_b64_tr_b16 v[106:107], v24 offset:7680
    buffer_load_dwordx4 v133, s[16:19], 0 offen offset:1024 lds
    s_mov_b32 s28, s62
    s_waitcnt lgkmcnt(6)
    v_mfma_f32_32x32x16_bf16 v[160:175], v[120:123], a[64:67], 0
    ds_read_b64_tr_b16 v[108:109], v22 offset:12288
    ds_read_b64_tr_b16 v[110:111], v22 offset:13824
    buffer_load_dwordx4 v134, s[16:19], 0 offen offset:2048 lds
    s_mov_b32 s29, s63
    s_mov_b32 s30, 2621440
    v_mfma_f32_32x32x16_bf16 v[176:191], v[124:127], a[64:67], 0
    ds_read_b64_tr_b16 v[112:113], v23 offset:12288
    ds_read_b64_tr_b16 v[114:115], v23 offset:13824
    s_mov_b32 s31, 0x20000
    s_lshl_b32 s96, s2, 1
    s_add_u32 s96, s96, s70
    v_mfma_f32_32x32x16_bf16 v[192:207], v[128:131], a[64:67], 0
    ds_read_b64_tr_b16 v[116:117], v24 offset:12288
    ds_read_b64_tr_b16 v[118:119], v24 offset:13824
    buffer_load_dwordx4 v135, s[16:19], 0 offen offset:3072 lds
    s_add_u32 m0, s75, 77824
    s_waitcnt lgkmcnt(6)
    v_mfma_f32_32x32x16_bf16 v[160:175], v[96:99], a[68:71], v[160:175]
    ds_read_b64_tr_b16 v[120:121], v22 offset:18432
    ds_read_b64_tr_b16 v[122:123], v22 offset:19968
    s_add_u32 s74, s74, 1
    buffer_load_dwordx4 v136, s[16:19], 0 offen lds
    v_cvt_pk_bf16_f32 v220, v32, v33
    v_mfma_f32_32x32x16_bf16 v[176:191], v[100:103], a[68:71], v[176:191]
    ds_read_b64_tr_b16 v[124:125], v23 offset:18432
    ds_read_b64_tr_b16 v[126:127], v23 offset:19968
    v_cvt_pk_bf16_f32 v221, v34, v35
    v_cvt_pk_bf16_f32 v222, v36, v37
    v_cvt_pk_bf16_f32 v223, v38, v39
    v_mfma_f32_32x32x16_bf16 v[192:207], v[104:107], a[68:71], v[192:207]
    ds_read_b64_tr_b16 v[128:129], v24 offset:18432
    ds_read_b64_tr_b16 v[130:131], v24 offset:19968
    buffer_load_dwordx4 v137, s[16:19], 0 offen offset:1024 lds
    s_cmp_eq_u32 s74, 10
    s_cselect_b32 s74, 0, s74
    s_waitcnt lgkmcnt(6)
    v_mfma_f32_32x32x16_bf16 v[160:175], v[108:111], a[72:75], v[160:175]
    s_waitcnt vmcnt(12)
    s_barrier
    ds_read_b64_tr_b16 v[96:97], v22 offset:24576
    ds_read_b64_tr_b16 v[98:99], v22 offset:26112
    s_add_u32 m0, s75, 98304
    v_mfma_f32_32x32x16_bf16 v[176:191], v[112:115], a[72:75], v[176:191]
    ds_read_b64_tr_b16 v[100:101], v23 offset:24576
    ds_read_b64_tr_b16 v[102:103], v23 offset:26112
    s_mul_i32 s81, s74, 196608
    s_add_u32 s16, s56, s81
    s_addc_u32 s17, s57, 0
    v_mfma_f32_32x32x16_bf16 v[192:207], v[116:119], a[72:75], v[192:207]
    ds_read_b64_tr_b16 v[104:105], v24 offset:24576
    ds_read_b64_tr_b16 v[106:107], v24 offset:26112
    buffer_load_dwordx4 v132, s[16:19], 0 offen lds
    v_cvt_pk_bf16_f32 v224, v40, v41
    s_waitcnt lgkmcnt(6)
    v_mfma_f32_32x32x16_bf16 v[160:175], v[120:123], a[76:79], v[160:175]
    ds_read_b64_tr_b16 v[108:109], v22 offset:30720
    ds_read_b64_tr_b16 v[110:111], v22 offset:32256
    v_cvt_pk_bf16_f32 v225, v42, v43
    v_cndmask_b32_e64 v224, v224, 0, s[90:91]
    v_cndmask_b32_e64 v225, v225, 0, s[90:91]
    v_mfma_f32_32x32x16_bf16 v[176:191], v[124:127], a[76:79], v[176:191]
    ds_read_b64_tr_b16 v[112:113], v23 offset:30720
    ds_read_b64_tr_b16 v[114:115], v23 offset:32256
    buffer_load_dwordx4 v133, s[16:19], 0 offen offset:1024 lds
    v_cvt_pk_bf16_f32 v226, v48, v49
    v_cvt_pk_bf16_f32 v227, v50, v51
    v_mfma_f32_32x32x16_bf16 v[192:207], v[128:131], a[76:79], v[192:207]
    ds_read_b64_tr_b16 v[116:117], v24 offset:30720
    ds_read_b64_tr_b16 v[118:119], v24 offset:32256
    v_cvt_pk_bf16_f32 v228, v52, v53
    v_cvt_pk_bf16_f32 v229, v54, v55
    s_waitcnt lgkmcnt(6)
    v_mfma_f32_32x32x16_bf16 v[160:175], v[96:99], a[80:83], v[160:175]
    ds_read_b64_tr_b16 v[120:121], v22 offset:36864
    ds_read_b64_tr_b16 v[122:123], v22 offset:38400
    buffer_load_dwordx4 v134, s[16:19], 0 offen offset:2048 lds
    v_cvt_pk_bf16_f32 v230, v56, v57
    v_cvt_pk_bf16_f32 v231, v58, v59
    v_mfma_f32_32x32x16_bf16 v[176:191], v[100:103], a[80:83], v[176:191]
    ds_read_b64_tr_b16 v[124:125], v23 offset:36864
    ds_read_b64_tr_b16 v[126:127], v23 offset:38400
    v_cndmask_b32_e64 v230, v230, 0, s[90:91]
    v_cndmask_b32_e64 v231, v231, 0, s[90:91]
    s_add_u32 s97, s2, 512
    v_mfma_f32_32x32x16_bf16 v[192:207], v[104:107], a[80:83], v[192:207]
    ds_read_b64_tr_b16 v[128:129], v24 offset:36864
    ds_read_b64_tr_b16 v[130:131], v24 offset:38400
    buffer_load_dwordx4 v135, s[16:19], 0 offen offset:3072 lds
    s_add_u32 m0, s75, 102400
    s_waitcnt lgkmcnt(6)
    v_mfma_f32_32x32x16_bf16 v[160:175], v[108:111], a[84:87], v[160:175]
    ds_read_b64_tr_b16 v[96:97], v22 offset:43008
    ds_read_b64_tr_b16 v[98:99], v22 offset:44544
    s_add_u32 s74, s74, 1
    buffer_load_dwordx4 v136, s[16:19], 0 offen lds
    s_cmp_lt_u32 s70, 2
    s_cselect_b32 s96, s96, s97
    v_mfma_f32_32x32x16_bf16 v[176:191], v[112:115], a[84:87], v[176:191]
    ds_read_b64_tr_b16 v[100:101], v23 offset:43008
    ds_read_b64_tr_b16 v[102:103], v23 offset:44544
    s_cmp_eq_u32 s70, 3
    s_cselect_b32 s96, 1000, s96
    s_cmp_lt_u32 s96, 544
    s_cselect_b32 s38, 5120, 0
    s_cselect_b32 s42, 2785280, 0
    s_cselect_b32 s96, s96, 0
    v_mfma_f32_32x32x16_bf16 v[192:207], v[116:119], a[84:87], v[192:207]
    ds_read_b64_tr_b16 v[104:105], v24 offset:43008
    ds_read_b64_tr_b16 v[106:107], v24 offset:44544
    buffer_load_dwordx4 v137, s[16:19], 0 offen offset:1024 lds
    s_cmp_eq_u32 s74, 10
    s_cselect_b32 s74, 0, s74
    s_waitcnt lgkmcnt(6)
    v_mfma_f32_32x32x16_bf16 v[160:175], v[120:123], a[88:91], v[160:175]
L_pad3:
    s_cbranch_execz L_pad7
    s_waitcnt vmcnt(12)
    s_barrier
    ds_read_b64_tr_b16 v[108:109], v22 offset:49152
    ds_read_b64_tr_b16 v[110:111], v22 offset:50688
    s_add_u32 m0, s75, 0
    v_mfma_f32_32x32x16_bf16 v[176:191], v[124:127], a[88:91], v[176:191]
    ds_read_b64_tr_b16 v[112:113], v23 offset:49152
    ds_read_b64_tr_b16 v[114:115], v23 offset:50688
    s_mul_i32 s81, s74, 196608
    s_add_u32 s16, s56, s81
    s_addc_u32 s17, s57, 0
    v_mfma_f32_32x32x16_bf16 v[192:207], v[128:131], a[88:91], v[192:207]
    ds_read_b64_tr_b16 v[116:117], v24 offset:49152
    ds_read_b64_tr_b16 v[118:119], v24 offset:50688
    buffer_load_dwordx4 v132, s[16:19], 0 offen lds
    s_mov_b32 s39, 0x20000
    s_waitcnt lgkmcnt(6)
    v_mfma_f32_32x32x16_bf16 v[160:175], v[96:99], a[92:95], v[160:175]
    ds_read_b64_tr_b16 v[120:121], v22 offset:55296
    ds_read_b64_tr_b16 v[122:123], v22 offset:56832
    s_mov_b32 s43, 0x20000
    s_mul_i32 s55, s96, 640
    s_mov_b32 s97, 0
    v_mfma_f32_32x32x16_bf16 v[176:191], v[100:103], a[92:95], v[176:191]
    ds_read_b64_tr_b16 v[124:125], v23 offset:55296
    ds_read_b64_tr_b16 v[126:127], v23 offset:56832
    buffer_load_dwordx4 v133, s[16:19], 0 offen offset:1024 lds
    s_cmp_ge_u32 s96, 192
    s_cselect_b32 s97, 51200, s97
    v_mfma_f32_32x32x16_bf16 v[192:207], v[104:107], a[92:95], v[192:207]
    ds_read_b64_tr_b16 v[128:129], v24 offset:55296
    ds_read_b64_tr_b16 v[130:131], v24 offset:56832
    s_cmp_ge_u32 s96, 384
    s_cselect_b32 s97, 4294844416, s97
    s_waitcnt lgkmcnt(6)
    v_mfma_f32_32x32x16_bf16 v[160:175], v[108:111], a[96:99], v[160:175]
    ds_read_b64_tr_b16 v[96:97], v22 offset:61440
    ds_read_b64_tr_b16 v[98:99], v22 offset:62976
    buffer_load_dwordx4 v134, s[16:19], 0 offen offset:2048 lds
    s_cmp_ge_u32 s96, 464
    s_cselect_b32 s97, 0, s97
    v_mfma_f32_32x32x16_bf16 v[176:191], v[112:115], a[96:99], v[176:191]
    ds_read_b64_tr_b16 v[100:101], v23 offset:61440
    ds_read_b64_tr_b16 v[102:103], v23 offset:62976
    s_add_u32 s55, s55, s97
    s_add_u32 s55, s55, 12582912
    s_add_u32 s40, s20, s55
    s_addc_u32 s41, s21, 0
    v_mfma_f32_32x32x16_bf16 v[192:207], v[116:119], a[96:99], v[192:207]
    ds_read_b64_tr_b16 v[104:105], v24 offset:61440
    ds_read_b64_tr_b16 v[106:107], v24 offset:62976
    buffer_load_dwordx4 v135, s[16:19], 0 offen offset:3072 lds
    s_add_u32 m0, s75, 4096
    s_waitcnt lgkmcnt(6)
    v_mfma_f32_32x32x16_bf16 v[160:175], v[120:123], a[100:103], v[160:175]
    ds_read_b64_tr_b16 v[108:109], v25 offset:10240
    ds_read_b64_tr_b16 v[110:111], v25 offset:11776
    s_add_u32 s74, s74, 1
    buffer_load_dwordx4 v136, s[16:19], 0 offen lds
    s_sub_u32 s51, s96, 384
    v_mfma_f32_32x32x16_bf16 v[176:191], v[124:127], a[100:103], v[176:191]
    ds_read_b64_tr_b16 v[112:113], v26 offset:10240
    ds_read_b64_tr_b16 v[114:115], v26 offset:11776
    s_max_i32 s51, s51, 0
    s_bfe_u32 s98, s51, 0x10001
    s_lshr_b32 s99, s51, 2
    v_mfma_f32_32x32x16_bf16 v[192:207], v[128:131], a[100:103], v[192:207]
    ds_read_b64_tr_b16 v[116:117], v27 offset:10240
    ds_read_b64_tr_b16 v[118:119], v27 offset:11776
    buffer_load_dwordx4 v137, s[16:19], 0 offen offset:1024 lds
    s_cmp_eq_u32 s74, 10
    s_cselect_b32 s74, 0, s74
    s_waitcnt lgkmcnt(6)
    v_mfma_f32_32x32x16_bf16 v[160:175], v[96:99], a[104:107], v[160:175]
    s_waitcnt vmcnt(12)
    s_barrier
    ds_read_b64_tr_b16 v[120:121], v25 offset:16384
    ds_read_b64_tr_b16 v[122:123], v25 offset:17920
    s_add_u32 m0, s75, 24576
    v_mfma_f32_32x32x16_bf16 v[176:191], v[100:103], a[104:107], v[176:191]
    ds_read_b64_tr_b16 v[124:125], v26 offset:16384
    ds_read_b64_tr_b16 v[126:127], v26 offset:17920
    s_mul_i32 s81, s74, 196608
    s_add_u32 s16, s56, s81
    s_addc_u32 s17, s57, 0
    v_mfma_f32_32x32x16_bf16 v[192:207], v[104:107], a[104:107], v[192:207]
    ds_read_b64_tr_b16 v[128:129], v27 offset:16384
    ds_read_b64_tr_b16 v[130:131], v27 offset:17920
    buffer_load_dwordx4 v132, s[16:19], 0 offen lds
    s_and_b32 s50, s51, 1
    s_waitcnt lgkmcnt(6)
    v_mfma_f32_32x32x16_bf16 v[160:175], v[108:111], a[108:111], v[160:175]
    ds_read_b64_tr_b16 v[96:97], v25 offset:22528
    ds_read_b64_tr_b16 v[98:99], v25 offset:24064
    s_lshl1_add_u32 s99, s99, s50
    s_mul_i32 s97, s99, 205
    s_lshr_b32 s97, s97, 10
    v_mfma_f32_32x32x16_bf16 v[176:191], v[112:115], a[108:111], v[176:191]
    ds_read_b64_tr_b16 v[100:101], v26 offset:22528
    ds_read_b64_tr_b16 v[102:103], v26 offset:24064
    buffer_load_dwordx4 v133, s[16:19], 0 offen offset:1024 lds
    s_mul_i32 s50, s97, 5
    s_sub_u32 s99, s99, s50
    v_mfma_f32_32x32x16_bf16 v[192:207], v[116:119], a[108:111], v[192:207]
    ds_read_b64_tr_b16 v[104:105], v27 offset:22528
    ds_read_b64_tr_b16 v[106:107], v27 offset:24064
    s_mul_i32 s97, s97, 10
    s_lshr_b32 s50, s99, 1
    s_waitcnt lgkmcnt(6)
    v_mfma_f32_32x32x16_bf16 v[160:175], v[120:123], a[112:115], v[160:175]
    ds_read_b64_tr_b16 v[108:109], v25 offset:28672
    ds_read_b64_tr_b16 v[110:111], v25 offset:30208
    buffer_load_dwordx4 v134, s[16:19], 0 offen offset:2048 lds
    s_mul_i32 s50, s50, 5
    s_and_b32 s51, s99, 1
    v_mfma_f32_32x32x16_bf16 v[176:191], v[124:127], a[112:115], v[176:191]
    ds_read_b64_tr_b16 v[112:113], v26 offset:28672
    ds_read_b64_tr_b16 v[114:115], v26 offset:30208
    s_add_u32 s50, s50, s51
    s_lshl1_add_u32 s50, s98, s50
    s_mul_i32 s98, s98, 5
    v_mfma_f32_32x32x16_bf16 v[192:207], v[128:131], a[112:115], v[192:207]
    ds_read_b64_tr_b16 v[116:117], v27 offset:28672
    ds_read_b64_tr_b16 v[118:119], v27 offset:30208
    buffer_load_dwordx4 v135, s[16:19], 0 offen offset:3072 lds
    s_add_u32 m0, s75, 28672
    s_waitcnt lgkmcnt(6)
    v_mfma_f32_32x32x16_bf16 v[160:175], v[96:99], a[116:119], v[160:175]
    ds_read_b64_tr_b16 v[120:121], v25 offset:34816
    ds_read_b64_tr_b16 v[122:123], v25 offset:36352
    s_add_u32 s74, s74, 1
    buffer_load_dwordx4 v136, s[16:19], 0 offen lds
    s_add_u32 s98, s98, 4
    v_mfma_f32_32x32x16_bf16 v[176:191], v[100:103], a[116:119], v[176:191]
    ds_read_b64_tr_b16 v[124:125], v26 offset:34816
    ds_read_b64_tr_b16 v[126:127], v26 offset:36352
    s_cmp_eq_u32 s99, 4
    s_cselect_b32 s50, s98, s50
    s_add_u32 s97, s97, s50
    v_mfma_f32_32x32x16_bf16 v[192:207], v[104:107], a[116:119], v[192:207]
    ds_read_b64_tr_b16 v[128:129], v27 offset:34816
    ds_read_b64_tr_b16 v[130:131], v27 offset:36352
    buffer_load_dwordx4 v137, s[16:19], 0 offen offset:1024 lds
    s_cmp_eq_u32 s74, 10
    s_cselect_b32 s74, 0, s74
    s_waitcnt lgkmcnt(6)
    v_mfma_f32_32x32x16_bf16 v[160:175], v[108:111], a[120:123], v[160:175]
    s_waitcnt vmcnt(12)
    s_barrier
    ds_read_b64_tr_b16 v[96:97], v25 offset:40960
    ds_read_b64_tr_b16 v[98:99], v25 offset:42496
    s_add_u32 m0, s75, 49152
    v_mfma_f32_32x32x16_bf16 v[176:191], v[112:115], a[120:123], v[176:191]
    ds_read_b64_tr_b16 v[100:101], v26 offset:40960
    ds_read_b64_tr_b16 v[102:103], v26 offset:42496
    s_mul_i32 s81, s74, 196608
    s_add_u32 s16, s56, s81
    s_addc_u32 s17, s57, 0
    v_mfma_f32_32x32x16_bf16 v[192:207], v[116:119], a[120:123], v[192:207]
    ds_read_b64_tr_b16 v[104:105], v27 offset:40960
    ds_read_b64_tr_b16 v[106:107], v27 offset:42496
    buffer_load_dwordx4 v132, s[16:19], 0 offen lds
    s_cmp_lt_u32 s96, 384
    s_cselect_b32 s97, s96, s97
    s_cselect_b64 s[36:37], s[58:59], s[52:53]
    s_waitcnt lgkmcnt(6)
    v_mfma_f32_32x32x16_bf16 v[160:175], v[120:123], a[124:127], v[160:175]
    ds_read_b64_tr_b16 v[108:109], v25 offset:47104
    ds_read_b64_tr_b16 v[110:111], v25 offset:48640
    s_mul_i32 s97, s97, 5120
    s_add_u32 s36, s36, s97
    s_addc_u32 s37, s37, 0
    v_mfma_f32_32x32x16_bf16 v[176:191], v[124:127], a[124:127], v[176:191]
    ds_read_b64_tr_b16 v[112:113], v26 offset:47104
    ds_read_b64_tr_b16 v[114:115], v26 offset:48640
    buffer_load_dwordx4 v133, s[16:19], 0 offen offset:1024 lds
    v_mul_u32_u24 v31, 0xcd, v1
    v_lshrrev_b32 v31, 11, v31
    v_mfma_f32_32x32x16_bf16 v[192:207], v[128:131], a[124:127], v[192:207]
    ds_read_b64_tr_b16 v[116:117], v27 offset:47104
    ds_read_b64_tr_b16 v[118:119], v27 offset:48640
    v_mul_u32_u24 v31, 1120, v31
    v_cmp_gt_u32 vcc, 40, v1
    s_waitcnt lgkmcnt(6)
    v_mfma_f32_32x32x16_bf16 v[160:175], v[96:99], a[128:131], v[160:175]
    ds_read_b64_tr_b16 v[120:121], v25 offset:53248
    ds_read_b64_tr_b16 v[122:123], v25 offset:54784
    buffer_load_dwordx4 v134, s[16:19], 0 offen offset:2048 lds
    v_mov_b32 v30, 0x80000000
    v_add_u32 v31, v31, v6
    v_mfma_f32_32x32x16_bf16 v[176:191], v[100:103], a[128:131], v[176:191]
    ds_read_b64_tr_b16 v[124:125], v26 offset:53248
    ds_read_b64_tr_b16 v[126:127], v26 offset:54784
    v_cndmask_b32 v232, v30, v31, vcc
    v_cndmask_b32 v233, v30, v6, vcc
    v_add_u32 v234, 348160, v233
    v_mfma_f32_32x32x16_bf16 v[192:207], v[104:107], a[128:131], v[192:207]
    ds_read_b64_tr_b16 v[128:129], v27 offset:53248
    ds_read_b64_tr_b16 v[130:131], v27 offset:54784
    buffer_load_dwordx4 v135, s[16:19], 0 offen offset:3072 lds
    s_add_u32 m0, s75, 53248
    s_waitcnt lgkmcnt(6)
    v_mfma_f32_32x32x16_bf16 v[160:175], v[108:111], a[132:135], v[160:175]
    ds_read_b64_tr_b16 v[96:97], v25 offset:59392
    ds_read_b64_tr_b16 v[98:99], v25 offset:60928
    s_add_u32 s74, s74, 1
    buffer_load_dwordx4 v136, s[16:19], 0 offen lds
    v_add_u32 v235, 696320, v233
    v_mfma_f32_32x32x16_bf16 v[176:191], v[112:115], a[132:135], v[176:191]
    ds_read_b64_tr_b16 v[100:101], v26 offset:59392
    ds_read_b64_tr_b16 v[102:103], v26 offset:60928
    v_add_u32 v250, 1044480, v233
    v_add_u32 v251, 1392640, v233
    v_add_u32 v252, 1740800, v233
    v_mfma_f32_32x32x16_bf16 v[192:207], v[116:119], a[132:135], v[192:207]
    ds_read_b64_tr_b16 v[104:105], v27 offset:59392
    ds_read_b64_tr_b16 v[106:107], v27 offset:60928
    buffer_load_dwordx4 v137, s[16:19], 0 offen offset:1024 lds
    s_cmp_eq_u32 s74, 10
    s_cselect_b32 s74, 0, s74
    s_waitcnt lgkmcnt(6)
    v_mfma_f32_32x32x16_bf16 v[160:175], v[120:123], a[136:139], v[160:175]
    s_waitcnt vmcnt(12)
    s_barrier
    ds_read_b64_tr_b16 v[108:109], v22 offset:0
    ds_read_b64_tr_b16 v[110:111], v22 offset:1536
    s_add_u32 m0, s75, 73728
    v_mfma_f32_32x32x16_bf16 v[176:191], v[124:127], a[136:139], v[176:191]
    ds_read_b64_tr_b16 v[112:113], v23 offset:0
    ds_read_b64_tr_b16 v[114:115], v23 offset:1536
    s_mul_i32 s81, s74, 196608
    s_add_u32 s16, s56, s81
    s_addc_u32 s17, s57, 0
    v_mfma_f32_32x32x16_bf16 v[192:207], v[128:131], a[136:139], v[192:207]
    ds_read_b64_tr_b16 v[116:117], v24 offset:0
    ds_read_b64_tr_b16 v[118:119], v24 offset:1536
    buffer_load_dwordx4 v132, s[16:19], 0 offen lds
    v_add_u32 v253, 2088960, v233
    s_waitcnt lgkmcnt(6)
    v_mfma_f32_32x32x16_bf16 v[160:175], v[96:99], a[140:143], v[160:175]
    ds_read_b64_tr_b16 v[120:121], v22 offset:6144
    ds_read_b64_tr_b16 v[122:123], v22 offset:7680
    v_add_u32 v254, 2437120, v233
    v_mfma_f32_32x32x16_bf16 v[176:191], v[100:103], a[140:143], v[176:191]
    ds_read_b64_tr_b16 v[124:125], v23 offset:6144
    ds_read_b64_tr_b16 v[126:127], v23 offset:7680
    buffer_load_dwordx4 v133, s[16:19], 0 offen offset:1024 lds
    v_mfma_f32_32x32x16_bf16 v[192:207], v[104:107], a[140:143], v[192:207]
    ds_read_b64_tr_b16 v[128:129], v24 offset:6144
    ds_read_b64_tr_b16 v[130:131], v24 offset:7680
    s_waitcnt lgkmcnt(6)
    v_mfma_f32_32x32x16_bf16 v[160:175], v[108:111], a[144:147], v[160:175]
    ds_read_b64_tr_b16 v[96:97], v22 offset:12288
    ds_read_b64_tr_b16 v[98:99], v22 offset:13824
    buffer_load_dwordx4 v134, s[16:19], 0 offen offset:2048 lds
    v_mfma_f32_32x32x16_bf16 v[176:191], v[112:115], a[144:147], v[176:191]
    ds_read_b64_tr_b16 v[100:101], v23 offset:12288
    ds_read_b64_tr_b16 v[102:103], v23 offset:13824
    buffer_load_dwordx4 v135, s[16:19], 0 offen offset:3072 lds
    s_add_u32 m0, s75, 77824
    s_add_u32 s74, s74, 1
    v_mfma_f32_32x32x16_bf16 v[192:207], v[116:119], a[144:147], v[192:207]
    ds_read_b64_tr_b16 v[104:105], v24 offset:12288
    ds_read_b64_tr_b16 v[106:107], v24 offset:13824
    buffer_load_dwordx4 v136, s[16:19], 0 offen lds
    s_waitcnt lgkmcnt(6)
    v_mfma_f32_32x32x16_bf16 v[160:175], v[120:123], a[148:151], v[160:175]
    ds_read_b64_tr_b16 v[108:109], v22 offset:18432
    ds_read_b64_tr_b16 v[110:111], v22 offset:19968
    buffer_load_dwordx4 v137, s[16:19], 0 offen offset:1024 lds
    s_cmp_eq_u32 s74, 10
    s_cselect_b32 s74, 0, s74
    v_mfma_f32_32x32x16_bf16 v[176:191], v[124:127], a[148:151], v[176:191]
    ds_read_b64_tr_b16 v[112:113], v23 offset:18432
    ds_read_b64_tr_b16 v[114:115], v23 offset:19968
    v_mfma_f32_32x32x16_bf16 v[192:207], v[128:131], a[148:151], v[192:207]
    ds_read_b64_tr_b16 v[116:117], v24 offset:18432
    ds_read_b64_tr_b16 v[118:119], v24 offset:19968
    buffer_load_dword v5, v244, s[24:27], 0 offen sc1
    s_waitcnt lgkmcnt(6)
    v_mfma_f32_32x32x16_bf16 v[160:175], v[96:99], a[152:155], v[160:175]
    s_waitcnt vmcnt(13)
    s_barrier
    ds_read_b64_tr_b16 v[120:121], v22 offset:24576
    ds_read_b64_tr_b16 v[122:123], v22 offset:26112
    s_add_u32 m0, s75, 98304
    v_mfma_f32_32x32x16_bf16 v[176:191], v[100:103], a[152:155], v[176:191]
    ds_read_b64_tr_b16 v[124:125], v23 offset:24576
    ds_read_b64_tr_b16 v[126:127], v23 offset:26112
    s_mul_i32 s81, s74, 196608
    s_add_u32 s16, s56, s81
    s_addc_u32 s17, s57, 0
    v_mfma_f32_32x32x16_bf16 v[192:207], v[104:107], a[152:155], v[192:207]
    ds_read_b64_tr_b16 v[128:129], v24 offset:24576
    ds_read_b64_tr_b16 v[130:131], v24 offset:26112
    buffer_load_dwordx4 v132, s[16:19], 0 offen lds
    s_waitcnt lgkmcnt(6)
    v_mfma_f32_32x32x16_bf16 v[160:175], v[108:111], a[156:159], v[160:175]
    ds_read_b64_tr_b16 v[96:97], v22 offset:30720
    ds_read_b64_tr_b16 v[98:99], v22 offset:32256
    v_mfma_f32_32x32x16_bf16 v[176:191], v[112:115], a[156:159], v[176:191]
    ds_read_b64_tr_b16 v[100:101], v23 offset:30720
    ds_read_b64_tr_b16 v[102:103], v23 offset:32256
    buffer_load_dwordx4 v133, s[16:19], 0 offen offset:1024 lds
    v_mfma_f32_32x32x16_bf16 v[192:207], v[116:119], a[156:159], v[192:207]
    ds_read_b64_tr_b16 v[104:105], v24 offset:30720
    ds_read_b64_tr_b16 v[106:107], v24 offset:32256
    s_waitcnt lgkmcnt(6)
    v_mfma_f32_32x32x16_bf16 v[160:175], v[120:123], a[160:163], v[160:175]
    ds_read_b64_tr_b16 v[108:109], v22 offset:36864
    ds_read_b64_tr_b16 v[110:111], v22 offset:38400
    buffer_load_dwordx4 v134, s[16:19], 0 offen offset:2048 lds
    v_mfma_f32_32x32x16_bf16 v[176:191], v[124:127], a[160:163], v[176:191]
    ds_read_b64_tr_b16 v[112:113], v23 offset:36864
    ds_read_b64_tr_b16 v[114:115], v23 offset:38400
    v_mfma_f32_32x32x16_bf16 v[192:207], v[128:131], a[160:163], v[192:207]
    ds_read_b64_tr_b16 v[116:117], v24 offset:36864
    ds_read_b64_tr_b16 v[118:119], v24 offset:38400
    buffer_load_dwordx4 v135, s[16:19], 0 offen offset:3072 lds
    s_add_u32 m0, s75, 102400
    s_waitcnt lgkmcnt(6)
    v_mfma_f32_32x32x16_bf16 v[160:175], v[96:99], a[164:167], v[160:175]
    ds_read_b64_tr_b16 v[120:121], v22 offset:43008
    ds_read_b64_tr_b16 v[122:123], v22 offset:44544
    s_add_u32 s74, s74, 1
    buffer_load_dwordx4 v136, s[16:19], 0 offen lds
    v_mfma_f32_32x32x16_bf16 v[176:191], v[100:103], a[164:167], v[176:191]
    ds_read_b64_tr_b16 v[124:125], v23 offset:43008
    ds_read_b64_tr_b16 v[126:127], v23 offset:44544
    v_mfma_f32_32x32x16_bf16 v[192:207], v[104:107], a[164:167], v[192:207]
    ds_read_b64_tr_b16 v[128:129], v24 offset:43008
    ds_read_b64_tr_b16 v[130:131], v24 offset:44544
    buffer_load_dwordx4 v137, s[16:19], 0 offen offset:1024 lds
    s_cmp_eq_u32 s74, 10
    s_cselect_b32 s74, 0, s74
    s_waitcnt lgkmcnt(6)
    v_mfma_f32_32x32x16_bf16 v[160:175], v[108:111], a[168:171], v[160:175]
    s_waitcnt vmcnt(13)
    s_barrier
    ds_read_b64_tr_b16 v[96:97], v22 offset:49152
    ds_read_b64_tr_b16 v[98:99], v22 offset:50688
    v_mfma_f32_32x32x16_bf16 v[176:191], v[112:115], a[168:171], v[176:191]
    ds_read_b64_tr_b16 v[100:101], v23 offset:49152
    ds_read_b64_tr_b16 v[102:103], v23 offset:50688
    v_mfma_f32_32x32x16_bf16 v[192:207], v[116:119], a[168:171], v[192:207]
    ds_read_b64_tr_b16 v[104:105], v24 offset:49152
    ds_read_b64_tr_b16 v[106:107], v24 offset:50688
    s_waitcnt lgkmcnt(6)
    v_mfma_f32_32x32x16_bf16 v[160:175], v[120:123], a[172:175], v[160:175]
    ds_read_b64_tr_b16 v[108:109], v22 offset:55296
    ds_read_b64_tr_b16 v[110:111], v22 offset:56832
    v_mfma_f32_32x32x16_bf16 v[176:191], v[124:127], a[172:175], v[176:191]
    ds_read_b64_tr_b16 v[112:113], v23 offset:55296
    ds_read_b64_tr_b16 v[114:115], v23 offset:56832
    v_mfma_f32_32x32x16_bf16 v[192:207], v[128:131], a[172:175], v[192:207]
    ds_read_b64_tr_b16 v[116:117], v24 offset:55296
    ds_read_b64_tr_b16 v[118:119], v24 offset:56832
    s_waitcnt vmcnt(6)
    v_and_b32 v5, 0xff, v5
    v_cmp_gt_u32 vcc, 2, v5
    s_nop 4
    s_cbranch_vccz L_kvpoll_done
    buffer_load_dword v5, v244, s[24:27], 0 offen sc1
    s_mov_b32 s84, 0
L_kvpoll:
    s_waitcnt vmcnt(0)
    v_and_b32 v5, 0xff, v5
    v_cmp_gt_u32 vcc, 2, v5
    s_nop 4
    s_cbranch_vccz L_kvpoll_ok
    s_add_u32 s84, s84, 1
    s_cmp_ge_u32 s84, 1048576
    s_cbranch_scc1 L_kvpoll_ok
    s_sleep 4
    buffer_load_dword v5, v244, s[24:27], 0 offen sc1
    s_branch L_kvpoll
L_kvpoll_ok:
L_kvpoll_done:
    s_waitcnt lgkmcnt(6)
    v_mfma_f32_32x32x16_bf16 v[160:175], v[96:99], a[176:179], v[160:175]
    ds_read_b64_tr_b16 v[120:121], v22 offset:61440
    ds_read_b64_tr_b16 v[122:123], v22 offset:62976
    buffer_load_dwordx4 a[0:3], v6, s[4:7], 0 offen sc1
    v_mfma_f32_32x32x16_bf16 v[176:191], v[100:103], a[176:179], v[176:191]
    ds_read_b64_tr_b16 v[124:125], v23 offset:61440
    ds_read_b64_tr_b16 v[126:127], v23 offset:62976
    buffer_load_dwordx2 a[12:13], v4, s[4:7], 0 offen offset:3072 sc1
    v_mfma_f32_32x32x16_bf16 v[192:207], v[104:107], a[176:179], v[192:207]
    ds_read_b64_tr_b16 v[128:129], v24 offset:61440
    ds_read_b64_tr_b16 v[130:131], v24 offset:62976
    buffer_load_dwordx4 a[4:7], v3, s[4:7], 0 offen offset:1024 sc1
    s_waitcnt lgkmcnt(6)
    v_mfma_f32_32x32x16_bf16 v[160:175], v[108:111], a[180:183], v[160:175]
    ds_read_b64_tr_b16 v[96:97], v25 offset:10240
    ds_read_b64_tr_b16 v[98:99], v25 offset:11776
    buffer_load_dwordx4 a[8:11], v3, s[4:7], 0 offen offset:2048 sc1
    s_add_u32 s83, s83, 8192
    s_and_b32 s83, s83, 0x3ffff
    v_mfma_f32_32x32x16_bf16 v[176:191], v[112:115], a[180:183], v[176:191]
    ds_read_b64_tr_b16 v[100:101], v26 offset:10240
    ds_read_b64_tr_b16 v[102:103], v26 offset:11776
    s_add_u32 s4, s20, s83
    s_addc_u32 s5, s21, 0
    buffer_load_dwordx4 a[14:17], v6, s[4:7], 0 offen sc1
    v_mfma_f32_32x32x16_bf16 v[192:207], v[116:119], a[180:183], v[192:207]
    ds_read_b64_tr_b16 v[104:105], v27 offset:10240
    ds_read_b64_tr_b16 v[106:107], v27 offset:11776
    buffer_load_dwordx2 a[26:27], v4, s[4:7], 0 offen offset:3072 sc1
    s_waitcnt lgkmcnt(6)
    v_mfma_f32_32x32x16_bf16 v[160:175], v[120:123], a[184:187], v[160:175]
    s_barrier
    ds_read_b64_tr_b16 v[108:109], v25 offset:16384
    ds_read_b64_tr_b16 v[110:111], v25 offset:17920
    v_mfma_f32_32x32x16_bf16 v[176:191], v[124:127], a[184:187], v[176:191]
    ds_read_b64_tr_b16 v[112:113], v26 offset:16384
    ds_read_b64_tr_b16 v[114:115], v26 offset:17920
    buffer_load_dwordx4 a[18:21], v3, s[4:7], 0 offen offset:1024 sc1
    v_mfma_f32_32x32x16_bf16 v[192:207], v[128:131], a[184:187], v[192:207]
    ds_read_b64_tr_b16 v[116:117], v27 offset:16384
    ds_read_b64_tr_b16 v[118:119], v27 offset:17920
    s_waitcnt lgkmcnt(6)
    v_mfma_f32_32x32x16_bf16 v[160:175], v[96:99], a[188:191], v[160:175]
    ds_read_b64_tr_b16 v[120:121], v25 offset:22528
    ds_read_b64_tr_b16 v[122:123], v25 offset:24064
    buffer_load_dwordx4 a[22:25], v3, s[4:7], 0 offen offset:2048 sc1
    s_add_u32 s83, s83, 8192
    s_and_b32 s83, s83, 0x3ffff
    v_mfma_f32_32x32x16_bf16 v[176:191], v[100:103], a[188:191], v[176:191]
    ds_read_b64_tr_b16 v[124:125], v26 offset:22528
    ds_read_b64_tr_b16 v[126:127], v26 offset:24064
    s_add_u32 s4, s20, s83
    s_addc_u32 s5, s21, 0
    v_mfma_f32_32x32x16_bf16 v[192:207], v[104:107], a[188:191], v[192:207]
    ds_read_b64_tr_b16 v[128:129], v27 offset:22528
    ds_read_b64_tr_b16 v[130:131], v27 offset:24064
    buffer_load_dwordx4 a[28:31], v6, s[4:7], 0 offen sc1
    s_waitcnt lgkmcnt(6)
    v_mfma_f32_32x32x16_bf16 v[160:175], v[108:111], a[192:195], v[160:175]
    ds_read_b64_tr_b16 v[96:97], v25 offset:28672
    ds_read_b64_tr_b16 v[98:99], v25 offset:30208
    v_mfma_f32_32x32x16_bf16 v[176:191], v[112:115], a[192:195], v[176:191]
    ds_read_b64_tr_b16 v[100:101], v26 offset:28672
    ds_read_b64_tr_b16 v[102:103], v26 offset:30208
    buffer_load_dwordx2 a[40:41], v4, s[4:7], 0 offen offset:3072 sc1
    v_mfma_f32_32x32x16_bf16 v[192:207], v[116:119], a[192:195], v[192:207]
    ds_read_b64_tr_b16 v[104:105], v27 offset:28672
    ds_read_b64_tr_b16 v[106:107], v27 offset:30208
    s_waitcnt lgkmcnt(6)
    v_mfma_f32_32x32x16_bf16 v[160:175], v[120:123], a[196:199], v[160:175]
    ds_read_b64_tr_b16 v[108:109], v25 offset:34816
    ds_read_b64_tr_b16 v[110:111], v25 offset:36352
    buffer_load_dwordx4 a[32:35], v3, s[4:7], 0 offen offset:1024 sc1
    v_mfma_f32_32x32x16_bf16 v[176:191], v[124:127], a[196:199], v[176:191]
    ds_read_b64_tr_b16 v[112:113], v26 offset:34816
    ds_read_b64_tr_b16 v[114:115], v26 offset:36352
    v_mfma_f32_32x32x16_bf16 v[192:207], v[128:131], a[196:199], v[192:207]
    ds_read_b64_tr_b16 v[116:117], v27 offset:34816
    ds_read_b64_tr_b16 v[118:119], v27 offset:36352
    buffer_load_dwordx4 a[36:39], v3, s[4:7], 0 offen offset:2048 sc1
    s_add_u32 s83, s83, 8192
    s_waitcnt lgkmcnt(6)
    v_mfma_f32_32x32x16_bf16 v[160:175], v[96:99], a[200:203], v[160:175]
    s_waitcnt vmcnt(12)
    s_barrier
    ds_read_b64_tr_b16 v[120:121], v25 offset:40960
    ds_read_b64_tr_b16 v[122:123], v25 offset:42496
    s_and_b32 s83, s83, 0x3ffff
    v_mfma_f32_32x32x16_bf16 v[176:191], v[100:103], a[200:203], v[176:191]
    ds_read_b64_tr_b16 v[124:125], v26 offset:40960
    ds_read_b64_tr_b16 v[126:127], v26 offset:42496
    s_add_u32 s4, s20, s83
    s_addc_u32 s5, s21, 0
    ds_write_b128 v238, v[220:223] offset:0
    v_mfma_f32_32x32x16_bf16 v[192:207], v[104:107], a[200:203], v[192:207]
    ds_read_b64_tr_b16 v[128:129], v27 offset:40960
    ds_read_b64_tr_b16 v[130:131], v27 offset:42496
    ds_write_b128 v238, v[224:227] offset:1024
    ds_write_b128 v238, v[228:231] offset:2048
    s_waitcnt lgkmcnt(9)
    v_mfma_f32_32x32x16_bf16 v[160:175], v[108:111], a[204:207], v[160:175]
    ds_read_b64_tr_b16 v[96:97], v25 offset:47104
    ds_read_b64_tr_b16 v[98:99], v25 offset:48640
    ds_write_b32 v9, v64
    v_mfma_f32_32x32x16_bf16 v[176:191], v[112:115], a[204:207], v[176:191]
    ds_read_b64_tr_b16 v[100:101], v26 offset:47104
    ds_read_b64_tr_b16 v[102:103], v26 offset:48640
    v_mfma_f32_32x32x16_bf16 v[192:207], v[116:119], a[204:207], v[192:207]
    ds_read_b64_tr_b16 v[104:105], v27 offset:47104
    ds_read_b64_tr_b16 v[106:107], v27 offset:48640
    s_waitcnt lgkmcnt(9)
    v_mfma_f32_32x32x16_bf16 v[160:175], v[120:123], a[208:211], v[160:175]
    ds_read_b64_tr_b16 v[108:109], v25 offset:53248
    ds_read_b64_tr_b16 v[110:111], v25 offset:54784
    ds_read_b64_tr_b16 v[120:121], v25 offset:59392
    ds_read_b64_tr_b16 v[122:123], v25 offset:60928
    v_mfma_f32_32x32x16_bf16 v[176:191], v[124:127], a[208:211], v[176:191]
    ds_read_b64_tr_b16 v[112:113], v26 offset:53248
    ds_read_b64_tr_b16 v[114:115], v26 offset:54784
    ds_read_b64_tr_b16 v[124:125], v26 offset:59392
    ds_read_b64_tr_b16 v[126:127], v26 offset:60928
    v_mfma_f32_32x32x16_bf16 v[192:207], v[128:131], a[208:211], v[192:207]
    ds_read_b64_tr_b16 v[116:117], v27 offset:53248
    ds_read_b64_tr_b16 v[118:119], v27 offset:54784
    ds_read_b64_tr_b16 v[128:129], v27 offset:59392
    ds_read_b64_tr_b16 v[130:131], v27 offset:60928
    s_waitcnt lgkmcnt(12)
    v_mfma_f32_32x32x16_bf16 v[160:175], v[96:99], a[212:215], v[160:175]
    s_barrier
    ds_read_b128 v[208:211], v239 offset:0
    ds_read_b128 v[212:215], v239 offset:1024
    ds_read_b128 v[216:219], v239 offset:2048
    v_mov_b32 v30, 0
    v_mov_b32 v31, 0
    s_waitcnt lgkmcnt(11)
    v_mfma_f32_32x32x16_bf16 v[160:175], v[108:111], a[216:219], v[160:175]
    s_mov_b32 s76, 0
    s_mov_b32 s77, 0x35800000
    v_mfma_f32_32x32x16_bf16 v[160:175], v[120:123], a[220:223], v[160:175]
    s_mov_b32 s78, 0x53800000
    v_mfma_f32_32x32x16_bf16 v[176:191], v[100:103], a[212:215], v[176:191]
    s_waitcnt lgkmcnt(7)
    v_mfma_f32_32x32x16_bf16 v[176:191], v[112:115], a[216:219], v[176:191]
    v_cvt_pk_bf16_f32 v160, v160, v161
    v_cvt_pk_bf16_f32 v161, v162, v163
    v_cvt_pk_bf16_f32 v162, v164, v165
    v_cvt_pk_bf16_f32 v163, v166, v167
    v_pk_max_i16 v160, v160, 0 op_sel_hi:[1,0]
    v_mfma_f32_32x32x16_bf16 v[176:191], v[124:127], a[220:223], v[176:191]
    v_pk_max_i16 v161, v161, 0 op_sel_hi:[1,0]
    v_pk_max_i16 v162, v162, 0 op_sel_hi:[1,0]
    v_pk_max_i16 v163, v163, 0 op_sel_hi:[1,0]
    buffer_store_dwordx4 v[160:163], v236, s[20:23], s85 offen offset:0 sc1
    v_cvt_pk_bf16_f32 v168, v168, v169
    v_mfma_f32_32x32x16_bf16 v[192:207], v[104:107], a[212:215], v[192:207]
    v_cvt_pk_bf16_f32 v169, v170, v171
    v_cvt_pk_bf16_f32 v170, v172, v173
    v_cvt_pk_bf16_f32 v171, v174, v175
    v_pk_max_i16 v168, v168, 0 op_sel_hi:[1,0]
    v_pk_max_i16 v169, v169, 0 op_sel_hi:[1,0]
    s_waitcnt lgkmcnt(3)
    v_mfma_f32_32x32x16_bf16 v[192:207], v[116:119], a[216:219], v[192:207]
    v_pk_max_i16 v170, v170, 0 op_sel_hi:[1,0]
    v_pk_max_i16 v171, v171, 0 op_sel_hi:[1,0]
    buffer_store_dwordx4 v[168:171], v236, s[20:23], s85 offen offset:512 sc1
    v_cvt_pk_bf16_f32 v176, v176, v177
    v_cvt_pk_bf16_f32 v177, v178, v179
    v_mfma_f32_32x32x16_bf16 v[192:207], v[128:131], a[220:223], v[192:207]
    v_cvt_pk_bf16_f32 v178, v180, v181
    v_cvt_pk_bf16_f32 v179, v182, v183
    v_pk_max_i16 v176, v176, 0 op_sel_hi:[1,0]
    v_pk_max_i16 v177, v177, 0 op_sel_hi:[1,0]
    v_pk_max_i16 v178, v178, 0 op_sel_hi:[1,0]
    s_waitcnt vmcnt(10) lgkmcnt(0)
    v_mfma_f32_32x32x8_bf16 v[32:47], a[12:13], v[212:213], 0
    v_pk_max_i16 v179, v179, 0 op_sel_hi:[1,0]
    buffer_store_dwordx4 v[176:179], v236, s[20:23], s85 offen offset:1024 sc1
    v_cvt_pk_bf16_f32 v184, v184, v185
    v_cvt_pk_bf16_f32 v185, v186, v187
    v_cvt_pk_bf16_f32 v186, v188, v189
    v_mfma_f32_32x32x16_bf16 v[32:47], a[0:3], v[208:211], v[32:47]
    v_cvt_pk_bf16_f32 v187, v190, v191
    v_pk_max_i16 v184, v184, 0 op_sel_hi:[1,0]
    v_pk_max_i16 v185, v185, 0 op_sel_hi:[1,0]
    v_pk_max_i16 v186, v186, 0 op_sel_hi:[1,0]
    v_pk_max_i16 v187, v187, 0 op_sel_hi:[1,0]
    v_mfma_f32_32x32x8_bf16 v[48:63], a[12:13], v[218:219], 0
    buffer_store_dwordx4 v[184:187], v236, s[20:23], s85 offen offset:1536 sc1
    v_cvt_pk_bf16_f32 v192, v192, v193
    v_cvt_pk_bf16_f32 v193, v194, v195
    v_cvt_pk_bf16_f32 v194, v196, v197
    v_cvt_pk_bf16_f32 v195, v198, v199
    v_mfma_f32_32x32x16_bf16 v[48:63], a[0:3], v[214:217], v[48:63]
    v_pk_max_i16 v192, v192, 0 op_sel_hi:[1,0]
    v_pk_max_i16 v193, v193, 0 op_sel_hi:[1,0]
    v_pk_max_i16 v194, v194, 0 op_sel_hi:[1,0]
    v_pk_max_i16 v195, v195, 0 op_sel_hi:[1,0]
    buffer_store_dwordx4 v[192:195], v236, s[20:23], s85 offen offset:2048 sc1
    v_mfma_f32_32x32x8_bf16 v[96:111], v[30:31], v[30:31], 0
    v_cvt_pk_bf16_f32 v200, v200, v201
    v_cvt_pk_bf16_f32 v201, v202, v203
L_pad4:
    s_cbranch_execz L_pad8
    v_cvt_pk_bf16_f32 v202, v204, v205
    v_cvt_pk_bf16_f32 v203, v206, v207
    v_pk_max_i16 v200, v200, 0 op_sel_hi:[1,0]
    v_mfma_f32_32x32x8_bf16 v[112:127], v[30:31], v[30:31], 0
    v_pk_max_i16 v201, v201, 0 op_sel_hi:[1,0]
    v_pk_max_i16 v202, v202, 0 op_sel_hi:[1,0]
    v_pk_max_i16 v203, v203, 0 op_sel_hi:[1,0]
    buffer_store_dwordx4 v[200:203], v236, s[20:23], s85 offen offset:2560 sc1
    v_mfma_f32_32x32x8_bf16 v[128:143], v[30:31], v[30:31], 0
    v_mfma_f32_32x32x8_bf16 v[144:159], v[30:31], v[30:31], 0
    v_exp_f32 v32, v32
    v_exp_f32 v33, v33
    buffer_load_dwordx4 a[42:45], v6, s[4:7], 0 offen sc1
    buffer_load_dwordx2 a[54:55], v4, s[4:7], 0 offen offset:3072 sc1
    buffer_load_dwordx4 a[46:49], v3, s[4:7], 0 offen offset:1024 sc1
    buffer_load_dwordx4 a[50:53], v3, s[4:7], 0 offen offset:2048 sc1
    v_exp_f32 v34, v34
    v_exp_f32 v35, v35
    v_exp_f32 v36, v36
    v_mfma_f32_32x32x8_bf16 v[64:79], a[12:13], v[224:225], 0
    v_exp_f32 v37, v37
    v_exp_f32 v38, v38
    v_exp_f32 v39, v39
    v_exp_f32 v40, v40
    v_mfma_f32_32x32x16_bf16 v[64:79], a[0:3], v[220:223], v[64:79]
    s_bfe_u32 s96, s68, 0x10003
    v_exp_f32 v41, v41
    v_exp_f32 v42, v42
    v_exp_f32 v43, v43
    v_exp_f32 v44, v44
    v_smfmac_f32_32x32x32_bf16 v[96:111], a[4:7], v[32:39], v2
    s_cmp_eq_u32 s96, 0
    s_cselect_b32 s45, 0, -1
    v_exp_f32 v45, v45
    v_exp_f32 v46, v46
    v_exp_f32 v47, v47
    v_exp_f32 v48, v48
    v_exp_f32 v49, v49
    v_smfmac_f32_32x32x32_bf16 v[96:111], a[8:11], v[40:47], v2
    s_add_u32 s83, s83, 8192
    s_and_b32 s83, s83, 0x3ffff
    v_exp_f32 v50, v50
    v_exp_f32 v51, v51
    v_exp_f32 v52, v52
    v_mfma_f32_32x32x8_bf16 v[80:95], a[12:13], v[230:231], 0
    v_exp_f32 v53, v53
    v_exp_f32 v54, v54
    v_exp_f32 v55, v55
    v_exp_f32 v56, v56
    v_mfma_f32_32x32x16_bf16 v[80:95], a[0:3], v[226:229], v[80:95]
    s_mov_b32 s49, s45
    v_exp_f32 v57, v57
    v_exp_f32 v58, v58
    v_exp_f32 v59, v59
    v_exp_f32 v60, v60
    v_smfmac_f32_32x32x32_bf16 v[112:127], a[4:7], v[48:55], v2
    s_add_u32 s4, s20, s83
    s_addc_u32 s5, s21, 0
    v_exp_f32 v61, v61
    v_exp_f32 v62, v62
    v_exp_f32 v63, v63
    v_exp_f32 v64, v64
    v_exp_f32 v65, v65
    v_smfmac_f32_32x32x32_bf16 v[112:127], a[8:11], v[56:63], v2
    s_waitcnt vmcnt(14)
    v_exp_f32 v66, v66
    v_exp_f32 v67, v67
    v_exp_f32 v68, v68
    v_mfma_f32_32x32x8_bf16 v[32:47], a[26:27], v[212:213], 0
    v_exp_f32 v69, v69
    v_exp_f32 v70, v70
    v_exp_f32 v71, v71
    v_exp_f32 v72, v72
    v_mfma_f32_32x32x16_bf16 v[32:47], a[14:17], v[208:211], v[32:47]
    s_mov_b32 s47, 0
    v_exp_f32 v73, v73
    v_exp_f32 v74, v74
    v_exp_f32 v75, v75
    v_exp_f32 v76, v76
    v_smfmac_f32_32x32x32_bf16 v[128:143], a[4:7], v[64:71], v2
    s_mul_i32 s44, s96, 4294844416
    s_add_u32 s44, s44, 10240
    v_exp_f32 v77, v77
    v_exp_f32 v78, v78
    v_exp_f32 v79, v79
    v_exp_f32 v80, v80
    v_exp_f32 v81, v81
    v_smfmac_f32_32x32x32_bf16 v[128:143], a[8:11], v[72:79], v2
    v_exp_f32 v82, v82
    v_exp_f32 v83, v83
    v_exp_f32 v84, v84
    v_mfma_f32_32x32x8_bf16 v[48:63], a[26:27], v[218:219], 0
    v_exp_f32 v85, v85
    v_exp_f32 v86, v86
    v_exp_f32 v87, v87
    v_exp_f32 v88, v88
    v_mfma_f32_32x32x16_bf16 v[48:63], a[14:17], v[214:217], v[48:63]
    s_mul_i32 s46, s96, 61440
    v_exp_f32 v89, v89
    v_exp_f32 v90, v90
    v_exp_f32 v91, v91
    v_exp_f32 v92, v92
    v_smfmac_f32_32x32x32_bf16 v[144:159], a[4:7], v[80:87], v2
    s_add_u32 s46, s46, 10240
    s_mul_i32 s48, s96, 4294942720
    v_exp_f32 v93, v93
    v_exp_f32 v94, v94
    v_exp_f32 v95, v95
    v_exp_f32 v32, v32
    v_exp_f32 v33, v33
    v_smfmac_f32_32x32x32_bf16 v[144:159], a[8:11], v[88:95], v2
    buffer_load_dwordx4 a[0:3], v6, s[4:7], 0 offen sc1
    buffer_load_dwordx2 a[12:13], v4, s[4:7], 0 offen offset:3072 sc1
    buffer_load_dwordx4 a[4:7], v3, s[4:7], 0 offen offset:1024 sc1
    buffer_load_dwordx4 a[8:11], v3, s[4:7], 0 offen offset:2048 sc1
    buffer_load_dwordx4 a[224:227], v232, s[36:39], 0 offen offset:0
    buffer_load_dwordx4 a[228:231], v232, s[36:39], 0 offen offset:160
    buffer_load_dwordx4 a[232:235], v232, s[36:39], 0 offen offset:320
    buffer_load_dwordx4 a[236:239], v232, s[36:39], 0 offen offset:480
    v_exp_f32 v34, v34
    v_exp_f32 v35, v35
    v_exp_f32 v36, v36
    v_mfma_f32_32x32x8_bf16 v[64:79], a[26:27], v[224:225], 0
    v_exp_f32 v37, v37
    v_exp_f32 v38, v38
    v_exp_f32 v39, v39
    v_exp_f32 v40, v40
    v_mfma_f32_32x32x16_bf16 v[64:79], a[14:17], v[220:223], v[64:79]
    s_add_u32 s48, s48, 4096
    v_exp_f32 v41, v41
    v_exp_f32 v42, v42
    v_exp_f32 v43, v43
    v_exp_f32 v44, v44
    v_smfmac_f32_32x32x32_bf16 v[96:111], a[18:21], v[32:39], v2
    s_mul_i32 s97, s68, 196608
    s_mul_i32 s99, s72, 24576
    v_exp_f32 v45, v45
    v_exp_f32 v46, v46
    v_exp_f32 v47, v47
    v_exp_f32 v48, v48
    v_exp_f32 v49, v49
    v_smfmac_f32_32x32x32_bf16 v[96:111], a[22:25], v[40:47], v2
    s_add_u32 s83, s83, 8192
    s_and_b32 s83, s83, 0x3ffff
    v_exp_f32 v50, v50
    v_exp_f32 v51, v51
    v_exp_f32 v52, v52
    v_mfma_f32_32x32x8_bf16 v[80:95], a[26:27], v[230:231], 0
    v_exp_f32 v53, v53
    v_exp_f32 v54, v54
    v_exp_f32 v55, v55
    v_exp_f32 v56, v56
    v_mfma_f32_32x32x16_bf16 v[80:95], a[14:17], v[226:229], v[80:95]
    s_add_u32 s97, s97, s99
    v_exp_f32 v57, v57
    v_exp_f32 v58, v58
    v_exp_f32 v59, v59
    v_exp_f32 v60, v60
    v_smfmac_f32_32x32x32_bf16 v[112:127], a[18:21], v[48:55], v2
    s_add_u32 s4, s20, s83
    s_addc_u32 s5, s21, 0
    v_exp_f32 v61, v61
    v_exp_f32 v62, v62
    v_exp_f32 v63, v63
    v_exp_f32 v64, v64
    v_exp_f32 v65, v65
    v_smfmac_f32_32x32x32_bf16 v[112:127], a[22:25], v[56:63], v2
    s_waitcnt vmcnt(18)
    v_exp_f32 v66, v66
    v_exp_f32 v67, v67
    v_exp_f32 v68, v68
    v_mfma_f32_32x32x8_bf16 v[32:47], a[40:41], v[212:213], 0
    v_exp_f32 v69, v69
    v_exp_f32 v70, v70
    v_exp_f32 v71, v71
    v_exp_f32 v72, v72
    v_mfma_f32_32x32x16_bf16 v[32:47], a[28:31], v[208:211], v[32:47]
    s_mul_i32 s99, s96, 12288
    v_exp_f32 v73, v73
    v_exp_f32 v74, v74
    v_exp_f32 v75, v75
    v_exp_f32 v76, v76
    v_smfmac_f32_32x32x32_bf16 v[128:143], a[18:21], v[64:71], v2
    s_add_u32 s97, s97, s99
    s_add_u32 s97, s97, 1048576
    v_exp_f32 v77, v77
    v_exp_f32 v78, v78
    v_exp_f32 v79, v79
    v_exp_f32 v80, v80
    v_exp_f32 v81, v81
    v_smfmac_f32_32x32x32_bf16 v[128:143], a[22:25], v[72:79], v2
    buffer_load_dwordx4 a[240:243], v232, s[36:39], 0 offen offset:640
    buffer_load_dwordx4 a[244:247], v232, s[36:39], 0 offen offset:800
    buffer_load_dwordx4 a[248:251], v232, s[36:39], 0 offen offset:960
    buffer_load_dwordx4 a[252:255], v232, s[36:39], 0 offen offset:1120
    v_exp_f32 v82, v82
    v_exp_f32 v83, v83
    v_exp_f32 v84, v84
    v_mfma_f32_32x32x8_bf16 v[48:63], a[40:41], v[218:219], 0
    v_exp_f32 v85, v85
    v_exp_f32 v86, v86
    v_exp_f32 v87, v87
    v_exp_f32 v88, v88
    v_mfma_f32_32x32x16_bf16 v[48:63], a[28:31], v[214:217], v[48:63]
    v_exp_f32 v89, v89
    v_exp_f32 v90, v90
    v_exp_f32 v91, v91
    v_exp_f32 v92, v92
    v_smfmac_f32_32x32x32_bf16 v[144:159], a[18:21], v[80:87], v2
    s_add_u32 s8, s20, s97
    s_addc_u32 s9, s21, 0
    v_exp_f32 v93, v93
    v_exp_f32 v94, v94
    v_exp_f32 v95, v95
    v_exp_f32 v32, v32
    v_exp_f32 v33, v33
    v_smfmac_f32_32x32x32_bf16 v[144:159], a[22:25], v[88:95], v2
    buffer_load_dwordx4 a[14:17], v6, s[4:7], 0 offen sc1
    buffer_load_dwordx2 a[26:27], v4, s[4:7], 0 offen offset:3072 sc1
    buffer_load_dwordx4 a[18:21], v3, s[4:7], 0 offen offset:1024 sc1
    buffer_load_dwordx4 a[22:25], v3, s[4:7], 0 offen offset:2048 sc1
    v_exp_f32 v34, v34
    v_exp_f32 v35, v35
    v_exp_f32 v36, v36
    v_mfma_f32_32x32x8_bf16 v[64:79], a[40:41], v[224:225], 0
    v_exp_f32 v37, v37
    v_exp_f32 v38, v38
    v_exp_f32 v39, v39
    v_exp_f32 v40, v40
    v_mfma_f32_32x32x16_bf16 v[64:79], a[28:31], v[220:223], v[64:79]
    s_mov_b32 s10, 0x100000
    v_exp_f32 v41, v41
    v_exp_f32 v42, v42
    v_exp_f32 v43, v43
    v_exp_f32 v44, v44
    v_smfmac_f32_32x32x32_bf16 v[96:111], a[32:35], v[32:39], v2
    s_mul_i32 s97, s68, 81920
    s_mul_i32 s99, s72, 10240
    v_exp_f32 v45, v45
    v_exp_f32 v46, v46
    v_exp_f32 v47, v47
    v_exp_f32 v48, v48
    v_exp_f32 v49, v49
    v_smfmac_f32_32x32x32_bf16 v[96:111], a[36:39], v[40:47], v2
    s_add_u32 s83, s83, 8192
    s_and_b32 s83, s83, 0x3ffff
    v_exp_f32 v50, v50
    v_exp_f32 v51, v51
    v_exp_f32 v52, v52
    v_mfma_f32_32x32x8_bf16 v[80:95], a[40:41], v[230:231], 0
    v_exp_f32 v53, v53
    v_exp_f32 v54, v54
    v_exp_f32 v55, v55
    v_exp_f32 v56, v56
    v_mfma_f32_32x32x16_bf16 v[80:95], a[28:31], v[226:229], v[80:95]
    s_add_u32 s97, s97, s99
    v_exp_f32 v57, v57
    v_exp_f32 v58, v58
    v_exp_f32 v59, v59
    v_exp_f32 v60, v60
    v_smfmac_f32_32x32x32_bf16 v[112:127], a[32:35], v[48:55], v2
    s_add_u32 s4, s20, s83
    s_addc_u32 s5, s21, 0
    v_exp_f32 v61, v61
    v_exp_f32 v62, v62
    v_exp_f32 v63, v63
    v_exp_f32 v64, v64
    v_exp_f32 v65, v65
    v_smfmac_f32_32x32x32_bf16 v[112:127], a[36:39], v[56:63], v2
    s_waitcnt vmcnt(16)
    v_exp_f32 v66, v66
    v_exp_f32 v67, v67
    v_exp_f32 v68, v68
    v_mfma_f32_32x32x8_bf16 v[32:47], a[54:55], v[212:213], 0
    v_exp_f32 v69, v69
    v_exp_f32 v70, v70
    v_exp_f32 v71, v71
    v_exp_f32 v72, v72
    v_mfma_f32_32x32x16_bf16 v[32:47], a[42:45], v[208:211], v[32:47]
    s_add_u32 s97, s97, 8388608
    v_exp_f32 v73, v73
    v_exp_f32 v74, v74
    v_exp_f32 v75, v75
    v_exp_f32 v76, v76
    v_smfmac_f32_32x32x32_bf16 v[128:143], a[32:35], v[64:71], v2
    s_add_u32 s32, s20, s97
    s_addc_u32 s33, s21, 0
    v_exp_f32 v77, v77
    v_exp_f32 v78, v78
    v_exp_f32 v79, v79
    v_exp_f32 v80, v80
    v_exp_f32 v81, v81
    v_smfmac_f32_32x32x32_bf16 v[128:143], a[36:39], v[72:79], v2
    v_exp_f32 v82, v82
    v_exp_f32 v83, v83
    v_exp_f32 v84, v84
    v_mfma_f32_32x32x8_bf16 v[48:63], a[54:55], v[218:219], 0
    v_exp_f32 v85, v85
    v_exp_f32 v86, v86
    v_exp_f32 v87, v87
    v_exp_f32 v88, v88
    v_mfma_f32_32x32x16_bf16 v[48:63], a[42:45], v[214:217], v[48:63]
    s_mov_b32 s34, 0x100000
    v_exp_f32 v89, v89
    v_exp_f32 v90, v90
    v_exp_f32 v91, v91
    v_exp_f32 v92, v92
    v_smfmac_f32_32x32x32_bf16 v[144:159], a[32:35], v[80:87], v2
    s_mul_i32 s97, s69, 348160
    s_mul_i32 s99, s72, 174080
    v_exp_f32 v93, v93
    v_exp_f32 v94, v94
    v_exp_f32 v95, v95
    v_exp_f32 v32, v32
    v_exp_f32 v33, v33
    v_smfmac_f32_32x32x32_bf16 v[144:159], a[36:39], v[88:95], v2
    buffer_load_dwordx4 a[28:31], v6, s[4:7], 0 offen sc1
    buffer_load_dwordx2 a[40:41], v4, s[4:7], 0 offen offset:3072 sc1
    buffer_load_dwordx4 a[32:35], v3, s[4:7], 0 offen offset:1024 sc1
    buffer_load_dwordx4 a[36:39], v3, s[4:7], 0 offen offset:2048 sc1
    v_exp_f32 v34, v34
    v_exp_f32 v35, v35
    v_exp_f32 v36, v36
    v_mfma_f32_32x32x8_bf16 v[64:79], a[54:55], v[224:225], 0
    v_exp_f32 v37, v37
    v_exp_f32 v38, v38
    v_exp_f32 v39, v39
    v_exp_f32 v40, v40
    v_mfma_f32_32x32x16_bf16 v[64:79], a[42:45], v[220:223], v[64:79]
    s_add_u32 s97, s97, s99
    v_exp_f32 v41, v41
    v_exp_f32 v42, v42
    v_exp_f32 v43, v43
    v_exp_f32 v44, v44
    v_smfmac_f32_32x32x32_bf16 v[96:111], a[46:49], v[32:39], v2
    s_mul_i32 s99, s71, 5120
    s_add_u32 s97, s97, s99
    v_exp_f32 v45, v45
    v_exp_f32 v46, v46
    v_exp_f32 v47, v47
    v_exp_f32 v48, v48
    v_exp_f32 v49, v49
    v_smfmac_f32_32x32x32_bf16 v[96:111], a[50:53], v[40:47], v2
    s_add_u32 s83, s83, 8192
    s_and_b32 s83, s83, 0x3ffff
    v_exp_f32 v50, v50
    v_exp_f32 v51, v51
    v_exp_f32 v52, v52
    v_mfma_f32_32x32x8_bf16 v[80:95], a[54:55], v[230:231], 0
    v_exp_f32 v53, v53
    v_exp_f32 v54, v54
    v_exp_f32 v55, v55
    v_exp_f32 v56, v56
    v_mfma_f32_32x32x16_bf16 v[80:95], a[42:45], v[226:229], v[80:95]
    s_mul_i32 s99, s96, 61440
    v_exp_f32 v57, v57
    v_exp_f32 v58, v58
    v_exp_f32 v59, v59
    v_exp_f32 v60, v60
    v_smfmac_f32_32x32x32_bf16 v[112:127], a[46:49], v[48:55], v2
    s_add_u32 s4, s20, s83
    s_addc_u32 s5, s21, 0
    v_exp_f32 v61, v61
    v_exp_f32 v62, v62
    v_exp_f32 v63, v63
    v_exp_f32 v64, v64
    v_exp_f32 v65, v65
    v_smfmac_f32_32x32x32_bf16 v[112:127], a[50:53], v[56:63], v2
    s_waitcnt vmcnt(16)
    v_exp_f32 v66, v66
    v_exp_f32 v67, v67
    v_exp_f32 v68, v68
    v_mfma_f32_32x32x8_bf16 v[32:47], a[12:13], v[212:213], 0
    v_exp_f32 v69, v69
    v_exp_f32 v70, v70
    v_exp_f32 v71, v71
    v_exp_f32 v72, v72
    v_mfma_f32_32x32x16_bf16 v[32:47], a[0:3], v[208:211], v[32:47]
    s_add_u32 s97, s97, s99
    v_exp_f32 v73, v73
    v_exp_f32 v74, v74
    v_exp_f32 v75, v75
    v_exp_f32 v76, v76
    v_smfmac_f32_32x32x32_bf16 v[128:143], a[46:49], v[64:71], v2
    s_add_u32 s97, s97, 12582912
    v_exp_f32 v77, v77
    v_exp_f32 v78, v78
    v_exp_f32 v79, v79
    v_exp_f32 v80, v80
    v_exp_f32 v81, v81
    v_smfmac_f32_32x32x32_bf16 v[128:143], a[50:53], v[72:79], v2
    v_exp_f32 v82, v82
    v_exp_f32 v83, v83
    v_exp_f32 v84, v84
    v_mfma_f32_32x32x8_bf16 v[48:63], a[12:13], v[218:219], 0
    v_exp_f32 v85, v85
    v_exp_f32 v86, v86
    v_exp_f32 v87, v87
    v_exp_f32 v88, v88
    v_mfma_f32_32x32x16_bf16 v[48:63], a[0:3], v[214:217], v[48:63]
    v_exp_f32 v89, v89
    v_exp_f32 v90, v90
    v_exp_f32 v91, v91
    v_exp_f32 v92, v92
    v_smfmac_f32_32x32x32_bf16 v[144:159], a[46:49], v[80:87], v2
    s_add_u32 s12, s20, s97
    s_addc_u32 s13, s21, 0
    v_exp_f32 v93, v93
    v_exp_f32 v94, v94
    v_exp_f32 v95, v95
    v_exp_f32 v32, v32
    v_exp_f32 v33, v33
    v_smfmac_f32_32x32x32_bf16 v[144:159], a[50:53], v[88:95], v2
    buffer_load_dwordx4 a[42:45], v6, s[4:7], 0 offen sc1
    buffer_load_dwordx2 a[54:55], v4, s[4:7], 0 offen offset:3072 sc1
    buffer_load_dwordx4 a[46:49], v3, s[4:7], 0 offen offset:1024 sc1
    buffer_load_dwordx4 a[50:53], v3, s[4:7], 0 offen offset:2048 sc1
    v_exp_f32 v34, v34
    v_exp_f32 v35, v35
    v_exp_f32 v36, v36
    v_mfma_f32_32x32x8_bf16 v[64:79], a[12:13], v[224:225], 0
    v_exp_f32 v37, v37
    v_exp_f32 v38, v38
    v_exp_f32 v39, v39
    v_exp_f32 v40, v40
    v_mfma_f32_32x32x16_bf16 v[64:79], a[0:3], v[220:223], v[64:79]
    s_mov_b32 s14, 0x100000
    v_exp_f32 v41, v41
    v_exp_f32 v42, v42
    v_exp_f32 v43, v43
    v_exp_f32 v44, v44
    v_smfmac_f32_32x32x32_bf16 v[96:111], a[4:7], v[32:39], v2
    s_mul_i32 s80, s72, 61440
    s_mul_i32 s99, s71, 5120
    v_exp_f32 v45, v45
    v_exp_f32 v46, v46
    v_exp_f32 v47, v47
    v_exp_f32 v48, v48
    v_exp_f32 v49, v49
    v_smfmac_f32_32x32x32_bf16 v[96:111], a[8:11], v[40:47], v2
    s_add_u32 s83, s83, 8192
    s_and_b32 s83, s83, 0x3ffff
    v_exp_f32 v50, v50
    v_exp_f32 v51, v51
    v_exp_f32 v52, v52
    v_mfma_f32_32x32x8_bf16 v[80:95], a[12:13], v[230:231], 0
    v_exp_f32 v53, v53
    v_exp_f32 v54, v54
    v_exp_f32 v55, v55
    v_exp_f32 v56, v56
    v_mfma_f32_32x32x16_bf16 v[80:95], a[0:3], v[226:229], v[80:95]
    s_add_u32 s80, s80, s99
    v_exp_f32 v57, v57
    v_exp_f32 v58, v58
    v_exp_f32 v59, v59
    v_exp_f32 v60, v60
    v_smfmac_f32_32x32x32_bf16 v[112:127], a[4:7], v[48:55], v2
    s_add_u32 s4, s20, s83
    s_addc_u32 s5, s21, 0
    v_exp_f32 v61, v61
    v_exp_f32 v62, v62
    v_exp_f32 v63, v63
    v_exp_f32 v64, v64
    v_exp_f32 v65, v65
    v_smfmac_f32_32x32x32_bf16 v[112:127], a[8:11], v[56:63], v2
    s_waitcnt vmcnt(8)
    v_exp_f32 v66, v66
    v_exp_f32 v67, v67
    v_exp_f32 v68, v68
    v_mfma_f32_32x32x8_bf16 v[32:47], a[26:27], v[212:213], 0
    v_exp_f32 v69, v69
    v_exp_f32 v70, v70
    v_exp_f32 v71, v71
    v_exp_f32 v72, v72
    v_mfma_f32_32x32x16_bf16 v[32:47], a[14:17], v[208:211], v[32:47]
    s_mul_i32 s82, s72, 10240
    v_exp_f32 v73, v73
    v_exp_f32 v74, v74
    v_exp_f32 v75, v75
    v_exp_f32 v76, v76
    v_smfmac_f32_32x32x32_bf16 v[128:143], a[4:7], v[64:71], v2
    s_mul_i32 s99, s71, 5120
    s_add_u32 s82, s82, s99
    v_exp_f32 v77, v77
    v_exp_f32 v78, v78
    v_exp_f32 v79, v79
    v_exp_f32 v80, v80
    v_exp_f32 v81, v81
    v_smfmac_f32_32x32x32_bf16 v[128:143], a[8:11], v[72:79], v2
    v_exp_f32 v82, v82
    v_exp_f32 v83, v83
    v_exp_f32 v84, v84
    v_mfma_f32_32x32x8_bf16 v[48:63], a[26:27], v[218:219], 0
    v_exp_f32 v85, v85
    v_exp_f32 v86, v86
    v_exp_f32 v87, v87
    v_exp_f32 v88, v88
    v_mfma_f32_32x32x16_bf16 v[48:63], a[14:17], v[214:217], v[48:63]
    s_add_u32 s82, s82, 125952
    v_exp_f32 v89, v89
    v_exp_f32 v90, v90
    v_exp_f32 v91, v91
    v_exp_f32 v92, v92
    v_smfmac_f32_32x32x32_bf16 v[144:159], a[4:7], v[80:87], v2
    s_mul_i32 s87, s68, 128
    s_mul_i32 s99, s72, 16
    v_exp_f32 v93, v93
    v_exp_f32 v94, v94
    v_exp_f32 v95, v95
    v_exp_f32 v32, v32
    v_exp_f32 v33, v33
    v_smfmac_f32_32x32x32_bf16 v[144:159], a[8:11], v[88:95], v2
    buffer_load_dwordx4 a[0:3], v6, s[4:7], 0 offen sc1
    buffer_load_dwordx2 a[12:13], v4, s[4:7], 0 offen offset:3072 sc1
    buffer_load_dwordx4 a[4:7], v3, s[4:7], 0 offen offset:1024 sc1
    buffer_load_dwordx4 a[8:11], v3, s[4:7], 0 offen offset:2048 sc1
    buffer_store_dwordx4 a[224:227], v233, s[40:43], 0 offen sc1
    buffer_store_dwordx4 a[228:231], v234, s[40:43], 0 offen sc1
    buffer_store_dwordx4 a[232:235], v235, s[40:43], 0 offen sc1
    buffer_store_dwordx4 a[236:239], v250, s[40:43], 0 offen sc1
    v_exp_f32 v34, v34
    v_exp_f32 v35, v35
    v_exp_f32 v36, v36
    v_mfma_f32_32x32x8_bf16 v[64:79], a[26:27], v[224:225], 0
    v_exp_f32 v37, v37
    v_exp_f32 v38, v38
    v_exp_f32 v39, v39
    v_exp_f32 v40, v40
    v_mfma_f32_32x32x16_bf16 v[64:79], a[14:17], v[220:223], v[64:79]
    s_add_u32 s87, s87, s99
    v_exp_f32 v41, v41
    v_exp_f32 v42, v42
    v_exp_f32 v43, v43
    v_exp_f32 v44, v44
    v_smfmac_f32_32x32x32_bf16 v[96:111], a[18:21], v[32:39], v2
    s_add_u32 s87, s87, 16777216
    s_mul_i32 s88, s68, 128
    v_exp_f32 v45, v45
    v_exp_f32 v46, v46
    v_exp_f32 v47, v47
    v_exp_f32 v48, v48
    v_exp_f32 v49, v49
    v_smfmac_f32_32x32x32_bf16 v[96:111], a[22:25], v[40:47], v2
    s_add_u32 s83, s83, 8192
    s_and_b32 s83, s83, 0x3ffff
    v_exp_f32 v50, v50
    v_exp_f32 v51, v51
    v_exp_f32 v52, v52
    v_mfma_f32_32x32x8_bf16 v[80:95], a[26:27], v[230:231], 0
    v_exp_f32 v53, v53
    v_exp_f32 v54, v54
    v_exp_f32 v55, v55
    v_exp_f32 v56, v56
    v_mfma_f32_32x32x16_bf16 v[80:95], a[14:17], v[226:229], v[80:95]
    s_mul_i32 s99, s69, 4
    v_exp_f32 v57, v57
    v_exp_f32 v58, v58
    v_exp_f32 v59, v59
    v_exp_f32 v60, v60
    v_smfmac_f32_32x32x32_bf16 v[112:127], a[18:21], v[48:55], v2
    s_add_u32 s4, s20, s83
    s_addc_u32 s5, s21, 0
    v_exp_f32 v61, v61
    v_exp_f32 v62, v62
    v_exp_f32 v63, v63
    v_exp_f32 v64, v64
    v_exp_f32 v65, v65
    v_smfmac_f32_32x32x32_bf16 v[112:127], a[22:25], v[56:63], v2
    s_waitcnt vmcnt(12)
    v_exp_f32 v66, v66
    v_exp_f32 v67, v67
    v_exp_f32 v68, v68
    v_mfma_f32_32x32x8_bf16 v[32:47], a[40:41], v[212:213], 0
    v_exp_f32 v69, v69
    v_exp_f32 v70, v70
    v_exp_f32 v71, v71
    v_exp_f32 v72, v72
    v_mfma_f32_32x32x16_bf16 v[32:47], a[28:31], v[208:211], v[32:47]
    s_add_u32 s88, s88, s99
    v_exp_f32 v73, v73
    v_exp_f32 v74, v74
    v_exp_f32 v75, v75
    v_exp_f32 v76, v76
    v_smfmac_f32_32x32x32_bf16 v[128:143], a[18:21], v[64:71], v2
    s_add_u32 s88, s88, 16777216
    s_mul_i32 s86, s68, 81920
    v_exp_f32 v77, v77
    v_exp_f32 v78, v78
    v_exp_f32 v79, v79
    v_exp_f32 v80, v80
    v_exp_f32 v81, v81
    v_smfmac_f32_32x32x32_bf16 v[128:143], a[22:25], v[72:79], v2
    buffer_store_dwordx4 a[240:243], v251, s[40:43], 0 offen sc1
    buffer_store_dwordx4 a[244:247], v252, s[40:43], 0 offen sc1
    buffer_store_dwordx4 a[248:251], v253, s[40:43], 0 offen sc1
    buffer_store_dwordx4 a[252:255], v254, s[40:43], 0 offen sc1
    v_exp_f32 v82, v82
    v_exp_f32 v83, v83
    v_exp_f32 v84, v84
    v_mfma_f32_32x32x8_bf16 v[48:63], a[40:41], v[218:219], 0
    v_exp_f32 v85, v85
    v_exp_f32 v86, v86
    v_exp_f32 v87, v87
    v_exp_f32 v88, v88
    v_mfma_f32_32x32x16_bf16 v[48:63], a[28:31], v[214:217], v[48:63]
    s_mul_i32 s99, s71, 40960
    v_exp_f32 v89, v89
    v_exp_f32 v90, v90
    v_exp_f32 v91, v91
    v_exp_f32 v92, v92
    v_smfmac_f32_32x32x32_bf16 v[144:159], a[18:21], v[80:87], v2
    s_add_u32 s86, s86, s99
    s_mul_i32 s99, s69, 2560
    v_exp_f32 v93, v93
    v_exp_f32 v94, v94
    v_exp_f32 v95, v95
    v_exp_f32 v32, v32
    v_exp_f32 v33, v33
    v_smfmac_f32_32x32x32_bf16 v[144:159], a[22:25], v[88:95], v2
    buffer_load_dwordx4 a[14:17], v6, s[4:7], 0 offen sc1
    buffer_load_dwordx2 a[26:27], v4, s[4:7], 0 offen offset:3072 sc1
    buffer_load_dwordx4 a[18:21], v3, s[4:7], 0 offen offset:1024 sc1
    buffer_load_dwordx4 a[22:25], v3, s[4:7], 0 offen offset:2048 sc1
    v_exp_f32 v34, v34
    v_exp_f32 v35, v35
    v_exp_f32 v36, v36
    v_mfma_f32_32x32x8_bf16 v[64:79], a[40:41], v[224:225], 0
    v_exp_f32 v37, v37
    v_exp_f32 v38, v38
    v_exp_f32 v39, v39
    v_exp_f32 v40, v40
    v_mfma_f32_32x32x16_bf16 v[64:79], a[28:31], v[220:223], v[64:79]
    s_add_u32 s86, s86, s99
    v_exp_f32 v41, v41
    v_exp_f32 v42, v42
    v_exp_f32 v43, v43
    v_exp_f32 v44, v44
    v_smfmac_f32_32x32x32_bf16 v[96:111], a[32:35], v[32:39], v2
    s_mul_i32 s99, s72, 1280
    s_add_u32 s86, s86, s99
    v_exp_f32 v45, v45
    v_exp_f32 v46, v46
    v_exp_f32 v47, v47
    v_exp_f32 v48, v48
    v_exp_f32 v49, v49
    v_smfmac_f32_32x32x32_bf16 v[96:111], a[36:39], v[40:47], v2
    s_add_u32 s83, s83, 8192
    s_and_b32 s83, s83, 0x3ffff
    v_exp_f32 v50, v50
    v_exp_f32 v51, v51
    v_exp_f32 v52, v52
    v_mfma_f32_32x32x8_bf16 v[80:95], a[40:41], v[230:231], 0
    v_exp_f32 v53, v53
    v_exp_f32 v54, v54
    v_exp_f32 v55, v55
    v_exp_f32 v56, v56
    v_mfma_f32_32x32x16_bf16 v[80:95], a[28:31], v[226:229], v[80:95]
    s_add_u32 s86, s86, 8388608
    v_exp_f32 v57, v57
    v_exp_f32 v58, v58
    v_exp_f32 v59, v59
    v_exp_f32 v60, v60
    v_smfmac_f32_32x32x32_bf16 v[112:127], a[32:35], v[48:55], v2
    s_add_u32 s4, s20, s83
    s_addc_u32 s5, s21, 0
    v_exp_f32 v61, v61
    v_exp_f32 v62, v62
    v_exp_f32 v63, v63
    v_exp_f32 v64, v64
    v_exp_f32 v65, v65
    v_smfmac_f32_32x32x32_bf16 v[112:127], a[36:39], v[56:63], v2
    s_waitcnt vmcnt(16)
    v_exp_f32 v66, v66
    v_exp_f32 v67, v67
    v_exp_f32 v68, v68
    v_mfma_f32_32x32x8_bf16 v[32:47], a[54:55], v[212:213], 0
    v_exp_f32 v69, v69
    v_exp_f32 v70, v70
    v_exp_f32 v71, v71
    v_exp_f32 v72, v72
    v_mfma_f32_32x32x16_bf16 v[32:47], a[42:45], v[208:211], v[32:47]
    s_mul_i32 s79, s68, 81920
    v_exp_f32 v73, v73
    v_exp_f32 v74, v74
    v_exp_f32 v75, v75
    v_exp_f32 v76, v76
    v_smfmac_f32_32x32x32_bf16 v[128:143], a[32:35], v[64:71], v2
    s_mul_i32 s99, s71, 40960
    s_add_u32 s79, s79, s99
    v_exp_f32 v77, v77
    v_exp_f32 v78, v78
    v_exp_f32 v79, v79
    v_exp_f32 v80, v80
    v_exp_f32 v81, v81
    v_smfmac_f32_32x32x32_bf16 v[128:143], a[36:39], v[72:79], v2
    v_exp_f32 v82, v82
    v_exp_f32 v83, v83
    v_exp_f32 v84, v84
    v_mfma_f32_32x32x8_bf16 v[48:63], a[54:55], v[218:219], 0
    v_exp_f32 v85, v85
    v_exp_f32 v86, v86
    v_exp_f32 v87, v87
    v_exp_f32 v88, v88
    v_mfma_f32_32x32x16_bf16 v[48:63], a[42:45], v[214:217], v[48:63]
    s_mul_i32 s99, s72, 20480
    v_exp_f32 v89, v89
    v_exp_f32 v90, v90
    v_exp_f32 v91, v91
    v_exp_f32 v92, v92
    v_smfmac_f32_32x32x32_bf16 v[144:159], a[32:35], v[80:87], v2
    s_add_u32 s79, s79, s99
    s_mul_i32 s99, s69, 160
    v_exp_f32 v93, v93
    v_exp_f32 v94, v94
    v_exp_f32 v95, v95
    v_exp_f32 v32, v32
    v_exp_f32 v33, v33
    v_smfmac_f32_32x32x32_bf16 v[144:159], a[36:39], v[88:95], v2
    buffer_load_dwordx4 a[28:31], v6, s[4:7], 0 offen sc1
    buffer_load_dwordx2 a[40:41], v4, s[4:7], 0 offen offset:3072 sc1
    buffer_load_dwordx4 a[32:35], v3, s[4:7], 0 offen offset:1024 sc1
    buffer_load_dwordx4 a[36:39], v3, s[4:7], 0 offen offset:2048 sc1
    v_exp_f32 v34, v34
    v_exp_f32 v35, v35
    v_exp_f32 v36, v36
    v_mfma_f32_32x32x8_bf16 v[64:79], a[54:55], v[224:225], 0
    v_exp_f32 v37, v37
    v_exp_f32 v38, v38
    v_exp_f32 v39, v39
    v_exp_f32 v40, v40
    v_mfma_f32_32x32x16_bf16 v[64:79], a[42:45], v[220:223], v[64:79]
    s_add_u32 s79, s79, s99
    v_exp_f32 v41, v41
    v_exp_f32 v42, v42
    v_exp_f32 v43, v43
    v_exp_f32 v44, v44
    v_smfmac_f32_32x32x32_bf16 v[96:111], a[46:49], v[32:39], v2
    s_lshr_b32 s96, s68, 3
    s_mul_i32 s54, s69, 348160
    v_exp_f32 v45, v45
    v_exp_f32 v46, v46
    v_exp_f32 v47, v47
    v_exp_f32 v48, v48
    v_exp_f32 v49, v49
    v_smfmac_f32_32x32x32_bf16 v[96:111], a[50:53], v[40:47], v2
    s_add_u32 s83, s83, 8192
    s_and_b32 s83, s83, 0x3ffff
    v_exp_f32 v50, v50
    v_exp_f32 v51, v51
    v_exp_f32 v52, v52
    v_mfma_f32_32x32x8_bf16 v[80:95], a[54:55], v[230:231], 0
    v_exp_f32 v53, v53
    v_exp_f32 v54, v54
    v_exp_f32 v55, v55
    v_exp_f32 v56, v56
    v_mfma_f32_32x32x16_bf16 v[80:95], a[42:45], v[226:229], v[80:95]
    s_mul_i32 s99, s72, 174080
    v_exp_f32 v57, v57
    v_exp_f32 v58, v58
    v_exp_f32 v59, v59
    v_exp_f32 v60, v60
    v_smfmac_f32_32x32x32_bf16 v[112:127], a[46:49], v[48:55], v2
    s_add_u32 s4, s20, s83
    s_addc_u32 s5, s21, 0
    v_exp_f32 v61, v61
    v_exp_f32 v62, v62
    v_exp_f32 v63, v63
    v_exp_f32 v64, v64
    v_exp_f32 v65, v65
    v_smfmac_f32_32x32x32_bf16 v[112:127], a[50:53], v[56:63], v2
    s_waitcnt vmcnt(16)
    v_exp_f32 v66, v66
    v_exp_f32 v67, v67
    v_exp_f32 v68, v68
    v_mfma_f32_32x32x8_bf16 v[32:47], a[12:13], v[212:213], 0
    v_exp_f32 v69, v69
    v_exp_f32 v70, v70
    v_exp_f32 v71, v71
    v_exp_f32 v72, v72
    v_mfma_f32_32x32x16_bf16 v[32:47], a[0:3], v[208:211], v[32:47]
    s_add_u32 s54, s54, s99
    v_exp_f32 v73, v73
    v_exp_f32 v74, v74
    v_exp_f32 v75, v75
    v_exp_f32 v76, v76
L_pad5:
    s_cbranch_execz L_pad9
    v_smfmac_f32_32x32x32_bf16 v[128:143], a[46:49], v[64:71], v2
    s_mul_i32 s99, s96, 12800
    s_add_u32 s54, s54, s99
    v_exp_f32 v77, v77
    v_exp_f32 v78, v78
    v_exp_f32 v79, v79
    v_exp_f32 v80, v80
    v_exp_f32 v81, v81
    v_smfmac_f32_32x32x32_bf16 v[128:143], a[50:53], v[72:79], v2
    v_exp_f32 v82, v82
    v_exp_f32 v83, v83
    v_exp_f32 v84, v84
    v_mfma_f32_32x32x8_bf16 v[48:63], a[12:13], v[218:219], 0
    v_exp_f32 v85, v85
    v_exp_f32 v86, v86
    v_exp_f32 v87, v87
    v_exp_f32 v88, v88
    v_mfma_f32_32x32x16_bf16 v[48:63], a[0:3], v[214:217], v[48:63]
    s_mul_i32 s99, s71, 6400
    v_exp_f32 v89, v89
    v_exp_f32 v90, v90
    v_exp_f32 v91, v91
    v_exp_f32 v92, v92
    v_smfmac_f32_32x32x32_bf16 v[144:159], a[46:49], v[80:87], v2
    s_add_u32 s54, s54, s99
    s_add_u32 s54, s54, 12705792
    v_exp_f32 v93, v93
    v_exp_f32 v94, v94
    v_exp_f32 v95, v95
    v_exp_f32 v32, v32
    v_exp_f32 v33, v33
    v_smfmac_f32_32x32x32_bf16 v[144:159], a[50:53], v[88:95], v2
    buffer_load_dwordx4 a[42:45], v6, s[4:7], 0 offen sc1
    buffer_load_dwordx2 a[54:55], v4, s[4:7], 0 offen offset:3072 sc1
    buffer_load_dwordx4 a[46:49], v3, s[4:7], 0 offen offset:1024 sc1
    buffer_load_dwordx4 a[50:53], v3, s[4:7], 0 offen offset:2048 sc1
    v_exp_f32 v34, v34
    v_exp_f32 v35, v35
    v_exp_f32 v36, v36
    v_mfma_f32_32x32x8_bf16 v[64:79], a[12:13], v[224:225], 0
    v_exp_f32 v37, v37
    v_exp_f32 v38, v38
    v_exp_f32 v39, v39
    v_exp_f32 v40, v40
    v_mfma_f32_32x32x16_bf16 v[64:79], a[0:3], v[220:223], v[64:79]
    v_exp_f32 v41, v41
    v_exp_f32 v42, v42
    v_exp_f32 v43, v43
    v_exp_f32 v44, v44
    v_smfmac_f32_32x32x32_bf16 v[96:111], a[4:7], v[32:39], v2
    v_exp_f32 v45, v45
    v_exp_f32 v46, v46
    v_exp_f32 v47, v47
    v_exp_f32 v48, v48
    v_exp_f32 v49, v49
    v_smfmac_f32_32x32x32_bf16 v[96:111], a[8:11], v[40:47], v2
    s_add_u32 s83, s83, 8192
    s_and_b32 s83, s83, 0x3ffff
    v_mov_b32 v30, 125696
    v_mov_b32 v31, 1
    v_exp_f32 v50, v50
    v_exp_f32 v51, v51
    v_exp_f32 v52, v52
    v_mfma_f32_32x32x8_bf16 v[80:95], a[12:13], v[230:231], 0
    v_exp_f32 v53, v53
    v_exp_f32 v54, v54
    v_exp_f32 v55, v55
    v_exp_f32 v56, v56
    v_mfma_f32_32x32x16_bf16 v[80:95], a[0:3], v[226:229], v[80:95]
    v_exp_f32 v57, v57
    v_exp_f32 v58, v58
    v_exp_f32 v59, v59
    v_exp_f32 v60, v60
    v_smfmac_f32_32x32x32_bf16 v[112:127], a[4:7], v[48:55], v2
    s_add_u32 s4, s20, s83
    s_addc_u32 s5, s21, 0
    v_exp_f32 v61, v61
    v_exp_f32 v62, v62
    v_exp_f32 v63, v63
    v_exp_f32 v64, v64
    v_exp_f32 v65, v65
    v_smfmac_f32_32x32x32_bf16 v[112:127], a[8:11], v[56:63], v2
    s_waitcnt vmcnt(8)
    s_mov_b64 exec, 1
    ds_add_rtn_u32 v30, v30, v31
    s_mov_b64 exec, -1
    v_exp_f32 v66, v66
    v_exp_f32 v67, v67
    v_exp_f32 v68, v68
    v_mfma_f32_32x32x8_bf16 v[32:47], a[26:27], v[212:213], 0
    v_exp_f32 v69, v69
    v_exp_f32 v70, v70
    v_exp_f32 v71, v71
    v_exp_f32 v72, v72
    v_mfma_f32_32x32x16_bf16 v[32:47], a[14:17], v[208:211], v[32:47]
    v_exp_f32 v73, v73
    v_exp_f32 v74, v74
    v_exp_f32 v75, v75
    v_exp_f32 v76, v76
    v_smfmac_f32_32x32x32_bf16 v[128:143], a[4:7], v[64:71], v2
    v_exp_f32 v77, v77
    v_exp_f32 v78, v78
    v_exp_f32 v79, v79
    v_exp_f32 v80, v80
    v_exp_f32 v81, v81
    v_smfmac_f32_32x32x32_bf16 v[128:143], a[8:11], v[72:79], v2
    v_exp_f32 v82, v82
    v_exp_f32 v83, v83
    v_exp_f32 v84, v84
    v_mfma_f32_32x32x8_bf16 v[48:63], a[26:27], v[218:219], 0
    v_exp_f32 v85, v85
    v_exp_f32 v86, v86
    v_exp_f32 v87, v87
    v_exp_f32 v88, v88
    v_mfma_f32_32x32x16_bf16 v[48:63], a[14:17], v[214:217], v[48:63]
    v_exp_f32 v89, v89
    v_exp_f32 v90, v90
    v_exp_f32 v91, v91
    v_exp_f32 v92, v92
    v_smfmac_f32_32x32x32_bf16 v[144:159], a[4:7], v[80:87], v2
    v_exp_f32 v93, v93
    v_exp_f32 v94, v94
    v_exp_f32 v95, v95
    v_exp_f32 v32, v32
    v_exp_f32 v33, v33
    v_smfmac_f32_32x32x32_bf16 v[144:159], a[8:11], v[88:95], v2
    buffer_load_dwordx4 a[0:3], v6, s[4:7], 0 offen sc1
    buffer_load_dwordx2 a[12:13], v4, s[4:7], 0 offen offset:3072 sc1
    buffer_load_dwordx4 a[4:7], v3, s[4:7], 0 offen offset:1024 sc1
    buffer_load_dwordx4 a[8:11], v3, s[4:7], 0 offen offset:2048 sc1
    v_exp_f32 v34, v34
    v_exp_f32 v35, v35
    v_exp_f32 v36, v36
    v_mfma_f32_32x32x8_bf16 v[64:79], a[26:27], v[224:225], 0
    v_exp_f32 v37, v37
    v_exp_f32 v38, v38
    v_exp_f32 v39, v39
    v_exp_f32 v40, v40
    v_mfma_f32_32x32x16_bf16 v[64:79], a[14:17], v[220:223], v[64:79]
    v_exp_f32 v41, v41
    v_exp_f32 v42, v42
    v_exp_f32 v43, v43
    v_exp_f32 v44, v44
    v_smfmac_f32_32x32x32_bf16 v[96:111], a[18:21], v[32:39], v2
    v_exp_f32 v45, v45
    v_exp_f32 v46, v46
    v_exp_f32 v47, v47
    v_exp_f32 v48, v48
    v_exp_f32 v49, v49
    v_smfmac_f32_32x32x32_bf16 v[96:111], a[22:25], v[40:47], v2
    s_add_u32 s83, s83, 8192
    s_and_b32 s83, s83, 0x3ffff
    v_exp_f32 v50, v50
    v_exp_f32 v51, v51
    v_exp_f32 v52, v52
    v_mfma_f32_32x32x8_bf16 v[80:95], a[26:27], v[230:231], 0
    v_exp_f32 v53, v53
    v_exp_f32 v54, v54
    v_exp_f32 v55, v55
    v_exp_f32 v56, v56
    v_mfma_f32_32x32x16_bf16 v[80:95], a[14:17], v[226:229], v[80:95]
    v_exp_f32 v57, v57
    v_exp_f32 v58, v58
    v_exp_f32 v59, v59
    v_exp_f32 v60, v60
    v_smfmac_f32_32x32x32_bf16 v[112:127], a[18:21], v[48:55], v2
    s_add_u32 s4, s20, s83
    s_addc_u32 s5, s21, 0
    v_exp_f32 v61, v61
    v_exp_f32 v62, v62
    v_exp_f32 v63, v63
    v_exp_f32 v64, v64
    v_exp_f32 v65, v65
    v_smfmac_f32_32x32x32_bf16 v[112:127], a[22:25], v[56:63], v2
    s_waitcnt vmcnt(8)
    s_waitcnt lgkmcnt(0)
    v_readfirstlane_b32 s98, v30
    s_lshl_b32 s96, s68, 1
    s_and_b32 s97, s69, 1
    s_cmp_lg_u32 s98, 3
    s_cbranch_scc1 L_nosigb
    s_add_u32 s96, s96, s97
    s_lshl_b32 s96, s96, 2
    v_mov_b32 v30, 0x100
    s_mov_b64 exec, 1
    buffer_atomic_add v30, off, s[24:27], s96 sc1
    s_mov_b64 exec, -1
L_nosigb:
    v_exp_f32 v66, v66
    v_exp_f32 v67, v67
    v_exp_f32 v68, v68
    v_mfma_f32_32x32x8_bf16 v[32:47], a[40:41], v[212:213], 0
    v_exp_f32 v69, v69
    v_exp_f32 v70, v70
    v_exp_f32 v71, v71
    v_exp_f32 v72, v72
    v_mfma_f32_32x32x16_bf16 v[32:47], a[28:31], v[208:211], v[32:47]
    v_exp_f32 v73, v73
    v_exp_f32 v74, v74
    v_exp_f32 v75, v75
    v_exp_f32 v76, v76
    v_smfmac_f32_32x32x32_bf16 v[128:143], a[18:21], v[64:71], v2
    v_exp_f32 v77, v77
    v_exp_f32 v78, v78
    v_exp_f32 v79, v79
    v_exp_f32 v80, v80
    v_exp_f32 v81, v81
    v_smfmac_f32_32x32x32_bf16 v[128:143], a[22:25], v[72:79], v2
    v_exp_f32 v82, v82
    v_exp_f32 v83, v83
    v_exp_f32 v84, v84
    v_mfma_f32_32x32x8_bf16 v[48:63], a[40:41], v[218:219], 0
    v_exp_f32 v85, v85
    v_exp_f32 v86, v86
    v_exp_f32 v87, v87
    v_exp_f32 v88, v88
    v_mfma_f32_32x32x16_bf16 v[48:63], a[28:31], v[214:217], v[48:63]
    v_exp_f32 v89, v89
    v_exp_f32 v90, v90
    v_exp_f32 v91, v91
    v_exp_f32 v92, v92
    v_smfmac_f32_32x32x32_bf16 v[144:159], a[18:21], v[80:87], v2
    v_exp_f32 v93, v93
    v_exp_f32 v94, v94
    v_exp_f32 v95, v95
    v_exp_f32 v32, v32
    v_exp_f32 v33, v33
    v_smfmac_f32_32x32x32_bf16 v[144:159], a[22:25], v[88:95], v2
    buffer_load_dwordx4 a[14:17], v6, s[4:7], 0 offen sc1
    buffer_load_dwordx2 a[26:27], v4, s[4:7], 0 offen offset:3072 sc1
    buffer_load_dwordx4 a[18:21], v3, s[4:7], 0 offen offset:1024 sc1
    buffer_load_dwordx4 a[22:25], v3, s[4:7], 0 offen offset:2048 sc1
    v_exp_f32 v34, v34
    v_exp_f32 v35, v35
    v_exp_f32 v36, v36
    v_mfma_f32_32x32x8_bf16 v[64:79], a[40:41], v[224:225], 0
    v_exp_f32 v37, v37
    v_exp_f32 v38, v38
    v_exp_f32 v39, v39
    v_exp_f32 v40, v40
    v_mfma_f32_32x32x16_bf16 v[64:79], a[28:31], v[220:223], v[64:79]
    v_exp_f32 v41, v41
    v_exp_f32 v42, v42
    v_exp_f32 v43, v43
    v_exp_f32 v44, v44
    v_smfmac_f32_32x32x32_bf16 v[96:111], a[32:35], v[32:39], v2
    v_exp_f32 v45, v45
    v_exp_f32 v46, v46
    v_exp_f32 v47, v47
    v_exp_f32 v48, v48
    v_exp_f32 v49, v49
    v_smfmac_f32_32x32x32_bf16 v[96:111], a[36:39], v[40:47], v2
    s_add_u32 s83, s83, 8192
    s_and_b32 s83, s83, 0x3ffff
    v_exp_f32 v50, v50
    v_exp_f32 v51, v51
    v_exp_f32 v52, v52
    v_mfma_f32_32x32x8_bf16 v[80:95], a[40:41], v[230:231], 0
    v_exp_f32 v53, v53
    v_exp_f32 v54, v54
    v_exp_f32 v55, v55
    v_exp_f32 v56, v56
    v_mfma_f32_32x32x16_bf16 v[80:95], a[28:31], v[226:229], v[80:95]
    v_exp_f32 v57, v57
    v_exp_f32 v58, v58
    v_exp_f32 v59, v59
    v_exp_f32 v60, v60
    v_smfmac_f32_32x32x32_bf16 v[112:127], a[32:35], v[48:55], v2
    s_add_u32 s4, s20, s83
    s_addc_u32 s5, s21, 0
    v_exp_f32 v61, v61
    v_exp_f32 v62, v62
    v_exp_f32 v63, v63
    v_exp_f32 v64, v64
    v_exp_f32 v65, v65
    v_smfmac_f32_32x32x32_bf16 v[112:127], a[36:39], v[56:63], v2
    s_waitcnt vmcnt(8)
    v_exp_f32 v66, v66
    v_exp_f32 v67, v67
    v_exp_f32 v68, v68
    v_mfma_f32_32x32x8_bf16 v[32:47], a[54:55], v[212:213], 0
    v_exp_f32 v69, v69
    v_exp_f32 v70, v70
    v_exp_f32 v71, v71
    v_exp_f32 v72, v72
    v_mfma_f32_32x32x16_bf16 v[32:47], a[42:45], v[208:211], v[32:47]
    v_exp_f32 v73, v73
    v_exp_f32 v74, v74
    v_exp_f32 v75, v75
    v_exp_f32 v76, v76
    v_smfmac_f32_32x32x32_bf16 v[128:143], a[32:35], v[64:71], v2
    v_exp_f32 v77, v77
    v_exp_f32 v78, v78
    v_exp_f32 v79, v79
    v_exp_f32 v80, v80
    v_exp_f32 v81, v81
    v_smfmac_f32_32x32x32_bf16 v[128:143], a[36:39], v[72:79], v2
    v_exp_f32 v82, v82
    v_exp_f32 v83, v83
    v_exp_f32 v84, v84
    v_mfma_f32_32x32x8_bf16 v[48:63], a[54:55], v[218:219], 0
    v_exp_f32 v85, v85
    v_exp_f32 v86, v86
    v_exp_f32 v87, v87
    v_exp_f32 v88, v88
    v_mfma_f32_32x32x16_bf16 v[48:63], a[42:45], v[214:217], v[48:63]
    v_exp_f32 v89, v89
    v_exp_f32 v90, v90
    v_exp_f32 v91, v91
    v_exp_f32 v92, v92
    v_smfmac_f32_32x32x32_bf16 v[144:159], a[32:35], v[80:87], v2
    v_exp_f32 v93, v93
    v_exp_f32 v94, v94
    v_exp_f32 v95, v95
    v_exp_f32 v32, v32
    v_exp_f32 v33, v33
    v_smfmac_f32_32x32x32_bf16 v[144:159], a[36:39], v[88:95], v2
    buffer_load_dwordx4 a[28:31], v6, s[4:7], 0 offen sc1
    buffer_load_dwordx2 a[40:41], v4, s[4:7], 0 offen offset:3072 sc1
    buffer_load_dwordx4 a[32:35], v3, s[4:7], 0 offen offset:1024 sc1
    buffer_load_dwordx4 a[36:39], v3, s[4:7], 0 offen offset:2048 sc1
    v_exp_f32 v34, v34
    v_exp_f32 v35, v35
    v_exp_f32 v36, v36
    v_mfma_f32_32x32x8_bf16 v[64:79], a[54:55], v[224:225], 0
    v_exp_f32 v37, v37
    v_exp_f32 v38, v38
    v_exp_f32 v39, v39
    v_exp_f32 v40, v40
    v_mfma_f32_32x32x16_bf16 v[64:79], a[42:45], v[220:223], v[64:79]
    v_exp_f32 v41, v41
    v_exp_f32 v42, v42
    v_exp_f32 v43, v43
    v_exp_f32 v44, v44
    v_smfmac_f32_32x32x32_bf16 v[96:111], a[46:49], v[32:39], v2
    v_exp_f32 v45, v45
    v_exp_f32 v46, v46
    v_exp_f32 v47, v47
    v_exp_f32 v48, v48
    v_exp_f32 v49, v49
    v_smfmac_f32_32x32x32_bf16 v[96:111], a[50:53], v[40:47], v2
    s_add_u32 s83, s83, 8192
    s_and_b32 s83, s83, 0x3ffff
    v_exp_f32 v50, v50
    v_exp_f32 v51, v51
    v_exp_f32 v52, v52
    v_mfma_f32_32x32x8_bf16 v[80:95], a[54:55], v[230:231], 0
    v_exp_f32 v53, v53
    v_exp_f32 v54, v54
    v_exp_f32 v55, v55
    v_exp_f32 v56, v56
    v_mfma_f32_32x32x16_bf16 v[80:95], a[42:45], v[226:229], v[80:95]
    v_exp_f32 v57, v57
    v_exp_f32 v58, v58
    v_exp_f32 v59, v59
    v_exp_f32 v60, v60
    v_smfmac_f32_32x32x32_bf16 v[112:127], a[46:49], v[48:55], v2
    s_add_u32 s4, s20, s83
    s_addc_u32 s5, s21, 0
    v_exp_f32 v61, v61
    v_exp_f32 v62, v62
    v_exp_f32 v63, v63
    v_exp_f32 v64, v64
    v_exp_f32 v65, v65
    v_smfmac_f32_32x32x32_bf16 v[112:127], a[50:53], v[56:63], v2
    s_waitcnt vmcnt(8)
    v_exp_f32 v66, v66
    v_exp_f32 v67, v67
    v_exp_f32 v68, v68
    v_mfma_f32_32x32x8_bf16 v[32:47], a[12:13], v[212:213], 0
    v_exp_f32 v69, v69
    v_exp_f32 v70, v70
    v_exp_f32 v71, v71
    v_exp_f32 v72, v72
    v_mfma_f32_32x32x16_bf16 v[32:47], a[0:3], v[208:211], v[32:47]
    v_exp_f32 v73, v73
    v_exp_f32 v74, v74
    v_exp_f32 v75, v75
    v_exp_f32 v76, v76
    v_smfmac_f32_32x32x32_bf16 v[128:143], a[46:49], v[64:71], v2
    v_exp_f32 v77, v77
    v_exp_f32 v78, v78
    v_exp_f32 v79, v79
    v_exp_f32 v80, v80
    v_exp_f32 v81, v81
    v_smfmac_f32_32x32x32_bf16 v[128:143], a[50:53], v[72:79], v2
    v_exp_f32 v82, v82
    v_exp_f32 v83, v83
    v_exp_f32 v84, v84
    v_mfma_f32_32x32x8_bf16 v[48:63], a[12:13], v[218:219], 0
    v_exp_f32 v85, v85
    v_exp_f32 v86, v86
    v_exp_f32 v87, v87
    v_exp_f32 v88, v88
    v_mfma_f32_32x32x16_bf16 v[48:63], a[0:3], v[214:217], v[48:63]
    v_exp_f32 v89, v89
    v_exp_f32 v90, v90
    v_exp_f32 v91, v91
    v_exp_f32 v92, v92
    v_smfmac_f32_32x32x32_bf16 v[144:159], a[46:49], v[80:87], v2
    v_exp_f32 v93, v93
    v_exp_f32 v94, v94
    v_exp_f32 v95, v95
    v_exp_f32 v32, v32
    v_exp_f32 v33, v33
    v_smfmac_f32_32x32x32_bf16 v[144:159], a[50:53], v[88:95], v2
    buffer_load_dwordx4 a[42:45], v6, s[4:7], 0 offen sc1
    buffer_load_dwordx2 a[54:55], v4, s[4:7], 0 offen offset:3072 sc1
    buffer_load_dwordx4 a[46:49], v3, s[4:7], 0 offen offset:1024 sc1
    buffer_load_dwordx4 a[50:53], v3, s[4:7], 0 offen offset:2048 sc1
    v_exp_f32 v34, v34
    v_exp_f32 v35, v35
    v_exp_f32 v36, v36
    v_mfma_f32_32x32x8_bf16 v[64:79], a[12:13], v[224:225], 0
    v_exp_f32 v37, v37
    v_exp_f32 v38, v38
    v_exp_f32 v39, v39
    v_exp_f32 v40, v40
    v_mfma_f32_32x32x16_bf16 v[64:79], a[0:3], v[220:223], v[64:79]
    v_exp_f32 v41, v41
    v_exp_f32 v42, v42
    v_exp_f32 v43, v43
    v_exp_f32 v44, v44
    v_smfmac_f32_32x32x32_bf16 v[96:111], a[4:7], v[32:39], v2
    v_exp_f32 v45, v45
    v_exp_f32 v46, v46
    v_exp_f32 v47, v47
    v_exp_f32 v48, v48
    v_exp_f32 v49, v49
    v_smfmac_f32_32x32x32_bf16 v[96:111], a[8:11], v[40:47], v2
    s_add_u32 s83, s83, 8192
    s_and_b32 s83, s83, 0x3ffff
    v_exp_f32 v50, v50
    v_exp_f32 v51, v51
    v_exp_f32 v52, v52
    v_mfma_f32_32x32x8_bf16 v[80:95], a[12:13], v[230:231], 0
    v_exp_f32 v53, v53
    v_exp_f32 v54, v54
    v_exp_f32 v55, v55
    v_exp_f32 v56, v56
    v_mfma_f32_32x32x16_bf16 v[80:95], a[0:3], v[226:229], v[80:95]
    v_exp_f32 v57, v57
    v_exp_f32 v58, v58
    v_exp_f32 v59, v59
    v_exp_f32 v60, v60
    v_smfmac_f32_32x32x32_bf16 v[112:127], a[4:7], v[48:55], v2
    s_add_u32 s4, s20, s83
    s_addc_u32 s5, s21, 0
    v_exp_f32 v61, v61
    v_exp_f32 v62, v62
    v_exp_f32 v63, v63
    v_exp_f32 v64, v64
    v_exp_f32 v65, v65
    v_smfmac_f32_32x32x32_bf16 v[112:127], a[8:11], v[56:63], v2
    s_waitcnt vmcnt(8)
    v_exp_f32 v66, v66
    v_exp_f32 v67, v67
    v_exp_f32 v68, v68
    v_mfma_f32_32x32x8_bf16 v[32:47], a[26:27], v[212:213], 0
    v_exp_f32 v69, v69
    v_exp_f32 v70, v70
    v_exp_f32 v71, v71
    v_exp_f32 v72, v72
    v_mfma_f32_32x32x16_bf16 v[32:47], a[14:17], v[208:211], v[32:47]
    v_exp_f32 v73, v73
    v_exp_f32 v74, v74
    v_exp_f32 v75, v75
    v_exp_f32 v76, v76
    v_smfmac_f32_32x32x32_bf16 v[128:143], a[4:7], v[64:71], v2
    v_exp_f32 v77, v77
    v_exp_f32 v78, v78
    v_exp_f32 v79, v79
    v_exp_f32 v80, v80
    v_exp_f32 v81, v81
    v_smfmac_f32_32x32x32_bf16 v[128:143], a[8:11], v[72:79], v2
    v_exp_f32 v82, v82
    v_exp_f32 v83, v83
    v_exp_f32 v84, v84
    v_mfma_f32_32x32x8_bf16 v[48:63], a[26:27], v[218:219], 0
    v_exp_f32 v85, v85
    v_exp_f32 v86, v86
    v_exp_f32 v87, v87
    v_exp_f32 v88, v88
    v_mfma_f32_32x32x16_bf16 v[48:63], a[14:17], v[214:217], v[48:63]
    v_exp_f32 v89, v89
    v_exp_f32 v90, v90
    v_exp_f32 v91, v91
    v_exp_f32 v92, v92
    v_smfmac_f32_32x32x32_bf16 v[144:159], a[4:7], v[80:87], v2
    v_exp_f32 v93, v93
    v_exp_f32 v94, v94
    v_exp_f32 v95, v95
    v_exp_f32 v32, v32
    v_exp_f32 v33, v33
    v_smfmac_f32_32x32x32_bf16 v[144:159], a[8:11], v[88:95], v2
    buffer_load_dwordx4 a[0:3], v6, s[4:7], 0 offen sc1
    buffer_load_dwordx2 a[12:13], v4, s[4:7], 0 offen offset:3072 sc1
    buffer_load_dwordx4 a[4:7], v3, s[4:7], 0 offen offset:1024 sc1
    buffer_load_dwordx4 a[8:11], v3, s[4:7], 0 offen offset:2048 sc1
    v_exp_f32 v34, v34
    v_exp_f32 v35, v35
    v_exp_f32 v36, v36
    v_mfma_f32_32x32x8_bf16 v[64:79], a[26:27], v[224:225], 0
    v_exp_f32 v37, v37
    v_exp_f32 v38, v38
    v_exp_f32 v39, v39
    v_exp_f32 v40, v40
    v_mfma_f32_32x32x16_bf16 v[64:79], a[14:17], v[220:223], v[64:79]
    v_exp_f32 v41, v41
    v_exp_f32 v42, v42
    v_exp_f32 v43, v43
    v_exp_f32 v44, v44
    v_smfmac_f32_32x32x32_bf16 v[96:111], a[18:21], v[32:39], v2
    v_exp_f32 v45, v45
    v_exp_f32 v46, v46
    v_exp_f32 v47, v47
    v_exp_f32 v48, v48
    v_exp_f32 v49, v49
    v_smfmac_f32_32x32x32_bf16 v[96:111], a[22:25], v[40:47], v2
    s_add_u32 s83, s83, 8192
    s_and_b32 s83, s83, 0x3ffff
    v_exp_f32 v50, v50
    v_exp_f32 v51, v51
    v_exp_f32 v52, v52
    v_mfma_f32_32x32x8_bf16 v[80:95], a[26:27], v[230:231], 0
    v_exp_f32 v53, v53
    v_exp_f32 v54, v54
    v_exp_f32 v55, v55
    v_exp_f32 v56, v56
    v_mfma_f32_32x32x16_bf16 v[80:95], a[14:17], v[226:229], v[80:95]
    v_exp_f32 v57, v57
    v_exp_f32 v58, v58
    v_exp_f32 v59, v59
    v_exp_f32 v60, v60
    v_smfmac_f32_32x32x32_bf16 v[112:127], a[18:21], v[48:55], v2
    s_add_u32 s4, s20, s83
    s_addc_u32 s5, s21, 0
    v_exp_f32 v61, v61
    v_exp_f32 v62, v62
    v_exp_f32 v63, v63
    v_exp_f32 v64, v64
    v_exp_f32 v65, v65
    v_smfmac_f32_32x32x32_bf16 v[112:127], a[22:25], v[56:63], v2
    s_waitcnt vmcnt(8)
    v_exp_f32 v66, v66
    v_exp_f32 v67, v67
    v_exp_f32 v68, v68
    v_mfma_f32_32x32x8_bf16 v[32:47], a[40:41], v[212:213], 0
    v_exp_f32 v69, v69
    v_exp_f32 v70, v70
    v_exp_f32 v71, v71
    v_exp_f32 v72, v72
    v_mfma_f32_32x32x16_bf16 v[32:47], a[28:31], v[208:211], v[32:47]
    v_exp_f32 v73, v73
    v_exp_f32 v74, v74
    v_exp_f32 v75, v75
    v_exp_f32 v76, v76
    v_smfmac_f32_32x32x32_bf16 v[128:143], a[18:21], v[64:71], v2
    v_exp_f32 v77, v77
    v_exp_f32 v78, v78
    v_exp_f32 v79, v79
    v_exp_f32 v80, v80
    v_exp_f32 v81, v81
    v_smfmac_f32_32x32x32_bf16 v[128:143], a[22:25], v[72:79], v2
    buffer_load_dword v5, v244, s[24:27], 0 offen sc1
    v_exp_f32 v82, v82
    v_exp_f32 v83, v83
    v_exp_f32 v84, v84
    v_mfma_f32_32x32x8_bf16 v[48:63], a[40:41], v[218:219], 0
    v_exp_f32 v85, v85
    v_exp_f32 v86, v86
    v_exp_f32 v87, v87
    v_exp_f32 v88, v88
    v_mfma_f32_32x32x16_bf16 v[48:63], a[28:31], v[214:217], v[48:63]
    v_exp_f32 v89, v89
    v_exp_f32 v90, v90
    v_exp_f32 v91, v91
    v_exp_f32 v92, v92
    v_smfmac_f32_32x32x32_bf16 v[144:159], a[18:21], v[80:87], v2
    v_exp_f32 v93, v93
    v_exp_f32 v94, v94
    v_exp_f32 v95, v95
    v_exp_f32 v32, v32
    v_exp_f32 v33, v33
    v_smfmac_f32_32x32x32_bf16 v[144:159], a[22:25], v[88:95], v2
    buffer_load_dwordx4 a[14:17], v6, s[4:7], 0 offen sc1
    buffer_load_dwordx2 a[26:27], v4, s[4:7], 0 offen offset:3072 sc1
    buffer_load_dwordx4 a[18:21], v3, s[4:7], 0 offen offset:1024 sc1
    buffer_load_dwordx4 a[22:25], v3, s[4:7], 0 offen offset:2048 sc1
    v_exp_f32 v34, v34
    v_exp_f32 v35, v35
    v_exp_f32 v36, v36
    v_mfma_f32_32x32x8_bf16 v[64:79], a[40:41], v[224:225], 0
    v_exp_f32 v37, v37
    v_exp_f32 v38, v38
    v_exp_f32 v39, v39
    v_exp_f32 v40, v40
    v_mfma_f32_32x32x16_bf16 v[64:79], a[28:31], v[220:223], v[64:79]
    v_exp_f32 v41, v41
    v_exp_f32 v42, v42
    v_exp_f32 v43, v43
    v_exp_f32 v44, v44
    v_smfmac_f32_32x32x32_bf16 v[96:111], a[32:35], v[32:39], v2
    v_exp_f32 v45, v45
    v_exp_f32 v46, v46
    v_exp_f32 v47, v47
    v_exp_f32 v48, v48
    v_exp_f32 v49, v49
    v_smfmac_f32_32x32x32_bf16 v[96:111], a[36:39], v[40:47], v2
    s_add_u32 s83, s83, 8192
    s_and_b32 s83, s83, 0x3ffff
    v_exp_f32 v50, v50
    v_exp_f32 v51, v51
    v_exp_f32 v52, v52
    v_mfma_f32_32x32x8_bf16 v[80:95], a[40:41], v[230:231], 0
    v_exp_f32 v53, v53
    v_exp_f32 v54, v54
    v_exp_f32 v55, v55
    v_exp_f32 v56, v56
    v_mfma_f32_32x32x16_bf16 v[80:95], a[28:31], v[226:229], v[80:95]
    v_exp_f32 v57, v57
    v_exp_f32 v58, v58
    v_exp_f32 v59, v59
    v_exp_f32 v60, v60
    v_smfmac_f32_32x32x32_bf16 v[112:127], a[32:35], v[48:55], v2
    s_add_u32 s4, s20, s83
    s_addc_u32 s5, s21, 0
    v_exp_f32 v61, v61
    v_exp_f32 v62, v62
    v_exp_f32 v63, v63
    v_exp_f32 v64, v64
    v_exp_f32 v65, v65
    v_smfmac_f32_32x32x32_bf16 v[112:127], a[36:39], v[56:63], v2
    s_waitcnt vmcnt(9)
    v_exp_f32 v66, v66
    v_exp_f32 v67, v67
    v_exp_f32 v68, v68
    v_mfma_f32_32x32x8_bf16 v[32:47], a[54:55], v[212:213], 0
    v_exp_f32 v69, v69
    v_exp_f32 v70, v70
    v_exp_f32 v71, v71
    v_exp_f32 v72, v72
    v_mfma_f32_32x32x16_bf16 v[32:47], a[42:45], v[208:211], v[32:47]
    v_exp_f32 v73, v73
    v_exp_f32 v74, v74
    v_exp_f32 v75, v75
    v_exp_f32 v76, v76
    v_smfmac_f32_32x32x32_bf16 v[128:143], a[32:35], v[64:71], v2
    v_exp_f32 v77, v77
    v_exp_f32 v78, v78
    v_exp_f32 v79, v79
    v_exp_f32 v80, v80
    v_exp_f32 v81, v81
    v_smfmac_f32_32x32x32_bf16 v[128:143], a[36:39], v[72:79], v2
    v_exp_f32 v82, v82
    v_exp_f32 v83, v83
    v_exp_f32 v84, v84
    v_mfma_f32_32x32x8_bf16 v[48:63], a[54:55], v[218:219], 0
    v_exp_f32 v85, v85
    v_exp_f32 v86, v86
    v_exp_f32 v87, v87
    v_exp_f32 v88, v88
    v_mfma_f32_32x32x16_bf16 v[48:63], a[42:45], v[214:217], v[48:63]
    v_exp_f32 v89, v89
    v_exp_f32 v90, v90
    v_exp_f32 v91, v91
    v_exp_f32 v92, v92
    v_smfmac_f32_32x32x32_bf16 v[144:159], a[32:35], v[80:87], v2
    v_exp_f32 v93, v93
    v_exp_f32 v94, v94
    v_exp_f32 v95, v95
    s_waitcnt vmcnt(4)
    v_cmp_gt_u32 vcc, 0x400, v5
    s_nop 4
    s_cbranch_vccz L_bpoll_done
    buffer_load_dword v5, v244, s[24:27], 0 offen sc1
    s_mov_b32 s84, 0
L_bpoll:
    s_waitcnt vmcnt(0)
    v_cmp_gt_u32 vcc, 0x400, v5
    s_nop 4
    s_cbranch_vccz L_bpoll_ok
    s_add_u32 s84, s84, 1
    s_cmp_ge_u32 s84, 1048576
    s_cbranch_scc1 L_bpoll_ok
    s_sleep 4
    buffer_load_dword v5, v244, s[24:27], 0 offen sc1
    s_branch L_bpoll
L_bpoll_ok:
L_bpoll_done:
    v_exp_f32 v32, v32
    v_exp_f32 v33, v33
    v_smfmac_f32_32x32x32_bf16 v[144:159], a[36:39], v[88:95], v2
    buffer_load_dwordx4 a[28:31], v6, s[4:7], 0 offen sc1
    buffer_load_dwordx2 a[40:41], v4, s[4:7], 0 offen offset:3072 sc1
    buffer_load_dwordx4 a[32:35], v3, s[4:7], 0 offen offset:1024 sc1
    buffer_load_dwordx4 a[36:39], v3, s[4:7], 0 offen offset:2048 sc1
    v_exp_f32 v34, v34
    v_exp_f32 v35, v35
    v_exp_f32 v36, v36
    v_mfma_f32_32x32x8_bf16 v[64:79], a[54:55], v[224:225], 0
    v_exp_f32 v37, v37
    v_exp_f32 v38, v38
    v_exp_f32 v39, v39
    v_exp_f32 v40, v40
    v_mfma_f32_32x32x16_bf16 v[64:79], a[42:45], v[220:223], v[64:79]
    v_exp_f32 v41, v41
    v_exp_f32 v42, v42
    v_exp_f32 v43, v43
    v_exp_f32 v44, v44
    v_smfmac_f32_32x32x32_bf16 v[96:111], a[46:49], v[32:39], v2
    v_exp_f32 v45, v45
    v_exp_f32 v46, v46
    v_exp_f32 v47, v47
    v_exp_f32 v48, v48
    v_exp_f32 v49, v49
    v_smfmac_f32_32x32x32_bf16 v[96:111], a[50:53], v[40:47], v2
    s_add_u32 s83, s83, 8192
    s_and_b32 s83, s83, 0x3ffff
    v_exp_f32 v50, v50
    v_exp_f32 v51, v51
    v_exp_f32 v52, v52
    v_mfma_f32_32x32x8_bf16 v[80:95], a[54:55], v[230:231], 0
    v_exp_f32 v53, v53
    v_exp_f32 v54, v54
    v_exp_f32 v55, v55
    v_exp_f32 v56, v56
    v_mfma_f32_32x32x16_bf16 v[80:95], a[42:45], v[226:229], v[80:95]
    v_exp_f32 v57, v57
    v_exp_f32 v58, v58
    v_exp_f32 v59, v59
    v_exp_f32 v60, v60
    v_smfmac_f32_32x32x32_bf16 v[112:127], a[46:49], v[48:55], v2
    s_add_u32 s4, s20, s83
    s_addc_u32 s5, s21, 0
    v_exp_f32 v61, v61
    v_exp_f32 v62, v62
    v_exp_f32 v63, v63
    v_exp_f32 v64, v64
    v_exp_f32 v65, v65
    v_smfmac_f32_32x32x32_bf16 v[112:127], a[50:53], v[56:63], v2
    v_exp_f32 v66, v66
    v_exp_f32 v67, v67
    v_exp_f32 v68, v68
    v_mfma_f32_32x32x8_bf16 v[32:47], a[12:13], v[212:213], 0
    v_exp_f32 v69, v69
    v_exp_f32 v70, v70
    v_exp_f32 v71, v71
    v_exp_f32 v72, v72
    v_mfma_f32_32x32x16_bf16 v[32:47], a[0:3], v[208:211], v[32:47]
    v_exp_f32 v73, v73
    v_exp_f32 v74, v74
    v_exp_f32 v75, v75
    v_exp_f32 v76, v76
    v_smfmac_f32_32x32x32_bf16 v[128:143], a[46:49], v[64:71], v2
    s_add_u32 m0, s80, 0
    v_exp_f32 v77, v77
    v_exp_f32 v78, v78
    v_exp_f32 v79, v79
    v_exp_f32 v80, v80
    v_exp_f32 v81, v81
    v_smfmac_f32_32x32x32_bf16 v[128:143], a[50:53], v[72:79], v2
    buffer_load_dwordx4 v6, s[12:15], 0 offen sc1 lds
    buffer_load_dwordx4 v6, s[12:15], 0 offen offset:1024 sc1 lds
    buffer_load_dwordx4 a[64:67], v245, s[8:11], 0 offen sc1
    buffer_load_dwordx4 a[68:71], v246, s[8:11], 0 offen sc1
    buffer_load_dwordx4 a[72:75], v245, s[8:11], 0 offen offset:1024 sc1
    v_exp_f32 v82, v82
    v_exp_f32 v83, v83
    v_exp_f32 v84, v84
    v_mfma_f32_32x32x8_bf16 v[48:63], a[12:13], v[218:219], 0
    v_exp_f32 v85, v85
    v_exp_f32 v86, v86
    v_exp_f32 v87, v87
    v_exp_f32 v88, v88
    v_mfma_f32_32x32x16_bf16 v[48:63], a[0:3], v[214:217], v[48:63]
    v_exp_f32 v89, v89
    v_exp_f32 v90, v90
    v_exp_f32 v91, v91
    v_exp_f32 v92, v92
    v_smfmac_f32_32x32x32_bf16 v[144:159], a[46:49], v[80:87], v2
    v_exp_f32 v93, v93
    v_exp_f32 v94, v94
    v_exp_f32 v95, v95
    v_exp_f32 v32, v32
    v_exp_f32 v33, v33
    v_smfmac_f32_32x32x32_bf16 v[144:159], a[50:53], v[88:95], v2
    buffer_load_dwordx4 a[42:45], v6, s[4:7], 0 offen sc1
    buffer_load_dwordx2 a[54:55], v4, s[4:7], 0 offen offset:3072 sc1
    buffer_load_dwordx4 a[46:49], v3, s[4:7], 0 offen offset:1024 sc1
    buffer_load_dwordx4 a[50:53], v3, s[4:7], 0 offen offset:2048 sc1
    v_exp_f32 v34, v34
    v_exp_f32 v35, v35
    v_exp_f32 v36, v36
    v_mfma_f32_32x32x8_bf16 v[64:79], a[12:13], v[224:225], 0
    v_exp_f32 v37, v37
    v_exp_f32 v38, v38
    v_exp_f32 v39, v39
    v_exp_f32 v40, v40
    v_mfma_f32_32x32x16_bf16 v[64:79], a[0:3], v[220:223], v[64:79]
    v_exp_f32 v41, v41
    v_exp_f32 v42, v42
    v_exp_f32 v43, v43
    v_exp_f32 v44, v44
    v_smfmac_f32_32x32x32_bf16 v[96:111], a[4:7], v[32:39], v2
    v_exp_f32 v45, v45
    v_exp_f32 v46, v46
    v_exp_f32 v47, v47
    v_exp_f32 v48, v48
    v_exp_f32 v49, v49
    v_smfmac_f32_32x32x32_bf16 v[96:111], a[8:11], v[40:47], v2
    s_add_u32 s83, s83, 8192
    s_and_b32 s83, s83, 0x3ffff
    v_exp_f32 v50, v50
    v_exp_f32 v51, v51
    v_exp_f32 v52, v52
    v_mfma_f32_32x32x8_bf16 v[80:95], a[12:13], v[230:231], 0
L_pad6:
    s_cbranch_execz L_back
    v_exp_f32 v53, v53
    v_exp_f32 v54, v54
    v_exp_f32 v55, v55
    v_exp_f32 v56, v56
    v_mfma_f32_32x32x16_bf16 v[80:95], a[0:3], v[226:229], v[80:95]
    v_exp_f32 v57, v57
    v_exp_f32 v58, v58
    v_exp_f32 v59, v59
    v_exp_f32 v60, v60
    v_smfmac_f32_32x32x32_bf16 v[112:127], a[4:7], v[48:55], v2
    s_add_u32 s4, s20, s83
    s_addc_u32 s5, s21, 0
    v_exp_f32 v61, v61
    v_exp_f32 v62, v62
    v_exp_f32 v63, v63
    v_exp_f32 v64, v64
    v_exp_f32 v65, v65
    v_smfmac_f32_32x32x32_bf16 v[112:127], a[8:11], v[56:63], v2
    s_waitcnt vmcnt(13)
    v_exp_f32 v66, v66
    v_exp_f32 v67, v67
    v_exp_f32 v68, v68
    v_mfma_f32_32x32x8_bf16 v[32:47], a[26:27], v[212:213], 0
    v_exp_f32 v69, v69
    v_exp_f32 v70, v70
    v_exp_f32 v71, v71
    v_exp_f32 v72, v72
    v_mfma_f32_32x32x16_bf16 v[32:47], a[14:17], v[208:211], v[32:47]
    v_exp_f32 v73, v73
    v_exp_f32 v74, v74
    v_exp_f32 v75, v75
    v_exp_f32 v76, v76
    v_smfmac_f32_32x32x32_bf16 v[128:143], a[4:7], v[64:71], v2
    v_exp_f32 v77, v77
    v_exp_f32 v78, v78
    v_exp_f32 v79, v79
    v_exp_f32 v80, v80
    v_exp_f32 v81, v81
    v_smfmac_f32_32x32x32_bf16 v[128:143], a[8:11], v[72:79], v2
    buffer_load_dwordx4 v6, s[12:15], 0 offen offset:2048 sc1 lds
    buffer_load_dwordx4 v6, s[12:15], 0 offen offset:3072 sc1 lds
    buffer_load_dwordx4 a[76:79], v246, s[8:11], 0 offen offset:1024 sc1
    buffer_load_dwordx4 a[80:83], v245, s[8:11], 0 offen offset:2048 sc1
    buffer_load_dwordx4 a[84:87], v246, s[8:11], 0 offen offset:2048 sc1
    v_exp_f32 v82, v82
    v_exp_f32 v83, v83
    v_exp_f32 v84, v84
    v_mfma_f32_32x32x8_bf16 v[48:63], a[26:27], v[218:219], 0
    v_exp_f32 v85, v85
    v_exp_f32 v86, v86
    v_exp_f32 v87, v87
    v_exp_f32 v88, v88
    v_mfma_f32_32x32x16_bf16 v[48:63], a[14:17], v[214:217], v[48:63]
    v_exp_f32 v89, v89
    v_exp_f32 v90, v90
    v_exp_f32 v91, v91
    v_exp_f32 v92, v92
    v_smfmac_f32_32x32x32_bf16 v[144:159], a[4:7], v[80:87], v2
    v_exp_f32 v93, v93
    v_exp_f32 v94, v94
    v_exp_f32 v95, v95
    v_exp_f32 v32, v32
    v_exp_f32 v33, v33
    v_smfmac_f32_32x32x32_bf16 v[144:159], a[8:11], v[88:95], v2
    buffer_load_dwordx4 a[0:3], v6, s[4:7], 0 offen sc1
    buffer_load_dwordx2 a[12:13], v4, s[4:7], 0 offen offset:3072 sc1
    buffer_load_dwordx4 a[4:7], v3, s[4:7], 0 offen offset:1024 sc1
    buffer_load_dwordx4 a[8:11], v3, s[4:7], 0 offen offset:2048 sc1
    v_exp_f32 v34, v34
    v_exp_f32 v35, v35
    v_exp_f32 v36, v36
    v_mfma_f32_32x32x8_bf16 v[64:79], a[26:27], v[224:225], 0
    v_exp_f32 v37, v37
    v_exp_f32 v38, v38
    v_exp_f32 v39, v39
    v_exp_f32 v40, v40
    v_mfma_f32_32x32x16_bf16 v[64:79], a[14:17], v[220:223], v[64:79]
    v_exp_f32 v41, v41
    v_exp_f32 v42, v42
    v_exp_f32 v43, v43
    v_exp_f32 v44, v44
    v_smfmac_f32_32x32x32_bf16 v[96:111], a[18:21], v[32:39], v2
    v_exp_f32 v45, v45
    v_exp_f32 v46, v46
    v_exp_f32 v47, v47
    v_exp_f32 v48, v48
    v_exp_f32 v49, v49
    v_smfmac_f32_32x32x32_bf16 v[96:111], a[22:25], v[40:47], v2
    s_add_u32 s83, s83, 8192
    s_and_b32 s83, s83, 0x3ffff
    v_exp_f32 v50, v50
    v_exp_f32 v51, v51
    v_exp_f32 v52, v52
    v_mfma_f32_32x32x8_bf16 v[80:95], a[26:27], v[230:231], 0
    v_exp_f32 v53, v53
    v_exp_f32 v54, v54
    v_exp_f32 v55, v55
    v_exp_f32 v56, v56
    v_mfma_f32_32x32x16_bf16 v[80:95], a[14:17], v[226:229], v[80:95]
    v_exp_f32 v57, v57
    v_exp_f32 v58, v58
    v_exp_f32 v59, v59
    v_exp_f32 v60, v60
    v_smfmac_f32_32x32x32_bf16 v[112:127], a[18:21], v[48:55], v2
    s_add_u32 s4, s20, s83
    s_addc_u32 s5, s21, 0
    v_exp_f32 v61, v61
    v_exp_f32 v62, v62
    v_exp_f32 v63, v63
    v_exp_f32 v64, v64
    v_exp_f32 v65, v65
    v_smfmac_f32_32x32x32_bf16 v[112:127], a[22:25], v[56:63], v2
    s_waitcnt vmcnt(18)
    v_exp_f32 v66, v66
    v_exp_f32 v67, v67
    v_exp_f32 v68, v68
    v_mfma_f32_32x32x8_bf16 v[32:47], a[40:41], v[212:213], 0
    v_exp_f32 v69, v69
    v_exp_f32 v70, v70
    v_exp_f32 v71, v71
    v_exp_f32 v72, v72
    v_mfma_f32_32x32x16_bf16 v[32:47], a[28:31], v[208:211], v[32:47]
    v_exp_f32 v73, v73
    v_exp_f32 v74, v74
    v_exp_f32 v75, v75
    v_exp_f32 v76, v76
    v_smfmac_f32_32x32x32_bf16 v[128:143], a[18:21], v[64:71], v2
    s_add_u32 m0, s80, 4096
    v_exp_f32 v77, v77
    v_exp_f32 v78, v78
    v_exp_f32 v79, v79
    v_exp_f32 v80, v80
    v_exp_f32 v81, v81
    v_smfmac_f32_32x32x32_bf16 v[128:143], a[22:25], v[72:79], v2
    buffer_load_dwordx4 v249, s[12:15], 0 offen sc1 lds
    s_add_u32 s12, s12, 10240
    s_addc_u32 s13, s13, 0
    s_add_u32 m0, s80, 10240
    buffer_load_dwordx4 a[88:91], v245, s[8:11], 0 offen offset:3072 sc1
    buffer_load_dwordx4 v6, s[12:15], 0 offen sc1 lds
    buffer_load_dwordx4 a[92:95], v246, s[8:11], 0 offen offset:3072 sc1
    s_add_u32 s8, s8, 4096
    s_addc_u32 s9, s9, 0
    buffer_load_dwordx4 a[96:99], v245, s[8:11], 0 offen sc1
    v_exp_f32 v82, v82
    v_exp_f32 v83, v83
    v_exp_f32 v84, v84
    v_mfma_f32_32x32x8_bf16 v[48:63], a[40:41], v[218:219], 0
    v_exp_f32 v85, v85
    v_exp_f32 v86, v86
    v_exp_f32 v87, v87
    v_exp_f32 v88, v88
    v_mfma_f32_32x32x16_bf16 v[48:63], a[28:31], v[214:217], v[48:63]
    v_exp_f32 v89, v89
    v_exp_f32 v90, v90
    v_exp_f32 v91, v91
    v_exp_f32 v92, v92
    v_smfmac_f32_32x32x32_bf16 v[144:159], a[18:21], v[80:87], v2
    v_exp_f32 v93, v93
    v_exp_f32 v94, v94
    v_exp_f32 v95, v95
    v_exp_f32 v32, v32
    v_exp_f32 v33, v33
    v_smfmac_f32_32x32x32_bf16 v[144:159], a[22:25], v[88:95], v2
    buffer_load_dwordx4 a[14:17], v6, s[4:7], 0 offen sc1
    buffer_load_dwordx2 a[26:27], v4, s[4:7], 0 offen offset:3072 sc1
    buffer_load_dwordx4 a[18:21], v3, s[4:7], 0 offen offset:1024 sc1
    buffer_load_dwordx4 a[22:25], v3, s[4:7], 0 offen offset:2048 sc1
    v_exp_f32 v34, v34
    v_exp_f32 v35, v35
    v_exp_f32 v36, v36
    v_mfma_f32_32x32x8_bf16 v[64:79], a[40:41], v[224:225], 0
    v_exp_f32 v37, v37
    v_exp_f32 v38, v38
    v_exp_f32 v39, v39
    v_exp_f32 v40, v40
    v_mfma_f32_32x32x16_bf16 v[64:79], a[28:31], v[220:223], v[64:79]
    v_exp_f32 v41, v41
    v_exp_f32 v42, v42
    v_exp_f32 v43, v43
    v_exp_f32 v44, v44
    v_smfmac_f32_32x32x32_bf16 v[96:111], a[32:35], v[32:39], v2
    v_exp_f32 v45, v45
    v_exp_f32 v46, v46
    v_exp_f32 v47, v47
    v_exp_f32 v48, v48
    v_exp_f32 v49, v49
    v_smfmac_f32_32x32x32_bf16 v[96:111], a[36:39], v[40:47], v2
    s_add_u32 s83, s83, 8192
    s_and_b32 s83, s83, 0x3ffff
    v_exp_f32 v50, v50
    v_exp_f32 v51, v51
    v_exp_f32 v52, v52
    v_mfma_f32_32x32x8_bf16 v[80:95], a[40:41], v[230:231], 0
    v_exp_f32 v53, v53
    v_exp_f32 v54, v54
    v_exp_f32 v55, v55
    v_exp_f32 v56, v56
    v_mfma_f32_32x32x16_bf16 v[80:95], a[28:31], v[226:229], v[80:95]
    v_exp_f32 v57, v57
    v_exp_f32 v58, v58
    v_exp_f32 v59, v59
    v_exp_f32 v60, v60
    v_smfmac_f32_32x32x32_bf16 v[112:127], a[32:35], v[48:55], v2
    s_add_u32 s4, s20, s83
    s_addc_u32 s5, s21, 0
    v_exp_f32 v61, v61
    v_exp_f32 v62, v62
    v_exp_f32 v63, v63
    v_exp_f32 v64, v64
    v_exp_f32 v65, v65
    v_smfmac_f32_32x32x32_bf16 v[112:127], a[36:39], v[56:63], v2
    s_waitcnt vmcnt(18)
    v_exp_f32 v66, v66
    v_exp_f32 v67, v67
    v_exp_f32 v68, v68
    v_mfma_f32_32x32x8_bf16 v[32:47], a[54:55], v[212:213], 0
    v_exp_f32 v69, v69
    v_exp_f32 v70, v70
    v_exp_f32 v71, v71
    v_exp_f32 v72, v72
    v_mfma_f32_32x32x16_bf16 v[32:47], a[42:45], v[208:211], v[32:47]
    v_exp_f32 v73, v73
    v_exp_f32 v74, v74
    v_exp_f32 v75, v75
    v_exp_f32 v76, v76
    v_smfmac_f32_32x32x32_bf16 v[128:143], a[32:35], v[64:71], v2
    v_exp_f32 v77, v77
    v_exp_f32 v78, v78
    v_exp_f32 v79, v79
    v_exp_f32 v80, v80
    v_exp_f32 v81, v81
    v_smfmac_f32_32x32x32_bf16 v[128:143], a[36:39], v[72:79], v2
    buffer_load_dwordx4 v6, s[12:15], 0 offen offset:1024 sc1 lds
    buffer_load_dwordx4 v6, s[12:15], 0 offen offset:2048 sc1 lds
    buffer_load_dwordx4 a[100:103], v246, s[8:11], 0 offen sc1
    buffer_load_dwordx4 a[104:107], v245, s[8:11], 0 offen offset:1024 sc1
    buffer_load_dwordx4 a[108:111], v246, s[8:11], 0 offen offset:1024 sc1
    v_exp_f32 v82, v82
    v_exp_f32 v83, v83
    v_exp_f32 v84, v84
    v_mfma_f32_32x32x8_bf16 v[48:63], a[54:55], v[218:219], 0
    v_exp_f32 v85, v85
    v_exp_f32 v86, v86
    v_exp_f32 v87, v87
    v_exp_f32 v88, v88
    v_mfma_f32_32x32x16_bf16 v[48:63], a[42:45], v[214:217], v[48:63]
    v_exp_f32 v89, v89
    v_exp_f32 v90, v90
    v_exp_f32 v91, v91
    v_exp_f32 v92, v92
    v_smfmac_f32_32x32x32_bf16 v[144:159], a[32:35], v[80:87], v2
    v_exp_f32 v93, v93
    v_exp_f32 v94, v94
    v_exp_f32 v95, v95
    v_exp_f32 v32, v32
    v_exp_f32 v33, v33
    v_smfmac_f32_32x32x32_bf16 v[144:159], a[36:39], v[88:95], v2
    buffer_load_dwordx4 a[28:31], v6, s[4:7], 0 offen sc1
    buffer_load_dwordx2 a[40:41], v4, s[4:7], 0 offen offset:3072 sc1
    buffer_load_dwordx4 a[32:35], v3, s[4:7], 0 offen offset:1024 sc1
    buffer_load_dwordx4 a[36:39], v3, s[4:7], 0 offen offset:2048 sc1
    v_exp_f32 v34, v34
    v_exp_f32 v35, v35
    v_exp_f32 v36, v36
    v_mfma_f32_32x32x8_bf16 v[64:79], a[54:55], v[224:225], 0
    v_exp_f32 v37, v37
    v_exp_f32 v38, v38
    v_exp_f32 v39, v39
    v_exp_f32 v40, v40
    v_mfma_f32_32x32x16_bf16 v[64:79], a[42:45], v[220:223], v[64:79]
    v_exp_f32 v41, v41
    v_exp_f32 v42, v42
    v_exp_f32 v43, v43
    v_exp_f32 v44, v44
    v_smfmac_f32_32x32x32_bf16 v[96:111], a[46:49], v[32:39], v2
    v_exp_f32 v45, v45
    v_exp_f32 v46, v46
    v_exp_f32 v47, v47
    v_exp_f32 v48, v48
    v_exp_f32 v49, v49
    v_smfmac_f32_32x32x32_bf16 v[96:111], a[50:53], v[40:47], v2
    s_add_u32 s83, s83, 8192
    s_and_b32 s83, s83, 0x3ffff
    v_exp_f32 v50, v50
    v_exp_f32 v51, v51
    v_exp_f32 v52, v52
    v_mfma_f32_32x32x8_bf16 v[80:95], a[54:55], v[230:231], 0
    v_exp_f32 v53, v53
    v_exp_f32 v54, v54
    v_exp_f32 v55, v55
    v_exp_f32 v56, v56
    v_mfma_f32_32x32x16_bf16 v[80:95], a[42:45], v[226:229], v[80:95]
    v_exp_f32 v57, v57
    v_exp_f32 v58, v58
    v_exp_f32 v59, v59
    v_exp_f32 v60, v60
    v_smfmac_f32_32x32x32_bf16 v[112:127], a[46:49], v[48:55], v2
    s_add_u32 s4, s20, s83
    s_addc_u32 s5, s21, 0
    v_exp_f32 v61, v61
    v_exp_f32 v62, v62
    v_exp_f32 v63, v63
    v_exp_f32 v64, v64
    v_exp_f32 v65, v65
    v_smfmac_f32_32x32x32_bf16 v[112:127], a[50:53], v[56:63], v2
    s_waitcnt vmcnt(18)
    v_exp_f32 v66, v66
    v_exp_f32 v67, v67
    v_exp_f32 v68, v68
    v_mfma_f32_32x32x8_bf16 v[32:47], a[12:13], v[212:213], 0
    v_exp_f32 v69, v69
    v_exp_f32 v70, v70
    v_exp_f32 v71, v71
    v_exp_f32 v72, v72
    v_mfma_f32_32x32x16_bf16 v[32:47], a[0:3], v[208:211], v[32:47]
    v_exp_f32 v73, v73
    v_exp_f32 v74, v74
    v_exp_f32 v75, v75
    v_exp_f32 v76, v76
    v_smfmac_f32_32x32x32_bf16 v[128:143], a[46:49], v[64:71], v2
    v_exp_f32 v77, v77
    v_exp_f32 v78, v78
    v_exp_f32 v79, v79
    v_exp_f32 v80, v80
    v_exp_f32 v81, v81
    v_smfmac_f32_32x32x32_bf16 v[128:143], a[50:53], v[72:79], v2
    buffer_load_dwordx4 v6, s[12:15], 0 offen offset:3072 sc1 lds
    s_add_u32 m0, s80, 14336
    buffer_load_dwordx4 a[112:115], v245, s[8:11], 0 offen offset:2048 sc1
    buffer_load_dwordx4 v249, s[12:15], 0 offen sc1 lds
    buffer_load_dwordx4 a[116:119], v246, s[8:11], 0 offen offset:2048 sc1
    buffer_load_dwordx4 a[120:123], v245, s[8:11], 0 offen offset:3072 sc1
    v_exp_f32 v82, v82
    v_exp_f32 v83, v83
    v_exp_f32 v84, v84
    v_mfma_f32_32x32x8_bf16 v[48:63], a[12:13], v[218:219], 0
    v_exp_f32 v85, v85
    v_exp_f32 v86, v86
    v_exp_f32 v87, v87
    v_exp_f32 v88, v88
    v_mfma_f32_32x32x16_bf16 v[48:63], a[0:3], v[214:217], v[48:63]
    v_exp_f32 v89, v89
    v_exp_f32 v90, v90
    v_exp_f32 v91, v91
    v_exp_f32 v92, v92
    v_smfmac_f32_32x32x32_bf16 v[144:159], a[46:49], v[80:87], v2
    v_exp_f32 v93, v93
    v_exp_f32 v94, v94
    v_exp_f32 v95, v95
    v_exp_f32 v32, v32
    v_exp_f32 v33, v33
    v_smfmac_f32_32x32x32_bf16 v[144:159], a[50:53], v[88:95], v2
    buffer_load_dwordx4 a[42:45], v6, s[4:7], 0 offen sc1
    buffer_load_dwordx2 a[54:55], v4, s[4:7], 0 offen offset:3072 sc1
    buffer_load_dwordx4 a[46:49], v3, s[4:7], 0 offen offset:1024 sc1
    buffer_load_dwordx4 a[50:53], v3, s[4:7], 0 offen offset:2048 sc1
    v_exp_f32 v34, v34
    v_exp_f32 v35, v35
    v_exp_f32 v36, v36
    v_mfma_f32_32x32x8_bf16 v[64:79], a[12:13], v[224:225], 0
    v_exp_f32 v37, v37
    v_exp_f32 v38, v38
    v_exp_f32 v39, v39
    v_exp_f32 v40, v40
    v_mfma_f32_32x32x16_bf16 v[64:79], a[0:3], v[220:223], v[64:79]
    v_exp_f32 v41, v41
    v_exp_f32 v42, v42
    v_exp_f32 v43, v43
    v_exp_f32 v44, v44
    v_smfmac_f32_32x32x32_bf16 v[96:111], a[4:7], v[32:39], v2
    v_exp_f32 v45, v45
    v_exp_f32 v46, v46
    v_exp_f32 v47, v47
    v_exp_f32 v48, v48
    v_exp_f32 v49, v49
    v_smfmac_f32_32x32x32_bf16 v[96:111], a[8:11], v[40:47], v2
    s_add_u32 s83, s83, 8192
    s_and_b32 s83, s83, 0x3ffff
    v_exp_f32 v50, v50
    v_exp_f32 v51, v51
    v_exp_f32 v52, v52
    v_mfma_f32_32x32x8_bf16 v[80:95], a[12:13], v[230:231], 0
    v_exp_f32 v53, v53
    v_exp_f32 v54, v54
    v_exp_f32 v55, v55
    v_exp_f32 v56, v56
    v_mfma_f32_32x32x16_bf16 v[80:95], a[0:3], v[226:229], v[80:95]
    v_exp_f32 v57, v57
    v_exp_f32 v58, v58
    v_exp_f32 v59, v59
    v_exp_f32 v60, v60
    v_smfmac_f32_32x32x32_bf16 v[112:127], a[4:7], v[48:55], v2
    s_add_u32 s4, s20, s83
    s_addc_u32 s5, s21, 0
    v_exp_f32 v61, v61
    v_exp_f32 v62, v62
    v_exp_f32 v63, v63
    v_exp_f32 v64, v64
    v_exp_f32 v65, v65
    v_smfmac_f32_32x32x32_bf16 v[112:127], a[8:11], v[56:63], v2
    s_waitcnt vmcnt(18)
    v_exp_f32 v66, v66
    v_exp_f32 v67, v67
    v_exp_f32 v68, v68
    v_mfma_f32_32x32x8_bf16 v[32:47], a[26:27], v[212:213], 0
    v_exp_f32 v69, v69
    v_exp_f32 v70, v70
    v_exp_f32 v71, v71
    v_exp_f32 v72, v72
    v_mfma_f32_32x32x16_bf16 v[32:47], a[14:17], v[208:211], v[32:47]
    v_exp_f32 v73, v73
    v_exp_f32 v74, v74
    v_exp_f32 v75, v75
    v_exp_f32 v76, v76
    v_smfmac_f32_32x32x32_bf16 v[128:143], a[4:7], v[64:71], v2
    s_add_u32 s12, s12, 10240
    s_addc_u32 s13, s13, 0
    s_add_u32 m0, s80, 20480
    v_exp_f32 v77, v77
    v_exp_f32 v78, v78
    v_exp_f32 v79, v79
    v_exp_f32 v80, v80
    v_exp_f32 v81, v81
    v_smfmac_f32_32x32x32_bf16 v[128:143], a[8:11], v[72:79], v2
    buffer_load_dwordx4 v6, s[12:15], 0 offen sc1 lds
    buffer_load_dwordx4 v6, s[12:15], 0 offen offset:1024 sc1 lds
    buffer_load_dwordx4 a[124:127], v246, s[8:11], 0 offen offset:3072 sc1
    s_add_u32 s8, s8, 4096
    s_addc_u32 s9, s9, 0
    buffer_load_dwordx4 a[128:131], v245, s[8:11], 0 offen sc1
    buffer_load_dwordx4 a[132:135], v246, s[8:11], 0 offen sc1
    v_exp_f32 v82, v82
    v_exp_f32 v83, v83
    v_exp_f32 v84, v84
    v_mfma_f32_32x32x8_bf16 v[48:63], a[26:27], v[218:219], 0
    v_exp_f32 v85, v85
    v_exp_f32 v86, v86
    v_exp_f32 v87, v87
    v_exp_f32 v88, v88
    v_mfma_f32_32x32x16_bf16 v[48:63], a[14:17], v[214:217], v[48:63]
    v_exp_f32 v89, v89
    v_exp_f32 v90, v90
    v_exp_f32 v91, v91
    v_exp_f32 v92, v92
    v_smfmac_f32_32x32x32_bf16 v[144:159], a[4:7], v[80:87], v2
    v_exp_f32 v93, v93
    v_exp_f32 v94, v94
    v_exp_f32 v95, v95
    v_exp_f32 v32, v32
    v_exp_f32 v33, v33
    v_smfmac_f32_32x32x32_bf16 v[144:159], a[8:11], v[88:95], v2
    buffer_load_dwordx4 a[0:3], v6, s[4:7], 0 offen sc1
    buffer_load_dwordx2 a[12:13], v4, s[4:7], 0 offen offset:3072 sc1
    buffer_load_dwordx4 a[4:7], v3, s[4:7], 0 offen offset:1024 sc1
    buffer_load_dwordx4 a[8:11], v3, s[4:7], 0 offen offset:2048 sc1
    v_exp_f32 v34, v34
    v_exp_f32 v35, v35
    v_exp_f32 v36, v36
    v_mfma_f32_32x32x8_bf16 v[64:79], a[26:27], v[224:225], 0
    v_exp_f32 v37, v37
    v_exp_f32 v38, v38
    v_exp_f32 v39, v39
    v_exp_f32 v40, v40
    v_mfma_f32_32x32x16_bf16 v[64:79], a[14:17], v[220:223], v[64:79]
    v_exp_f32 v41, v41
    v_exp_f32 v42, v42
    v_exp_f32 v43, v43
    v_exp_f32 v44, v44
    v_smfmac_f32_32x32x32_bf16 v[96:111], a[18:21], v[32:39], v2
    v_exp_f32 v45, v45
    v_exp_f32 v46, v46
    v_exp_f32 v47, v47
    v_exp_f32 v48, v48
    v_exp_f32 v49, v49
    v_smfmac_f32_32x32x32_bf16 v[96:111], a[22:25], v[40:47], v2
    s_add_u32 s83, s83, 8192
    s_and_b32 s83, s83, 0x3ffff
    v_exp_f32 v50, v50
    v_exp_f32 v51, v51
    v_exp_f32 v52, v52
    v_mfma_f32_32x32x8_bf16 v[80:95], a[26:27], v[230:231], 0
    v_exp_f32 v53, v53
    v_exp_f32 v54, v54
    v_exp_f32 v55, v55
    v_exp_f32 v56, v56
    v_mfma_f32_32x32x16_bf16 v[80:95], a[14:17], v[226:229], v[80:95]
    v_exp_f32 v57, v57
    v_exp_f32 v58, v58
    v_exp_f32 v59, v59
    v_exp_f32 v60, v60
    v_smfmac_f32_32x32x32_bf16 v[112:127], a[18:21], v[48:55], v2
    s_add_u32 s4, s20, s83
    s_addc_u32 s5, s21, 0
    v_exp_f32 v61, v61
    v_exp_f32 v62, v62
    v_exp_f32 v63, v63
    v_exp_f32 v64, v64
    v_exp_f32 v65, v65
    v_smfmac_f32_32x32x32_bf16 v[112:127], a[22:25], v[56:63], v2
    s_waitcnt vmcnt(18)
    v_exp_f32 v66, v66
    v_exp_f32 v67, v67
    v_exp_f32 v68, v68
    v_mfma_f32_32x32x8_bf16 v[32:47], a[40:41], v[212:213], 0
    v_exp_f32 v69, v69
    v_exp_f32 v70, v70
    v_exp_f32 v71, v71
    v_exp_f32 v72, v72
    v_mfma_f32_32x32x16_bf16 v[32:47], a[28:31], v[208:211], v[32:47]
    v_exp_f32 v73, v73
    v_exp_f32 v74, v74
    v_exp_f32 v75, v75
    v_exp_f32 v76, v76
    v_smfmac_f32_32x32x32_bf16 v[128:143], a[18:21], v[64:71], v2
    v_exp_f32 v77, v77
    v_exp_f32 v78, v78
    v_exp_f32 v79, v79
    v_exp_f32 v80, v80
    v_exp_f32 v81, v81
    v_smfmac_f32_32x32x32_bf16 v[128:143], a[22:25], v[72:79], v2
    buffer_load_dwordx4 v6, s[12:15], 0 offen offset:2048 sc1 lds
    buffer_load_dwordx4 v6, s[12:15], 0 offen offset:3072 sc1 lds
    buffer_load_dwordx4 a[136:139], v245, s[8:11], 0 offen offset:1024 sc1
    buffer_load_dwordx4 a[140:143], v246, s[8:11], 0 offen offset:1024 sc1
    buffer_load_dwordx4 a[144:147], v245, s[8:11], 0 offen offset:2048 sc1
    v_exp_f32 v82, v82
    v_exp_f32 v83, v83
    v_exp_f32 v84, v84
    v_mfma_f32_32x32x8_bf16 v[48:63], a[40:41], v[218:219], 0
    v_exp_f32 v85, v85
    v_exp_f32 v86, v86
    v_exp_f32 v87, v87
    v_exp_f32 v88, v88
    v_mfma_f32_32x32x16_bf16 v[48:63], a[28:31], v[214:217], v[48:63]
    v_exp_f32 v89, v89
    v_exp_f32 v90, v90
    v_exp_f32 v91, v91
    v_exp_f32 v92, v92
    v_smfmac_f32_32x32x32_bf16 v[144:159], a[18:21], v[80:87], v2
    v_exp_f32 v93, v93
    v_exp_f32 v94, v94
    v_exp_f32 v95, v95
    v_exp_f32 v32, v32
    v_exp_f32 v33, v33
    v_smfmac_f32_32x32x32_bf16 v[144:159], a[22:25], v[88:95], v2
    buffer_load_dwordx4 a[14:17], v6, s[4:7], 0 offen sc1
    buffer_load_dwordx2 a[26:27], v4, s[4:7], 0 offen offset:3072 sc1
    buffer_load_dwordx4 a[18:21], v3, s[4:7], 0 offen offset:1024 sc1
    buffer_load_dwordx4 a[22:25], v3, s[4:7], 0 offen offset:2048 sc1
    v_exp_f32 v34, v34
    v_exp_f32 v35, v35
    v_exp_f32 v36, v36
    v_mfma_f32_32x32x8_bf16 v[64:79], a[40:41], v[224:225], 0
    v_exp_f32 v37, v37
    v_exp_f32 v38, v38
    v_exp_f32 v39, v39
    v_exp_f32 v40, v40
    v_mfma_f32_32x32x16_bf16 v[64:79], a[28:31], v[220:223], v[64:79]
    v_exp_f32 v41, v41
    v_exp_f32 v42, v42
    v_exp_f32 v43, v43
    v_exp_f32 v44, v44
    v_smfmac_f32_32x32x32_bf16 v[96:111], a[32:35], v[32:39], v2
    v_exp_f32 v45, v45
    v_exp_f32 v46, v46
    v_exp_f32 v47, v47
    v_exp_f32 v48, v48
    v_exp_f32 v49, v49
    v_smfmac_f32_32x32x32_bf16 v[96:111], a[36:39], v[40:47], v2
    s_add_u32 s83, s83, 8192
    s_and_b32 s83, s83, 0x3ffff
    v_exp_f32 v50, v50
    v_exp_f32 v51, v51
    v_exp_f32 v52, v52
    v_mfma_f32_32x32x8_bf16 v[80:95], a[40:41], v[230:231], 0
    v_exp_f32 v53, v53
    v_exp_f32 v54, v54
    v_exp_f32 v55, v55
    v_exp_f32 v56, v56
    v_mfma_f32_32x32x16_bf16 v[80:95], a[28:31], v[226:229], v[80:95]
    v_exp_f32 v57, v57
    v_exp_f32 v58, v58
    v_exp_f32 v59, v59
    v_exp_f32 v60, v60
    v_smfmac_f32_32x32x32_bf16 v[112:127], a[32:35], v[48:55], v2
    s_add_u32 s4, s20, s83
    s_addc_u32 s5, s21, 0
    v_exp_f32 v61, v61
    v_exp_f32 v62, v62
    v_exp_f32 v63, v63
    v_exp_f32 v64, v64
    v_exp_f32 v65, v65
    v_smfmac_f32_32x32x32_bf16 v[112:127], a[36:39], v[56:63], v2
    s_waitcnt vmcnt(18)
    v_exp_f32 v66, v66
    v_exp_f32 v67, v67
    v_exp_f32 v68, v68
    v_mfma_f32_32x32x8_bf16 v[32:47], a[54:55], v[212:213], 0
    v_exp_f32 v69, v69
    v_exp_f32 v70, v70
    v_exp_f32 v71, v71
    v_exp_f32 v72, v72
    v_mfma_f32_32x32x16_bf16 v[32:47], a[42:45], v[208:211], v[32:47]
    v_exp_f32 v73, v73
    v_exp_f32 v74, v74
    v_exp_f32 v75, v75
    v_exp_f32 v76, v76
    v_smfmac_f32_32x32x32_bf16 v[128:143], a[32:35], v[64:71], v2
    s_add_u32 m0, s80, 24576
    v_exp_f32 v77, v77
    v_exp_f32 v78, v78
    v_exp_f32 v79, v79
    v_exp_f32 v80, v80
    v_exp_f32 v81, v81
    v_smfmac_f32_32x32x32_bf16 v[128:143], a[36:39], v[72:79], v2
    buffer_load_dwordx4 v249, s[12:15], 0 offen sc1 lds
    s_add_u32 s12, s12, 10240
    s_addc_u32 s13, s13, 0
    s_add_u32 m0, s80, 30720
    buffer_load_dwordx4 a[148:151], v246, s[8:11], 0 offen offset:2048 sc1
    buffer_load_dwordx4 v6, s[12:15], 0 offen sc1 lds
    buffer_load_dwordx4 a[152:155], v245, s[8:11], 0 offen offset:3072 sc1
    buffer_load_dwordx4 a[156:159], v246, s[8:11], 0 offen offset:3072 sc1
    v_exp_f32 v82, v82
    v_exp_f32 v83, v83
    v_exp_f32 v84, v84
    v_mfma_f32_32x32x8_bf16 v[48:63], a[54:55], v[218:219], 0
    v_exp_f32 v85, v85
    v_exp_f32 v86, v86
    v_exp_f32 v87, v87
    v_exp_f32 v88, v88
    v_mfma_f32_32x32x16_bf16 v[48:63], a[42:45], v[214:217], v[48:63]
    v_exp_f32 v89, v89
    v_exp_f32 v90, v90
    v_exp_f32 v91, v91
    v_exp_f32 v92, v92
    v_smfmac_f32_32x32x32_bf16 v[144:159], a[32:35], v[80:87], v2
    s_add_u32 s8, s8, s48
    s_addc_u32 s9, s9, s49
    v_exp_f32 v93, v93
    v_exp_f32 v94, v94
    v_exp_f32 v95, v95
    v_exp_f32 v32, v32
    v_exp_f32 v33, v33
    v_smfmac_f32_32x32x32_bf16 v[144:159], a[36:39], v[88:95], v2
    buffer_load_dwordx4 a[28:31], v6, s[4:7], 0 offen sc1
    buffer_load_dwordx2 a[40:41], v4, s[4:7], 0 offen offset:3072 sc1
    buffer_load_dwordx4 a[32:35], v3, s[4:7], 0 offen offset:1024 sc1
    buffer_load_dwordx4 a[36:39], v3, s[4:7], 0 offen offset:2048 sc1
    v_exp_f32 v34, v34
    v_exp_f32 v35, v35
    v_exp_f32 v36, v36
    v_mfma_f32_32x32x8_bf16 v[64:79], a[54:55], v[224:225], 0
    v_exp_f32 v37, v37
    v_exp_f32 v38, v38
    v_exp_f32 v39, v39
    v_exp_f32 v40, v40
    v_mfma_f32_32x32x16_bf16 v[64:79], a[42:45], v[220:223], v[64:79]
    v_exp_f32 v41, v41
    v_exp_f32 v42, v42
    v_exp_f32 v43, v43
    v_exp_f32 v44, v44
    v_smfmac_f32_32x32x32_bf16 v[96:111], a[46:49], v[32:39], v2
    v_exp_f32 v45, v45
    v_exp_f32 v46, v46
    v_exp_f32 v47, v47
    v_exp_f32 v48, v48
    v_exp_f32 v49, v49
    v_smfmac_f32_32x32x32_bf16 v[96:111], a[50:53], v[40:47], v2
    s_add_u32 s83, s83, 8192
    s_and_b32 s83, s83, 0x3ffff
    v_exp_f32 v50, v50
    v_exp_f32 v51, v51
    v_exp_f32 v52, v52
    v_mfma_f32_32x32x8_bf16 v[80:95], a[54:55], v[230:231], 0
    v_exp_f32 v53, v53
    v_exp_f32 v54, v54
    v_exp_f32 v55, v55
    v_exp_f32 v56, v56
    v_mfma_f32_32x32x16_bf16 v[80:95], a[42:45], v[226:229], v[80:95]
    v_exp_f32 v57, v57
    v_exp_f32 v58, v58
    v_exp_f32 v59, v59
    v_exp_f32 v60, v60
    v_smfmac_f32_32x32x32_bf16 v[112:127], a[46:49], v[48:55], v2
    s_add_u32 s4, s20, s83
    s_addc_u32 s5, s21, 0
    v_exp_f32 v61, v61
    v_exp_f32 v62, v62
    v_exp_f32 v63, v63
    v_exp_f32 v64, v64
    v_exp_f32 v65, v65
    v_smfmac_f32_32x32x32_bf16 v[112:127], a[50:53], v[56:63], v2
    s_waitcnt vmcnt(18)
    v_exp_f32 v66, v66
    v_exp_f32 v67, v67
    v_exp_f32 v68, v68
    v_mfma_f32_32x32x8_bf16 v[32:47], a[12:13], v[212:213], 0
    v_exp_f32 v69, v69
    v_exp_f32 v70, v70
    v_exp_f32 v71, v71
    v_exp_f32 v72, v72
    v_mfma_f32_32x32x16_bf16 v[32:47], a[0:3], v[208:211], v[32:47]
    v_exp_f32 v73, v73
    v_exp_f32 v74, v74
    v_exp_f32 v75, v75
    v_exp_f32 v76, v76
    v_smfmac_f32_32x32x32_bf16 v[128:143], a[46:49], v[64:71], v2
    v_exp_f32 v77, v77
    v_exp_f32 v78, v78
    v_exp_f32 v79, v79
    v_exp_f32 v80, v80
    v_exp_f32 v81, v81
    v_smfmac_f32_32x32x32_bf16 v[128:143], a[50:53], v[72:79], v2
    buffer_load_dwordx4 v6, s[12:15], 0 offen offset:1024 sc1 lds
    buffer_load_dwordx4 v6, s[12:15], 0 offen offset:2048 sc1 lds
    buffer_load_dwordx4 a[160:163], v245, s[8:11], 0 offen sc1
    buffer_load_dwordx4 a[164:167], v246, s[8:11], 0 offen sc1
    buffer_load_dwordx4 a[168:171], v245, s[8:11], 0 offen offset:1024 sc1
    v_exp_f32 v82, v82
    v_exp_f32 v83, v83
    v_exp_f32 v84, v84
    v_mfma_f32_32x32x8_bf16 v[48:63], a[12:13], v[218:219], 0
    v_exp_f32 v85, v85
    v_exp_f32 v86, v86
    v_exp_f32 v87, v87
    v_exp_f32 v88, v88
    v_mfma_f32_32x32x16_bf16 v[48:63], a[0:3], v[214:217], v[48:63]
    v_exp_f32 v89, v89
    v_exp_f32 v90, v90
    v_exp_f32 v91, v91
    v_exp_f32 v92, v92
    v_smfmac_f32_32x32x32_bf16 v[144:159], a[46:49], v[80:87], v2
    v_exp_f32 v93, v93
    v_exp_f32 v94, v94
    v_exp_f32 v95, v95
    v_exp_f32 v32, v32
    v_exp_f32 v33, v33
    v_smfmac_f32_32x32x32_bf16 v[144:159], a[50:53], v[88:95], v2
    buffer_load_dwordx4 a[42:45], v6, s[4:7], 0 offen sc1
    buffer_load_dwordx2 a[54:55], v4, s[4:7], 0 offen offset:3072 sc1
    buffer_load_dwordx4 a[46:49], v3, s[4:7], 0 offen offset:1024 sc1
    buffer_load_dwordx4 a[50:53], v3, s[4:7], 0 offen offset:2048 sc1
    v_exp_f32 v34, v34
    v_exp_f32 v35, v35
    v_exp_f32 v36, v36
    v_mfma_f32_32x32x8_bf16 v[64:79], a[12:13], v[224:225], 0
    v_exp_f32 v37, v37
    v_exp_f32 v38, v38
    v_exp_f32 v39, v39
    v_exp_f32 v40, v40
    v_mfma_f32_32x32x16_bf16 v[64:79], a[0:3], v[220:223], v[64:79]
    v_exp_f32 v41, v41
    v_exp_f32 v42, v42
    v_exp_f32 v43, v43
    v_exp_f32 v44, v44
    v_smfmac_f32_32x32x32_bf16 v[96:111], a[4:7], v[32:39], v2
    v_exp_f32 v45, v45
    v_exp_f32 v46, v46
    v_exp_f32 v47, v47
    v_exp_f32 v48, v48
    v_exp_f32 v49, v49
    v_smfmac_f32_32x32x32_bf16 v[96:111], a[8:11], v[40:47], v2
    s_add_u32 s83, s83, 8192
    s_and_b32 s83, s83, 0x3ffff
    v_exp_f32 v50, v50
    v_exp_f32 v51, v51
    v_exp_f32 v52, v52
    v_mfma_f32_32x32x8_bf16 v[80:95], a[12:13], v[230:231], 0
    v_exp_f32 v53, v53
    v_exp_f32 v54, v54
    v_exp_f32 v55, v55
    v_exp_f32 v56, v56
    v_mfma_f32_32x32x16_bf16 v[80:95], a[0:3], v[226:229], v[80:95]
    v_exp_f32 v57, v57
    v_exp_f32 v58, v58
    v_exp_f32 v59, v59
    v_exp_f32 v60, v60
    v_smfmac_f32_32x32x32_bf16 v[112:127], a[4:7], v[48:55], v2
    s_add_u32 s4, s20, s83
    s_addc_u32 s5, s21, 0
    v_exp_f32 v61, v61
    v_exp_f32 v62, v62
    v_exp_f32 v63, v63
    v_exp_f32 v64, v64
    v_exp_f32 v65, v65
    v_smfmac_f32_32x32x32_bf16 v[112:127], a[8:11], v[56:63], v2
    s_waitcnt vmcnt(18)
    v_exp_f32 v66, v66
    v_exp_f32 v67, v67
    v_exp_f32 v68, v68
L_pad7:
    s_cbranch_execz L_back
    v_mfma_f32_32x32x8_bf16 v[32:47], a[26:27], v[212:213], 0
    v_exp_f32 v69, v69
    v_exp_f32 v70, v70
    v_exp_f32 v71, v71
    v_exp_f32 v72, v72
    v_mfma_f32_32x32x16_bf16 v[32:47], a[14:17], v[208:211], v[32:47]
    v_exp_f32 v73, v73
    v_exp_f32 v74, v74
    v_exp_f32 v75, v75
    v_exp_f32 v76, v76
    v_smfmac_f32_32x32x32_bf16 v[128:143], a[4:7], v[64:71], v2
    v_exp_f32 v77, v77
    v_exp_f32 v78, v78
    v_exp_f32 v79, v79
    v_exp_f32 v80, v80
    v_exp_f32 v81, v81
    v_smfmac_f32_32x32x32_bf16 v[128:143], a[8:11], v[72:79], v2
    buffer_load_dwordx4 v6, s[12:15], 0 offen offset:3072 sc1 lds
    s_add_u32 m0, s80, 34816
    buffer_load_dwordx4 a[172:175], v246, s[8:11], 0 offen offset:1024 sc1
    buffer_load_dwordx4 v249, s[12:15], 0 offen sc1 lds
    buffer_load_dwordx4 a[176:179], v245, s[8:11], 0 offen offset:2048 sc1
    buffer_load_dwordx4 a[180:183], v246, s[8:11], 0 offen offset:2048 sc1
    v_exp_f32 v82, v82
    v_exp_f32 v83, v83
    v_exp_f32 v84, v84
    v_mfma_f32_32x32x8_bf16 v[48:63], a[26:27], v[218:219], 0
    v_exp_f32 v85, v85
    v_exp_f32 v86, v86
    v_exp_f32 v87, v87
    v_exp_f32 v88, v88
    v_mfma_f32_32x32x16_bf16 v[48:63], a[14:17], v[214:217], v[48:63]
    v_exp_f32 v89, v89
    v_exp_f32 v90, v90
    v_exp_f32 v91, v91
    v_exp_f32 v92, v92
    v_smfmac_f32_32x32x32_bf16 v[144:159], a[4:7], v[80:87], v2
    v_exp_f32 v93, v93
    v_exp_f32 v94, v94
    v_exp_f32 v95, v95
    v_exp_f32 v32, v32
    v_exp_f32 v33, v33
    v_smfmac_f32_32x32x32_bf16 v[144:159], a[8:11], v[88:95], v2
    buffer_load_dwordx4 a[0:3], v6, s[4:7], 0 offen sc1
    buffer_load_dwordx2 a[12:13], v4, s[4:7], 0 offen offset:3072 sc1
    buffer_load_dwordx4 a[4:7], v3, s[4:7], 0 offen offset:1024 sc1
    buffer_load_dwordx4 a[8:11], v3, s[4:7], 0 offen offset:2048 sc1
    v_exp_f32 v34, v34
    v_exp_f32 v35, v35
    v_exp_f32 v36, v36
    v_mfma_f32_32x32x8_bf16 v[64:79], a[26:27], v[224:225], 0
    v_exp_f32 v37, v37
    v_exp_f32 v38, v38
    v_exp_f32 v39, v39
    v_exp_f32 v40, v40
    v_mfma_f32_32x32x16_bf16 v[64:79], a[14:17], v[220:223], v[64:79]
    v_exp_f32 v41, v41
    v_exp_f32 v42, v42
    v_exp_f32 v43, v43
    v_exp_f32 v44, v44
    v_smfmac_f32_32x32x32_bf16 v[96:111], a[18:21], v[32:39], v2
    v_exp_f32 v45, v45
    v_exp_f32 v46, v46
    v_exp_f32 v47, v47
    v_exp_f32 v48, v48
    v_exp_f32 v49, v49
    v_smfmac_f32_32x32x32_bf16 v[96:111], a[22:25], v[40:47], v2
    s_add_u32 s83, s83, 8192
    s_and_b32 s83, s83, 0x3ffff
    v_exp_f32 v50, v50
    v_exp_f32 v51, v51
    v_exp_f32 v52, v52
    v_mfma_f32_32x32x8_bf16 v[80:95], a[26:27], v[230:231], 0
    v_exp_f32 v53, v53
    v_exp_f32 v54, v54
    v_exp_f32 v55, v55
    v_exp_f32 v56, v56
    v_mfma_f32_32x32x16_bf16 v[80:95], a[14:17], v[226:229], v[80:95]
    v_exp_f32 v57, v57
    v_exp_f32 v58, v58
    v_exp_f32 v59, v59
    v_exp_f32 v60, v60
    v_smfmac_f32_32x32x32_bf16 v[112:127], a[18:21], v[48:55], v2
    s_add_u32 s4, s20, s83
    s_addc_u32 s5, s21, 0
    v_exp_f32 v61, v61
    v_exp_f32 v62, v62
    v_exp_f32 v63, v63
    v_exp_f32 v64, v64
    v_exp_f32 v65, v65
    v_smfmac_f32_32x32x32_bf16 v[112:127], a[22:25], v[56:63], v2
    s_waitcnt vmcnt(18)
    v_exp_f32 v66, v66
    v_exp_f32 v67, v67
    v_exp_f32 v68, v68
    v_mfma_f32_32x32x8_bf16 v[32:47], a[40:41], v[212:213], 0
    v_exp_f32 v69, v69
    v_exp_f32 v70, v70
    v_exp_f32 v71, v71
    v_exp_f32 v72, v72
    v_mfma_f32_32x32x16_bf16 v[32:47], a[28:31], v[208:211], v[32:47]
    v_exp_f32 v73, v73
    v_exp_f32 v74, v74
    v_exp_f32 v75, v75
    v_exp_f32 v76, v76
    v_smfmac_f32_32x32x32_bf16 v[128:143], a[18:21], v[64:71], v2
    s_add_u32 s12, s12, 10240
    s_addc_u32 s13, s13, 0
    s_add_u32 m0, s80, 40960
    v_exp_f32 v77, v77
    v_exp_f32 v78, v78
    v_exp_f32 v79, v79
    v_exp_f32 v80, v80
    v_exp_f32 v81, v81
    v_smfmac_f32_32x32x32_bf16 v[128:143], a[22:25], v[72:79], v2
    buffer_load_dwordx4 v6, s[12:15], 0 offen sc1 lds
    buffer_load_dwordx4 v6, s[12:15], 0 offen offset:1024 sc1 lds
    buffer_load_dwordx4 a[184:187], v245, s[8:11], 0 offen offset:3072 sc1
    buffer_load_dwordx4 a[188:191], v246, s[8:11], 0 offen offset:3072 sc1
    s_add_u32 s8, s8, 4096
    s_addc_u32 s9, s9, 0
    buffer_load_dwordx4 a[192:195], v245, s[8:11], 0 offen sc1
    v_exp_f32 v82, v82
    v_exp_f32 v83, v83
    v_exp_f32 v84, v84
    v_mfma_f32_32x32x8_bf16 v[48:63], a[40:41], v[218:219], 0
    v_exp_f32 v85, v85
    v_exp_f32 v86, v86
    v_exp_f32 v87, v87
    v_exp_f32 v88, v88
    v_mfma_f32_32x32x16_bf16 v[48:63], a[28:31], v[214:217], v[48:63]
    v_exp_f32 v89, v89
    v_exp_f32 v90, v90
    v_exp_f32 v91, v91
    v_exp_f32 v92, v92
    v_smfmac_f32_32x32x32_bf16 v[144:159], a[18:21], v[80:87], v2
    v_exp_f32 v93, v93
    v_exp_f32 v94, v94
    v_exp_f32 v95, v95
    v_exp_f32 v32, v32
    v_exp_f32 v33, v33
    v_smfmac_f32_32x32x32_bf16 v[144:159], a[22:25], v[88:95], v2
    buffer_load_dwordx4 a[14:17], v6, s[4:7], 0 offen sc1
    buffer_load_dwordx2 a[26:27], v4, s[4:7], 0 offen offset:3072 sc1
    buffer_load_dwordx4 a[18:21], v3, s[4:7], 0 offen offset:1024 sc1
    buffer_load_dwordx4 a[22:25], v3, s[4:7], 0 offen offset:2048 sc1
    v_exp_f32 v34, v34
    v_exp_f32 v35, v35
    v_exp_f32 v36, v36
    v_mfma_f32_32x32x8_bf16 v[64:79], a[40:41], v[224:225], 0
    v_exp_f32 v37, v37
    v_exp_f32 v38, v38
    v_exp_f32 v39, v39
    v_exp_f32 v40, v40
    v_mfma_f32_32x32x16_bf16 v[64:79], a[28:31], v[220:223], v[64:79]
    v_exp_f32 v41, v41
    v_exp_f32 v42, v42
    v_exp_f32 v43, v43
    v_exp_f32 v44, v44
    v_smfmac_f32_32x32x32_bf16 v[96:111], a[32:35], v[32:39], v2
    v_exp_f32 v45, v45
    v_exp_f32 v46, v46
    v_exp_f32 v47, v47
    v_exp_f32 v48, v48
    v_exp_f32 v49, v49
    v_smfmac_f32_32x32x32_bf16 v[96:111], a[36:39], v[40:47], v2
    s_add_u32 s83, s83, 8192
    s_and_b32 s83, s83, 0x3ffff
    v_exp_f32 v50, v50
    v_exp_f32 v51, v51
    v_exp_f32 v52, v52
    v_mfma_f32_32x32x8_bf16 v[80:95], a[40:41], v[230:231], 0
    v_exp_f32 v53, v53
    v_exp_f32 v54, v54
    v_exp_f32 v55, v55
    v_exp_f32 v56, v56
    v_mfma_f32_32x32x16_bf16 v[80:95], a[28:31], v[226:229], v[80:95]
    v_exp_f32 v57, v57
    v_exp_f32 v58, v58
    v_exp_f32 v59, v59
    v_exp_f32 v60, v60
    v_smfmac_f32_32x32x32_bf16 v[112:127], a[32:35], v[48:55], v2
    s_add_u32 s4, s20, s83
    s_addc_u32 s5, s21, 0
    v_exp_f32 v61, v61
    v_exp_f32 v62, v62
    v_exp_f32 v63, v63
    v_exp_f32 v64, v64
    v_exp_f32 v65, v65
    v_smfmac_f32_32x32x32_bf16 v[112:127], a[36:39], v[56:63], v2
    s_waitcnt vmcnt(18)
    v_exp_f32 v66, v66
    v_exp_f32 v67, v67
    v_exp_f32 v68, v68
    v_mfma_f32_32x32x8_bf16 v[32:47], a[54:55], v[212:213], 0
    v_exp_f32 v69, v69
    v_exp_f32 v70, v70
    v_exp_f32 v71, v71
    v_exp_f32 v72, v72
    v_mfma_f32_32x32x16_bf16 v[32:47], a[42:45], v[208:211], v[32:47]
    v_exp_f32 v73, v73
    v_exp_f32 v74, v74
    v_exp_f32 v75, v75
    v_exp_f32 v76, v76
    v_smfmac_f32_32x32x32_bf16 v[128:143], a[32:35], v[64:71], v2
    v_exp_f32 v77, v77
    v_exp_f32 v78, v78
    v_exp_f32 v79, v79
    v_exp_f32 v80, v80
    v_exp_f32 v81, v81
    v_smfmac_f32_32x32x32_bf16 v[128:143], a[36:39], v[72:79], v2
    buffer_load_dwordx4 v6, s[12:15], 0 offen offset:2048 sc1 lds
    buffer_load_dwordx4 v6, s[12:15], 0 offen offset:3072 sc1 lds
    buffer_load_dwordx4 a[196:199], v246, s[8:11], 0 offen sc1
    buffer_load_dwordx4 a[200:203], v245, s[8:11], 0 offen offset:1024 sc1
    buffer_load_dwordx4 a[204:207], v246, s[8:11], 0 offen offset:1024 sc1
    v_exp_f32 v82, v82
    v_exp_f32 v83, v83
    v_exp_f32 v84, v84
    v_mfma_f32_32x32x8_bf16 v[48:63], a[54:55], v[218:219], 0
    v_exp_f32 v85, v85
    v_exp_f32 v86, v86
    v_exp_f32 v87, v87
    v_exp_f32 v88, v88
    v_mfma_f32_32x32x16_bf16 v[48:63], a[42:45], v[214:217], v[48:63]
    v_exp_f32 v89, v89
    v_exp_f32 v90, v90
    v_exp_f32 v91, v91
    v_exp_f32 v92, v92
    v_smfmac_f32_32x32x32_bf16 v[144:159], a[32:35], v[80:87], v2
    v_exp_f32 v93, v93
    v_exp_f32 v94, v94
    v_exp_f32 v95, v95
    v_exp_f32 v32, v32
    v_exp_f32 v33, v33
    v_smfmac_f32_32x32x32_bf16 v[144:159], a[36:39], v[88:95], v2
    buffer_load_dwordx4 a[28:31], v6, s[4:7], 0 offen sc1
    buffer_load_dwordx2 a[40:41], v4, s[4:7], 0 offen offset:3072 sc1
    buffer_load_dwordx4 a[32:35], v3, s[4:7], 0 offen offset:1024 sc1
    buffer_load_dwordx4 a[36:39], v3, s[4:7], 0 offen offset:2048 sc1
    v_exp_f32 v34, v34
    v_exp_f32 v35, v35
    v_exp_f32 v36, v36
    v_mfma_f32_32x32x8_bf16 v[64:79], a[54:55], v[224:225], 0
    v_exp_f32 v37, v37
    v_exp_f32 v38, v38
    v_exp_f32 v39, v39
    v_exp_f32 v40, v40
    v_mfma_f32_32x32x16_bf16 v[64:79], a[42:45], v[220:223], v[64:79]
    v_exp_f32 v41, v41
    v_exp_f32 v42, v42
    v_exp_f32 v43, v43
    v_exp_f32 v44, v44
    v_smfmac_f32_32x32x32_bf16 v[96:111], a[46:49], v[32:39], v2
    v_exp_f32 v45, v45
    v_exp_f32 v46, v46
    v_exp_f32 v47, v47
    v_exp_f32 v48, v48
    v_exp_f32 v49, v49
    v_smfmac_f32_32x32x32_bf16 v[96:111], a[50:53], v[40:47], v2
    s_add_u32 s83, s83, 8192
    s_and_b32 s83, s83, 0x3ffff
    v_exp_f32 v50, v50
    v_exp_f32 v51, v51
    v_exp_f32 v52, v52
    v_mfma_f32_32x32x8_bf16 v[80:95], a[54:55], v[230:231], 0
    v_exp_f32 v53, v53
    v_exp_f32 v54, v54
    v_exp_f32 v55, v55
    v_exp_f32 v56, v56
    v_mfma_f32_32x32x16_bf16 v[80:95], a[42:45], v[226:229], v[80:95]
    v_exp_f32 v57, v57
    v_exp_f32 v58, v58
    v_exp_f32 v59, v59
    v_exp_f32 v60, v60
    v_smfmac_f32_32x32x32_bf16 v[112:127], a[46:49], v[48:55], v2
    s_add_u32 s4, s20, s83
    s_addc_u32 s5, s21, 0
    v_exp_f32 v61, v61
    v_exp_f32 v62, v62
    v_exp_f32 v63, v63
    v_exp_f32 v64, v64
    v_exp_f32 v65, v65
    v_smfmac_f32_32x32x32_bf16 v[112:127], a[50:53], v[56:63], v2
    s_waitcnt vmcnt(18)
    v_exp_f32 v66, v66
    v_exp_f32 v67, v67
    v_exp_f32 v68, v68
    v_mfma_f32_32x32x8_bf16 v[32:47], a[12:13], v[212:213], 0
    v_exp_f32 v69, v69
    v_exp_f32 v70, v70
    v_exp_f32 v71, v71
    v_exp_f32 v72, v72
    v_mfma_f32_32x32x16_bf16 v[32:47], a[0:3], v[208:211], v[32:47]
    v_exp_f32 v73, v73
    v_exp_f32 v74, v74
    v_exp_f32 v75, v75
    v_exp_f32 v76, v76
    v_smfmac_f32_32x32x32_bf16 v[128:143], a[46:49], v[64:71], v2
    s_add_u32 m0, s80, 45056
    v_exp_f32 v77, v77
    v_exp_f32 v78, v78
    v_exp_f32 v79, v79
    v_exp_f32 v80, v80
    v_exp_f32 v81, v81
    v_smfmac_f32_32x32x32_bf16 v[128:143], a[50:53], v[72:79], v2
    buffer_load_dwordx4 v249, s[12:15], 0 offen sc1 lds
    s_add_u32 s12, s12, 10240
    s_addc_u32 s13, s13, 0
    s_add_u32 m0, s80, 51200
    buffer_load_dwordx4 a[208:211], v245, s[8:11], 0 offen offset:2048 sc1
    buffer_load_dwordx4 v6, s[12:15], 0 offen sc1 lds
    buffer_load_dwordx4 a[212:215], v246, s[8:11], 0 offen offset:2048 sc1
    buffer_load_dwordx4 a[216:219], v245, s[8:11], 0 offen offset:3072 sc1
    v_exp_f32 v82, v82
    v_exp_f32 v83, v83
    v_exp_f32 v84, v84
    v_mfma_f32_32x32x8_bf16 v[48:63], a[12:13], v[218:219], 0
    v_exp_f32 v85, v85
    v_exp_f32 v86, v86
    v_exp_f32 v87, v87
    v_exp_f32 v88, v88
    v_mfma_f32_32x32x16_bf16 v[48:63], a[0:3], v[214:217], v[48:63]
    v_exp_f32 v89, v89
    v_exp_f32 v90, v90
    v_exp_f32 v91, v91
    v_exp_f32 v92, v92
    v_smfmac_f32_32x32x32_bf16 v[144:159], a[46:49], v[80:87], v2
    v_exp_f32 v93, v93
    v_exp_f32 v94, v94
    v_exp_f32 v95, v95
    v_exp_f32 v32, v32
    v_exp_f32 v33, v33
    v_smfmac_f32_32x32x32_bf16 v[144:159], a[50:53], v[88:95], v2
    buffer_load_dwordx4 a[42:45], v6, s[4:7], 0 offen sc1
    buffer_load_dwordx2 a[54:55], v4, s[4:7], 0 offen offset:3072 sc1
    buffer_load_dwordx4 a[46:49], v3, s[4:7], 0 offen offset:1024 sc1
    buffer_load_dwordx4 a[50:53], v3, s[4:7], 0 offen offset:2048 sc1
    v_exp_f32 v34, v34
    v_exp_f32 v35, v35
    v_exp_f32 v36, v36
    v_mfma_f32_32x32x8_bf16 v[64:79], a[12:13], v[224:225], 0
    v_exp_f32 v37, v37
    v_exp_f32 v38, v38
    v_exp_f32 v39, v39
    v_exp_f32 v40, v40
    v_mfma_f32_32x32x16_bf16 v[64:79], a[0:3], v[220:223], v[64:79]
    v_exp_f32 v41, v41
    v_exp_f32 v42, v42
    v_exp_f32 v43, v43
    v_exp_f32 v44, v44
    v_smfmac_f32_32x32x32_bf16 v[96:111], a[4:7], v[32:39], v2
    v_exp_f32 v45, v45
    v_exp_f32 v46, v46
    v_exp_f32 v47, v47
    v_exp_f32 v48, v48
    v_exp_f32 v49, v49
    v_smfmac_f32_32x32x32_bf16 v[96:111], a[8:11], v[40:47], v2
    s_add_u32 s83, s83, 8192
    s_and_b32 s83, s83, 0x3ffff
    v_exp_f32 v50, v50
    v_exp_f32 v51, v51
    v_exp_f32 v52, v52
    v_mfma_f32_32x32x8_bf16 v[80:95], a[12:13], v[230:231], 0
    v_exp_f32 v53, v53
    v_exp_f32 v54, v54
    v_exp_f32 v55, v55
    v_exp_f32 v56, v56
    v_mfma_f32_32x32x16_bf16 v[80:95], a[0:3], v[226:229], v[80:95]
    v_exp_f32 v57, v57
    v_exp_f32 v58, v58
    v_exp_f32 v59, v59
    v_exp_f32 v60, v60
    v_smfmac_f32_32x32x32_bf16 v[112:127], a[4:7], v[48:55], v2
    s_add_u32 s4, s20, s83
    s_addc_u32 s5, s21, 0
    v_exp_f32 v61, v61
    v_exp_f32 v62, v62
    v_exp_f32 v63, v63
    v_exp_f32 v64, v64
    v_exp_f32 v65, v65
    v_smfmac_f32_32x32x32_bf16 v[112:127], a[8:11], v[56:63], v2
    s_waitcnt vmcnt(18)
    v_exp_f32 v66, v66
    v_exp_f32 v67, v67
    v_exp_f32 v68, v68
    v_mfma_f32_32x32x8_bf16 v[32:47], a[26:27], v[212:213], 0
    v_exp_f32 v69, v69
    v_exp_f32 v70, v70
    v_exp_f32 v71, v71
    v_exp_f32 v72, v72
    v_mfma_f32_32x32x16_bf16 v[32:47], a[14:17], v[208:211], v[32:47]
    v_exp_f32 v73, v73
    v_exp_f32 v74, v74
    v_exp_f32 v75, v75
    v_exp_f32 v76, v76
    v_smfmac_f32_32x32x32_bf16 v[128:143], a[4:7], v[64:71], v2
    v_exp_f32 v77, v77
    v_exp_f32 v78, v78
    v_exp_f32 v79, v79
    v_exp_f32 v80, v80
    v_exp_f32 v81, v81
    v_smfmac_f32_32x32x32_bf16 v[128:143], a[8:11], v[72:79], v2
    buffer_load_dwordx4 v6, s[12:15], 0 offen offset:1024 sc1 lds
    buffer_load_dwordx4 v6, s[12:15], 0 offen offset:2048 sc1 lds
    buffer_load_dwordx4 a[220:223], v246, s[8:11], 0 offen offset:3072 sc1
    s_add_u32 s8, s8, 4096
    s_addc_u32 s9, s9, 0
    buffer_load_dwordx4 a[224:227], v245, s[8:11], 0 offen sc1
    buffer_load_dwordx4 a[228:231], v246, s[8:11], 0 offen sc1
    v_exp_f32 v82, v82
    v_exp_f32 v83, v83
    v_exp_f32 v84, v84
    v_mfma_f32_32x32x8_bf16 v[48:63], a[26:27], v[218:219], 0
    v_exp_f32 v85, v85
    v_exp_f32 v86, v86
    v_exp_f32 v87, v87
    v_exp_f32 v88, v88
    v_mfma_f32_32x32x16_bf16 v[48:63], a[14:17], v[214:217], v[48:63]
    v_exp_f32 v89, v89
    v_exp_f32 v90, v90
    v_exp_f32 v91, v91
    v_exp_f32 v92, v92
    v_smfmac_f32_32x32x32_bf16 v[144:159], a[4:7], v[80:87], v2
    v_exp_f32 v93, v93
    v_exp_f32 v94, v94
    v_exp_f32 v95, v95
    v_exp_f32 v32, v32
    v_exp_f32 v33, v33
    v_smfmac_f32_32x32x32_bf16 v[144:159], a[8:11], v[88:95], v2
    v_exp_f32 v34, v34
    v_exp_f32 v35, v35
    v_exp_f32 v36, v36
    v_mfma_f32_32x32x8_bf16 v[64:79], a[26:27], v[224:225], 0
    v_exp_f32 v37, v37
    v_exp_f32 v38, v38
    v_exp_f32 v39, v39
    v_exp_f32 v40, v40
    v_mfma_f32_32x32x16_bf16 v[64:79], a[14:17], v[220:223], v[64:79]
    v_exp_f32 v41, v41
    v_exp_f32 v42, v42
    v_exp_f32 v43, v43
    v_exp_f32 v44, v44
    v_smfmac_f32_32x32x32_bf16 v[96:111], a[18:21], v[32:39], v2
    v_exp_f32 v45, v45
    v_exp_f32 v46, v46
    v_exp_f32 v47, v47
    v_exp_f32 v48, v48
    v_exp_f32 v49, v49
    v_smfmac_f32_32x32x32_bf16 v[96:111], a[22:25], v[40:47], v2
    v_exp_f32 v50, v50
    v_exp_f32 v51, v51
    v_exp_f32 v52, v52
    v_mfma_f32_32x32x8_bf16 v[80:95], a[26:27], v[230:231], 0
    v_exp_f32 v53, v53
    v_exp_f32 v54, v54
    v_exp_f32 v55, v55
    v_exp_f32 v56, v56
    v_mfma_f32_32x32x16_bf16 v[80:95], a[14:17], v[226:229], v[80:95]
    v_exp_f32 v57, v57
    v_exp_f32 v58, v58
    v_exp_f32 v59, v59
    v_exp_f32 v60, v60
    v_smfmac_f32_32x32x32_bf16 v[112:127], a[18:21], v[48:55], v2
    v_exp_f32 v61, v61
    v_exp_f32 v62, v62
    v_exp_f32 v63, v63
    v_exp_f32 v64, v64
    v_exp_f32 v65, v65
    v_smfmac_f32_32x32x32_bf16 v[112:127], a[22:25], v[56:63], v2
    s_waitcnt vmcnt(14)
    v_exp_f32 v66, v66
    v_exp_f32 v67, v67
    v_exp_f32 v68, v68
    v_mfma_f32_32x32x8_bf16 v[32:47], a[40:41], v[212:213], 0
    v_exp_f32 v69, v69
    v_exp_f32 v70, v70
    v_exp_f32 v71, v71
    v_exp_f32 v72, v72
    v_mfma_f32_32x32x16_bf16 v[32:47], a[28:31], v[208:211], v[32:47]
    v_exp_f32 v73, v73
    v_exp_f32 v74, v74
    v_exp_f32 v75, v75
    v_exp_f32 v76, v76
    v_smfmac_f32_32x32x32_bf16 v[128:143], a[18:21], v[64:71], v2
    v_exp_f32 v77, v77
    v_exp_f32 v78, v78
    v_exp_f32 v79, v79
    v_exp_f32 v80, v80
    v_exp_f32 v81, v81
    v_smfmac_f32_32x32x32_bf16 v[128:143], a[22:25], v[72:79], v2
    buffer_load_dwordx4 v6, s[12:15], 0 offen offset:3072 sc1 lds
    s_add_u32 m0, s80, 55296
    buffer_load_dwordx4 a[232:235], v245, s[8:11], 0 offen offset:1024 sc1
    buffer_load_dwordx4 v249, s[12:15], 0 offen sc1 lds
    buffer_load_dwordx4 a[236:239], v246, s[8:11], 0 offen offset:1024 sc1
    buffer_load_dwordx4 a[240:243], v245, s[8:11], 0 offen offset:2048 sc1
    v_exp_f32 v82, v82
    v_exp_f32 v83, v83
    v_exp_f32 v84, v84
    v_mfma_f32_32x32x8_bf16 v[48:63], a[40:41], v[218:219], 0
    v_exp_f32 v85, v85
    v_exp_f32 v86, v86
    v_exp_f32 v87, v87
    v_exp_f32 v88, v88
    v_mfma_f32_32x32x16_bf16 v[48:63], a[28:31], v[214:217], v[48:63]
    v_exp_f32 v89, v89
    v_exp_f32 v90, v90
    v_exp_f32 v91, v91
    v_exp_f32 v92, v92
    v_smfmac_f32_32x32x32_bf16 v[144:159], a[18:21], v[80:87], v2
    v_exp_f32 v93, v93
    v_exp_f32 v94, v94
    v_exp_f32 v95, v95
    v_exp_f32 v32, v32
    v_exp_f32 v33, v33
    v_smfmac_f32_32x32x32_bf16 v[144:159], a[22:25], v[88:95], v2
    v_exp_f32 v34, v34
    v_exp_f32 v35, v35
    v_exp_f32 v36, v36
    v_mfma_f32_32x32x8_bf16 v[64:79], a[40:41], v[224:225], 0
    v_exp_f32 v37, v37
    v_exp_f32 v38, v38
    v_exp_f32 v39, v39
    v_exp_f32 v40, v40
    v_mfma_f32_32x32x16_bf16 v[64:79], a[28:31], v[220:223], v[64:79]
    v_exp_f32 v41, v41
    v_exp_f32 v42, v42
    v_exp_f32 v43, v43
    v_exp_f32 v44, v44
    v_smfmac_f32_32x32x32_bf16 v[96:111], a[32:35], v[32:39], v2
    v_exp_f32 v45, v45
    v_exp_f32 v46, v46
    v_exp_f32 v47, v47
    v_exp_f32 v48, v48
    v_exp_f32 v49, v49
    v_smfmac_f32_32x32x32_bf16 v[96:111], a[36:39], v[40:47], v2
    v_exp_f32 v50, v50
    v_exp_f32 v51, v51
    v_exp_f32 v52, v52
    v_mfma_f32_32x32x8_bf16 v[80:95], a[40:41], v[230:231], 0
    v_exp_f32 v53, v53
    v_exp_f32 v54, v54
    v_exp_f32 v55, v55
    v_exp_f32 v56, v56
    v_mfma_f32_32x32x16_bf16 v[80:95], a[28:31], v[226:229], v[80:95]
    v_exp_f32 v57, v57
    v_exp_f32 v58, v58
    v_exp_f32 v59, v59
    v_exp_f32 v60, v60
    v_smfmac_f32_32x32x32_bf16 v[112:127], a[32:35], v[48:55], v2
    v_exp_f32 v61, v61
    v_exp_f32 v62, v62
    v_exp_f32 v63, v63
    v_exp_f32 v64, v64
    v_exp_f32 v65, v65
    v_smfmac_f32_32x32x32_bf16 v[112:127], a[36:39], v[56:63], v2
    s_waitcnt vmcnt(10)
    v_exp_f32 v66, v66
    v_exp_f32 v67, v67
    v_exp_f32 v68, v68
    v_mfma_f32_32x32x8_bf16 v[32:47], a[54:55], v[212:213], 0
    v_exp_f32 v69, v69
    v_exp_f32 v70, v70
    v_exp_f32 v71, v71
    v_exp_f32 v72, v72
    v_mfma_f32_32x32x16_bf16 v[32:47], a[42:45], v[208:211], v[32:47]
    v_exp_f32 v73, v73
    v_exp_f32 v74, v74
    v_exp_f32 v75, v75
    v_exp_f32 v76, v76
    v_smfmac_f32_32x32x32_bf16 v[128:143], a[32:35], v[64:71], v2
    s_add_u32 s12, s12, s44
    s_addc_u32 s13, s13, s45
    v_exp_f32 v77, v77
    v_exp_f32 v78, v78
    v_exp_f32 v79, v79
    v_exp_f32 v80, v80
    v_exp_f32 v81, v81
    v_smfmac_f32_32x32x32_bf16 v[128:143], a[36:39], v[72:79], v2
    buffer_load_dwordx4 a[244:247], v246, s[8:11], 0 offen offset:2048 sc1
    buffer_load_dwordx4 a[248:251], v245, s[8:11], 0 offen offset:3072 sc1
    buffer_load_dwordx4 a[252:255], v246, s[8:11], 0 offen offset:3072 sc1
    v_exp_f32 v82, v82
    v_exp_f32 v83, v83
    v_exp_f32 v84, v84
    v_mfma_f32_32x32x8_bf16 v[48:63], a[54:55], v[218:219], 0
    v_exp_f32 v85, v85
    v_exp_f32 v86, v86
    v_exp_f32 v87, v87
    v_exp_f32 v88, v88
    v_mfma_f32_32x32x16_bf16 v[48:63], a[42:45], v[214:217], v[48:63]
    v_exp_f32 v89, v89
    v_exp_f32 v90, v90
    v_exp_f32 v91, v91
    v_exp_f32 v92, v92
    v_smfmac_f32_32x32x32_bf16 v[144:159], a[32:35], v[80:87], v2
    s_add_u32 s8, s8, 4096
    s_addc_u32 s9, s9, 0
    v_exp_f32 v93, v93
    v_exp_f32 v94, v94
    v_exp_f32 v95, v95
    v_exp_f32 v32, v32
    v_exp_f32 v33, v33
    v_smfmac_f32_32x32x32_bf16 v[144:159], a[36:39], v[88:95], v2
    v_exp_f32 v34, v34
    v_exp_f32 v35, v35
    v_exp_f32 v36, v36
    v_mfma_f32_32x32x8_bf16 v[64:79], a[54:55], v[224:225], 0
    v_exp_f32 v37, v37
    v_exp_f32 v38, v38
    v_exp_f32 v39, v39
    v_exp_f32 v40, v40
    v_mfma_f32_32x32x16_bf16 v[64:79], a[42:45], v[220:223], v[64:79]
    v_exp_f32 v41, v41
    v_exp_f32 v42, v42
    v_exp_f32 v43, v43
    v_exp_f32 v44, v44
    v_smfmac_f32_32x32x32_bf16 v[96:111], a[46:49], v[32:39], v2
    v_exp_f32 v45, v45
    v_exp_f32 v46, v46
    v_exp_f32 v47, v47
    v_exp_f32 v48, v48
    v_exp_f32 v49, v49
    v_smfmac_f32_32x32x32_bf16 v[96:111], a[50:53], v[40:47], v2
    v_exp_f32 v50, v50
    v_exp_f32 v51, v51
    v_exp_f32 v52, v52
    v_mfma_f32_32x32x8_bf16 v[80:95], a[54:55], v[230:231], 0
    v_exp_f32 v53, v53
    v_exp_f32 v54, v54
    v_exp_f32 v55, v55
    v_exp_f32 v56, v56
    v_mfma_f32_32x32x16_bf16 v[80:95], a[42:45], v[226:229], v[80:95]
    v_exp_f32 v57, v57
    v_exp_f32 v58, v58
    v_exp_f32 v59, v59
    v_exp_f32 v60, v60
    v_smfmac_f32_32x32x32_bf16 v[112:127], a[46:49], v[48:55], v2
    v_exp_f32 v61, v61
    v_exp_f32 v62, v62
    v_exp_f32 v63, v63
    v_exp_f32 v64, v64
    v_exp_f32 v65, v65
    v_smfmac_f32_32x32x32_bf16 v[112:127], a[50:53], v[56:63], v2
    s_waitcnt vmcnt(5)
    ds_write_b128 v238, v[96:99] offset:0
    ds_write_b128 v238, v[100:103] offset:1024
    ds_write_b128 v238, v[104:107] offset:2048
    v_exp_f32 v66, v66
    v_exp_f32 v67, v67
    v_exp_f32 v68, v68
    v_exp_f32 v69, v69
    v_exp_f32 v70, v70
    v_exp_f32 v71, v71
    v_exp_f32 v72, v72
    v_exp_f32 v73, v73
    v_exp_f32 v74, v74
    v_exp_f32 v75, v75
    v_exp_f32 v76, v76
    v_smfmac_f32_32x32x32_bf16 v[128:143], a[46:49], v[64:71], v2
    ds_write_b128 v238, v[112:115] offset:3072
    ds_write_b128 v238, v[116:119] offset:4096
    ds_write_b128 v238, v[120:123] offset:5120
    v_exp_f32 v77, v77
    v_exp_f32 v78, v78
    v_exp_f32 v79, v79
    v_exp_f32 v80, v80
    v_exp_f32 v81, v81
    v_smfmac_f32_32x32x32_bf16 v[128:143], a[50:53], v[72:79], v2
    s_waitcnt lgkmcnt(0)
    s_barrier
    ds_read_b128 v[160:163], v239 offset:0
    ds_read_b128 v[164:167], v239 offset:1024
    ds_read_b128 v[168:171], v239 offset:2048
    v_exp_f32 v82, v82
    v_exp_f32 v83, v83
    v_exp_f32 v84, v84
    v_exp_f32 v85, v85
    v_exp_f32 v86, v86
    v_exp_f32 v87, v87
    v_exp_f32 v88, v88
    v_exp_f32 v89, v89
    v_exp_f32 v90, v90
    v_exp_f32 v91, v91
    v_exp_f32 v92, v92
    v_smfmac_f32_32x32x32_bf16 v[144:159], a[46:49], v[80:87], v2
    ds_read_b128 v[172:175], v239 offset:3072
    ds_read_b128 v[176:179], v239 offset:4096
    ds_read_b128 v[180:183], v239 offset:5120
    ds_read_b32 v8, v242
    v_exp_f32 v93, v93
    v_exp_f32 v94, v94
    v_exp_f32 v95, v95
    s_nop 1
    v_smfmac_f32_32x32x32_bf16 v[144:159], a[50:53], v[88:95], v2
L_fin:
    ds_read_b64_tr_b16 v[184:185], v240 offset:0
    ds_read_b64_tr_b16 v[186:187], v240 offset:1280
    ds_read_b64_tr_b16 v[188:189], v240 offset:8
    ds_read_b64_tr_b16 v[190:191], v240 offset:1288
    ds_read_b64_tr_b16 v[192:193], v240 offset:16
    ds_read_b64_tr_b16 v[194:195], v240 offset:1296
    ds_read_b64_tr_b16 v[196:197], v240 offset:24
    ds_read_b64_tr_b16 v[198:199], v240 offset:1304
    ds_read_b64_tr_b16 v[200:201], v240 offset:32
    ds_read_b64_tr_b16 v[202:203], v240 offset:1312
    s_waitcnt lgkmcnt(11)
    v_add_f32 v76, v136, v168
    v_add_f32 v77, v136, v168
    v_add_f32 v78, v152, v180
    v_add_f32 v79, v152, v180
    ds_read_b64_tr_b16 v[10:11], v240 offset:5120
    ds_read_b64_tr_b16 v[12:13], v240 offset:6400
    v_permlane32_swap_b32 v76, v77
    v_permlane32_swap_b32 v78, v79
    ds_read_b64_tr_b16 v[14:15], v240 offset:5128
    ds_read_b64_tr_b16 v[16:17], v240 offset:6408
    v_cmp_nge_f32_e64 s[92:93], v77, s77
    v_cmp_nle_f32_e64 s[64:65], v77, s78
    v_cmp_nge_f32_e64 vcc, v79, s77
    v_rcp_f32 v76, v77
    s_or_b64 s[92:93], s[92:93], s[64:65]
    v_cmp_nle_f32_e64 s[64:65], v79, s78
    s_or_b64 s[92:93], s[92:93], vcc
    v_rcp_f32 v78, v79
    ds_read_b64_tr_b16 v[18:19], v240 offset:5136
    ds_read_b64_tr_b16 v[20:21], v240 offset:6416
    ds_read_b64_tr_b16 v[22:23], v240 offset:5144
    ds_read_b64_tr_b16 v[24:25], v240 offset:6424
    ds_read_b64_tr_b16 v[26:27], v240 offset:5152
    ds_read_b64_tr_b16 v[28:29], v240 offset:6432
    s_or_b64 s[92:93], s[92:93], s[64:65]
    s_or_b32 s92, s92, s93
    s_andn2_b32 s92, s92, s76
    s_cbranch_scc1 L_slow
    s_waitcnt lgkmcnt(15)
    v_mul_f32 v76, v76, v8
    v_pk_add_f32 v[128:129], v[128:129], v[160:161]
    v_pk_add_f32 v[130:131], v[130:131], v[162:163]
    v_pk_add_f32 v[132:133], v[132:133], v[164:165]
    v_pk_add_f32 v[134:135], v[134:135], v[166:167]
    v_pk_add_f32 v[136:137], v[136:137], v[168:169]
    v_pk_add_f32 v[138:139], v[138:139], v[170:171]
    v_pk_mul_f32 v[128:129], v[128:129], v[76:77] op_sel_hi:[1,0]
    v_pk_mul_f32 v[130:131], v[130:131], v[76:77] op_sel_hi:[1,0]
    v_pk_mul_f32 v[132:133], v[132:133], v[76:77] op_sel_hi:[1,0]
    v_pk_mul_f32 v[134:135], v[134:135], v[76:77] op_sel_hi:[1,0]
    v_pk_mul_f32 v[136:137], v[136:137], v[76:77] op_sel_hi:[1,0]
    v_pk_mul_f32 v[138:139], v[138:139], v[76:77] op_sel_hi:[1,0]
    v_cvt_pk_bf16_f32 v80, v128, v129
    v_cvt_pk_bf16_f32 v81, v130, v131
    v_cvt_pk_bf16_f32 v82, v132, v133
    v_cvt_pk_bf16_f32 v83, v134, v135
    v_cvt_pk_bf16_f32 v88, v136, v137
    v_cvt_pk_bf16_f32 v89, v138, v139
    buffer_store_dwordx4 v[80:83], v237, s[20:23], s86 offen offset:0 sc1
    v_mul_f32 v78, v78, v8
    v_pk_add_f32 v[144:145], v[144:145], v[172:173]
    v_pk_add_f32 v[146:147], v[146:147], v[174:175]
    v_pk_add_f32 v[148:149], v[148:149], v[176:177]
    v_pk_add_f32 v[150:151], v[150:151], v[178:179]
    v_pk_add_f32 v[152:153], v[152:153], v[180:181]
    v_pk_add_f32 v[154:155], v[154:155], v[182:183]
    v_pk_mul_f32 v[144:145], v[144:145], v[78:79] op_sel_hi:[1,0]
    v_pk_mul_f32 v[146:147], v[146:147], v[78:79] op_sel_hi:[1,0]
    v_pk_mul_f32 v[148:149], v[148:149], v[78:79] op_sel_hi:[1,0]
    v_pk_mul_f32 v[150:151], v[150:151], v[78:79] op_sel_hi:[1,0]
    v_pk_mul_f32 v[152:153], v[152:153], v[78:79] op_sel_hi:[1,0]
    v_pk_mul_f32 v[154:155], v[154:155], v[78:79] op_sel_hi:[1,0]
    v_cvt_pk_bf16_f32 v84, v144, v145
    v_cvt_pk_bf16_f32 v85, v146, v147
L_pad8:
    s_cbranch_execz L_back
    v_cvt_pk_bf16_f32 v86, v148, v149
    v_cvt_pk_bf16_f32 v87, v150, v151
    v_cvt_pk_bf16_f32 v90, v152, v153
    v_cvt_pk_bf16_f32 v91, v154, v155
    buffer_store_dwordx4 v[84:87], v237, s[20:23], s86 offen offset:512 sc1
    s_mov_b32 exec_hi, 0
    buffer_store_dwordx4 v[88:91], v237, s[20:23], s86 offen offset:1024 sc1
    s_mov_b32 exec_hi, -1
    ds_read_b32 v232, v243
    s_waitcnt lgkmcnt(11)
    v_mfma_f32_16x16x32_bf16 v[32:35], v[184:187], a[64:67], 0
    s_barrier
    ds_read_b64_tr_b16 v[204:205], v240 offset:10240
    v_mfma_f32_16x16x32_bf16 v[52:55], v[184:187], a[68:71], 0
    ds_read_b64_tr_b16 v[206:207], v240 offset:11520
    s_add_u32 m0, s82, 0
    v_mfma_f32_16x16x32_bf16 v[36:39], v[188:191], a[64:67], 0
    ds_read_b64_tr_b16 v[208:209], v240 offset:10248
    buffer_load_dwordx4 v6, s[12:15], 0 offen sc1 lds
    v_mfma_f32_16x16x32_bf16 v[56:59], v[188:191], a[68:71], 0
    ds_read_b64_tr_b16 v[210:211], v240 offset:11528
    v_mfma_f32_16x16x32_bf16 v[40:43], v[192:195], a[64:67], 0
    ds_read_b64_tr_b16 v[212:213], v240 offset:10256
    buffer_load_dwordx4 v6, s[12:15], 0 offen offset:1024 sc1 lds
    v_mfma_f32_16x16x32_bf16 v[60:63], v[192:195], a[68:71], 0
    ds_read_b64_tr_b16 v[214:215], v240 offset:11536
    v_mfma_f32_16x16x32_bf16 v[44:47], v[196:199], a[64:67], 0
    ds_read_b64_tr_b16 v[216:217], v240 offset:10264
    v_mfma_f32_16x16x32_bf16 v[64:67], v[196:199], a[68:71], 0
    ds_read_b64_tr_b16 v[218:219], v240 offset:11544
    buffer_load_dwordx4 v6, s[12:15], 0 offen offset:2048 sc1 lds
    v_mfma_f32_16x16x32_bf16 v[48:51], v[200:203], a[64:67], 0
    ds_read_b64_tr_b16 v[220:221], v240 offset:10272
    v_mfma_f32_16x16x32_bf16 v[68:71], v[200:203], a[68:71], 0
    ds_read_b64_tr_b16 v[222:223], v240 offset:11552
    s_waitcnt lgkmcnt(11)
    v_mfma_f32_16x16x32_bf16 v[32:35], v[10:13], a[72:75], v[32:35]
    ds_read_b64_tr_b16 v[184:185], v240 offset:15360
    v_mfma_f32_16x16x32_bf16 v[52:55], v[10:13], a[76:79], v[52:55]
    ds_read_b64_tr_b16 v[186:187], v240 offset:16640
    buffer_load_dwordx4 v6, s[12:15], 0 offen offset:3072 sc1 lds
    v_mfma_f32_16x16x32_bf16 v[36:39], v[14:17], a[72:75], v[36:39]
    ds_read_b64_tr_b16 v[188:189], v240 offset:15368
    s_add_u32 m0, s82, 4096
    v_mfma_f32_16x16x32_bf16 v[56:59], v[14:17], a[76:79], v[56:59]
    ds_read_b64_tr_b16 v[190:191], v240 offset:16648
    v_mfma_f32_16x16x32_bf16 v[40:43], v[18:21], a[72:75], v[40:43]
    ds_read_b64_tr_b16 v[192:193], v240 offset:15376
    buffer_load_dwordx4 v249, s[12:15], 0 offen sc1 lds
    v_mfma_f32_16x16x32_bf16 v[60:63], v[18:21], a[76:79], v[60:63]
    ds_read_b64_tr_b16 v[194:195], v240 offset:16656
    s_add_u32 s12, s12, 10240
    s_addc_u32 s13, s13, 0
    v_mfma_f32_16x16x32_bf16 v[44:47], v[22:25], a[72:75], v[44:47]
    ds_read_b64_tr_b16 v[196:197], v240 offset:15384
    v_mfma_f32_16x16x32_bf16 v[64:67], v[22:25], a[76:79], v[64:67]
    ds_read_b64_tr_b16 v[198:199], v240 offset:16664
    v_mfma_f32_16x16x32_bf16 v[48:51], v[26:29], a[72:75], v[48:51]
    ds_read_b64_tr_b16 v[200:201], v240 offset:15392
    v_mfma_f32_16x16x32_bf16 v[68:71], v[26:29], a[76:79], v[68:71]
    ds_read_b64_tr_b16 v[202:203], v240 offset:16672
    s_waitcnt lgkmcnt(10)
    v_mfma_f32_16x16x32_bf16 v[32:35], v[204:207], a[80:83], v[32:35]
    s_barrier
    ds_read_b64_tr_b16 v[10:11], v240 offset:20480
    v_mfma_f32_16x16x32_bf16 v[52:55], v[204:207], a[84:87], v[52:55]
    ds_read_b64_tr_b16 v[12:13], v240 offset:21760
    s_add_u32 m0, s80, 0
    v_mfma_f32_16x16x32_bf16 v[36:39], v[208:211], a[80:83], v[36:39]
    ds_read_b64_tr_b16 v[14:15], v240 offset:20488
    buffer_load_dwordx4 v6, s[12:15], 0 offen sc1 lds
    v_mfma_f32_16x16x32_bf16 v[56:59], v[208:211], a[84:87], v[56:59]
    ds_read_b64_tr_b16 v[16:17], v240 offset:21768
    v_mfma_f32_16x16x32_bf16 v[40:43], v[212:215], a[80:83], v[40:43]
    ds_read_b64_tr_b16 v[18:19], v240 offset:20496
    buffer_load_dwordx4 v6, s[12:15], 0 offen offset:1024 sc1 lds
    v_mfma_f32_16x16x32_bf16 v[60:63], v[212:215], a[84:87], v[60:63]
    ds_read_b64_tr_b16 v[20:21], v240 offset:21776
    v_mfma_f32_16x16x32_bf16 v[44:47], v[216:219], a[80:83], v[44:47]
    ds_read_b64_tr_b16 v[22:23], v240 offset:20504
    v_mfma_f32_16x16x32_bf16 v[64:67], v[216:219], a[84:87], v[64:67]
    ds_read_b64_tr_b16 v[24:25], v240 offset:21784
    buffer_load_dwordx4 v6, s[12:15], 0 offen offset:2048 sc1 lds
    v_mfma_f32_16x16x32_bf16 v[48:51], v[220:223], a[80:83], v[48:51]
    ds_read_b64_tr_b16 v[26:27], v240 offset:20512
    v_mfma_f32_16x16x32_bf16 v[68:71], v[220:223], a[84:87], v[68:71]
    ds_read_b64_tr_b16 v[28:29], v240 offset:21792
    s_waitcnt lgkmcnt(10)
    v_subrev_u32 v238, 84992, v238
    v_subrev_u32 v239, 84992, v239
    v_add_f32 v232, 1.0, v232
    v_rcp_f32 v232, v232
    v_mfma_f32_16x16x32_bf16 v[32:35], v[184:187], a[88:91], v[32:35]
    ds_read_b64_tr_b16 v[204:205], v240 offset:25600
    v_mfma_f32_16x16x32_bf16 v[52:55], v[184:187], a[92:95], v[52:55]
    ds_read_b64_tr_b16 v[206:207], v240 offset:26880
    buffer_load_dwordx4 v6, s[12:15], 0 offen offset:3072 sc1 lds
    v_mfma_f32_16x16x32_bf16 v[36:39], v[188:191], a[88:91], v[36:39]
    ds_read_b64_tr_b16 v[208:209], v240 offset:25608
    s_add_u32 m0, s80, 4096
    v_mfma_f32_16x16x32_bf16 v[56:59], v[188:191], a[92:95], v[56:59]
    ds_read_b64_tr_b16 v[210:211], v240 offset:26888
    v_mfma_f32_16x16x32_bf16 v[40:43], v[192:195], a[88:91], v[40:43]
    ds_read_b64_tr_b16 v[212:213], v240 offset:25616
    buffer_load_dwordx4 v249, s[12:15], 0 offen sc1 lds
    v_mfma_f32_16x16x32_bf16 v[60:63], v[192:195], a[92:95], v[60:63]
    ds_read_b64_tr_b16 v[214:215], v240 offset:26896
    s_add_u32 s12, s12, 10240
    s_addc_u32 s13, s13, 0
    v_mfma_f32_16x16x32_bf16 v[44:47], v[196:199], a[88:91], v[44:47]
    ds_read_b64_tr_b16 v[216:217], v240 offset:25624
    v_mfma_f32_16x16x32_bf16 v[64:67], v[196:199], a[92:95], v[64:67]
    ds_read_b64_tr_b16 v[218:219], v240 offset:26904
    v_mfma_f32_16x16x32_bf16 v[48:51], v[200:203], a[88:91], v[48:51]
    ds_read_b64_tr_b16 v[220:221], v240 offset:25632
    v_mfma_f32_16x16x32_bf16 v[68:71], v[200:203], a[92:95], v[68:71]
    ds_read_b64_tr_b16 v[222:223], v240 offset:26912
    s_waitcnt lgkmcnt(10)
    v_mfma_f32_16x16x32_bf16 v[32:35], v[10:13], a[96:99], v[32:35]
    s_barrier
    ds_read_b64_tr_b16 v[184:185], v240 offset:30720
    v_mfma_f32_16x16x32_bf16 v[52:55], v[10:13], a[100:103], v[52:55]
    ds_read_b64_tr_b16 v[186:187], v240 offset:32000
    s_add_u32 m0, s80, 10240
    v_mfma_f32_16x16x32_bf16 v[36:39], v[14:17], a[96:99], v[36:39]
    ds_read_b64_tr_b16 v[188:189], v240 offset:30728
    buffer_load_dwordx4 v6, s[12:15], 0 offen sc1 lds
    v_mfma_f32_16x16x32_bf16 v[56:59], v[14:17], a[100:103], v[56:59]
    ds_read_b64_tr_b16 v[190:191], v240 offset:32008
    v_mfma_f32_16x16x32_bf16 v[40:43], v[18:21], a[96:99], v[40:43]
    ds_read_b64_tr_b16 v[192:193], v240 offset:30736
    buffer_load_dwordx4 v6, s[12:15], 0 offen offset:1024 sc1 lds
    v_mfma_f32_16x16x32_bf16 v[60:63], v[18:21], a[100:103], v[60:63]
    ds_read_b64_tr_b16 v[194:195], v240 offset:32016
    v_mfma_f32_16x16x32_bf16 v[44:47], v[22:25], a[96:99], v[44:47]
    ds_read_b64_tr_b16 v[196:197], v240 offset:30744
    v_mfma_f32_16x16x32_bf16 v[64:67], v[22:25], a[100:103], v[64:67]
    ds_read_b64_tr_b16 v[198:199], v240 offset:32024
    buffer_load_dwordx4 v6, s[12:15], 0 offen offset:2048 sc1 lds
    v_mfma_f32_16x16x32_bf16 v[48:51], v[26:29], a[96:99], v[48:51]
    ds_read_b64_tr_b16 v[200:201], v240 offset:30752
    v_mfma_f32_16x16x32_bf16 v[68:71], v[26:29], a[100:103], v[68:71]
    ds_read_b64_tr_b16 v[202:203], v240 offset:32032
    s_waitcnt lgkmcnt(10)
    v_mfma_f32_16x16x32_bf16 v[32:35], v[204:207], a[104:107], v[32:35]
    ds_read_b64_tr_b16 v[10:11], v240 offset:35840
    v_mfma_f32_16x16x32_bf16 v[52:55], v[204:207], a[108:111], v[52:55]
    ds_read_b64_tr_b16 v[12:13], v240 offset:37120
    buffer_load_dwordx4 v6, s[12:15], 0 offen offset:3072 sc1 lds
    v_mfma_f32_16x16x32_bf16 v[36:39], v[208:211], a[104:107], v[36:39]
    ds_read_b64_tr_b16 v[14:15], v240 offset:35848
    s_add_u32 m0, s80, 14336
    v_mfma_f32_16x16x32_bf16 v[56:59], v[208:211], a[108:111], v[56:59]
    ds_read_b64_tr_b16 v[16:17], v240 offset:37128
    v_mfma_f32_16x16x32_bf16 v[40:43], v[212:215], a[104:107], v[40:43]
    ds_read_b64_tr_b16 v[18:19], v240 offset:35856
    buffer_load_dwordx4 v249, s[12:15], 0 offen sc1 lds
    v_mfma_f32_16x16x32_bf16 v[60:63], v[212:215], a[108:111], v[60:63]
    ds_read_b64_tr_b16 v[20:21], v240 offset:37136
    s_add_u32 s12, s12, 10240
    s_addc_u32 s13, s13, 0
    v_mfma_f32_16x16x32_bf16 v[44:47], v[216:219], a[104:107], v[44:47]
    ds_read_b64_tr_b16 v[22:23], v240 offset:35864
    v_mfma_f32_16x16x32_bf16 v[64:67], v[216:219], a[108:111], v[64:67]
    ds_read_b64_tr_b16 v[24:25], v240 offset:37144
    v_mfma_f32_16x16x32_bf16 v[48:51], v[220:223], a[104:107], v[48:51]
    ds_read_b64_tr_b16 v[26:27], v240 offset:35872
    v_mfma_f32_16x16x32_bf16 v[68:71], v[220:223], a[108:111], v[68:71]
    ds_read_b64_tr_b16 v[28:29], v240 offset:37152
    s_waitcnt lgkmcnt(10)
    v_mfma_f32_16x16x32_bf16 v[32:35], v[184:187], a[112:115], v[32:35]
    s_waitcnt vmcnt(15)
    s_barrier
    s_cmp_lg_u32 s70, 0
    s_cbranch_scc1 L_nosigo
    v_mov_b32 v30, 1
    s_mov_b64 exec, 1
    buffer_store_dword v30, off, s[20:23], s88 sc1
    s_mov_b64 exec, -1
L_nosigo:
    ds_read_b64_tr_b16 v[204:205], v240 offset:40960
    v_mfma_f32_16x16x32_bf16 v[52:55], v[184:187], a[116:119], v[52:55]
    ds_read_b64_tr_b16 v[206:207], v240 offset:42240
    s_add_u32 m0, s80, 20480
    v_mfma_f32_16x16x32_bf16 v[36:39], v[188:191], a[112:115], v[36:39]
    ds_read_b64_tr_b16 v[208:209], v240 offset:40968
    buffer_load_dwordx4 v6, s[12:15], 0 offen sc1 lds
    v_mfma_f32_16x16x32_bf16 v[56:59], v[188:191], a[116:119], v[56:59]
    ds_read_b64_tr_b16 v[210:211], v240 offset:42248
    v_mfma_f32_16x16x32_bf16 v[40:43], v[192:195], a[112:115], v[40:43]
    ds_read_b64_tr_b16 v[212:213], v240 offset:40976
    buffer_load_dwordx4 v6, s[12:15], 0 offen offset:1024 sc1 lds
    v_mfma_f32_16x16x32_bf16 v[60:63], v[192:195], a[116:119], v[60:63]
    ds_read_b64_tr_b16 v[214:215], v240 offset:42256
    v_mfma_f32_16x16x32_bf16 v[44:47], v[196:199], a[112:115], v[44:47]
    ds_read_b64_tr_b16 v[216:217], v240 offset:40984
    v_mfma_f32_16x16x32_bf16 v[64:67], v[196:199], a[116:119], v[64:67]
    ds_read_b64_tr_b16 v[218:219], v240 offset:42264
    buffer_load_dwordx4 v6, s[12:15], 0 offen offset:2048 sc1 lds
    v_mfma_f32_16x16x32_bf16 v[48:51], v[200:203], a[112:115], v[48:51]
    ds_read_b64_tr_b16 v[220:221], v240 offset:40992
    v_mfma_f32_16x16x32_bf16 v[68:71], v[200:203], a[116:119], v[68:71]
    ds_read_b64_tr_b16 v[222:223], v240 offset:42272
    s_waitcnt lgkmcnt(10)
    v_mfma_f32_16x16x32_bf16 v[32:35], v[10:13], a[120:123], v[32:35]
    ds_read_b64_tr_b16 v[184:185], v240 offset:46080
    v_mfma_f32_16x16x32_bf16 v[52:55], v[10:13], a[124:127], v[52:55]
    ds_read_b64_tr_b16 v[186:187], v240 offset:47360
    buffer_load_dwordx4 v6, s[12:15], 0 offen offset:3072 sc1 lds
    v_mfma_f32_16x16x32_bf16 v[36:39], v[14:17], a[120:123], v[36:39]
    ds_read_b64_tr_b16 v[188:189], v240 offset:46088
    s_add_u32 m0, s80, 24576
    v_mfma_f32_16x16x32_bf16 v[56:59], v[14:17], a[124:127], v[56:59]
    ds_read_b64_tr_b16 v[190:191], v240 offset:47368
    v_mfma_f32_16x16x32_bf16 v[40:43], v[18:21], a[120:123], v[40:43]
    ds_read_b64_tr_b16 v[192:193], v240 offset:46096
    buffer_load_dwordx4 v249, s[12:15], 0 offen sc1 lds
    v_mfma_f32_16x16x32_bf16 v[60:63], v[18:21], a[124:127], v[60:63]
    ds_read_b64_tr_b16 v[194:195], v240 offset:47376
    s_add_u32 s12, s12, 10240
    s_addc_u32 s13, s13, 0
    v_mfma_f32_16x16x32_bf16 v[44:47], v[22:25], a[120:123], v[44:47]
    ds_read_b64_tr_b16 v[196:197], v240 offset:46104
    v_mfma_f32_16x16x32_bf16 v[64:67], v[22:25], a[124:127], v[64:67]
    ds_read_b64_tr_b16 v[198:199], v240 offset:47384
    v_mfma_f32_16x16x32_bf16 v[48:51], v[26:29], a[120:123], v[48:51]
    ds_read_b64_tr_b16 v[200:201], v240 offset:46112
    v_mfma_f32_16x16x32_bf16 v[68:71], v[26:29], a[124:127], v[68:71]
    ds_read_b64_tr_b16 v[202:203], v240 offset:47392
    s_waitcnt lgkmcnt(10)
    v_mfma_f32_16x16x32_bf16 v[32:35], v[204:207], a[128:131], v[32:35]
    s_barrier
    ds_read_b64_tr_b16 v[10:11], v240 offset:51200
    v_mfma_f32_16x16x32_bf16 v[52:55], v[204:207], a[132:135], v[52:55]
    ds_read_b64_tr_b16 v[12:13], v240 offset:52480
    s_add_u32 m0, s80, 30720
    v_mfma_f32_16x16x32_bf16 v[36:39], v[208:211], a[128:131], v[36:39]
    ds_read_b64_tr_b16 v[14:15], v240 offset:51208
    buffer_load_dwordx4 v6, s[12:15], 0 offen sc1 lds
    v_mfma_f32_16x16x32_bf16 v[56:59], v[208:211], a[132:135], v[56:59]
    ds_read_b64_tr_b16 v[16:17], v240 offset:52488
    v_mfma_f32_16x16x32_bf16 v[40:43], v[212:215], a[128:131], v[40:43]
    ds_read_b64_tr_b16 v[18:19], v240 offset:51216
    buffer_load_dwordx4 v6, s[12:15], 0 offen offset:1024 sc1 lds
    v_mfma_f32_16x16x32_bf16 v[60:63], v[212:215], a[132:135], v[60:63]
    ds_read_b64_tr_b16 v[20:21], v240 offset:52496
    v_mfma_f32_16x16x32_bf16 v[44:47], v[216:219], a[128:131], v[44:47]
    ds_read_b64_tr_b16 v[22:23], v240 offset:51224
    v_mfma_f32_16x16x32_bf16 v[64:67], v[216:219], a[132:135], v[64:67]
    ds_read_b64_tr_b16 v[24:25], v240 offset:52504
    buffer_load_dwordx4 v6, s[12:15], 0 offen offset:2048 sc1 lds
    v_mfma_f32_16x16x32_bf16 v[48:51], v[220:223], a[128:131], v[48:51]
    ds_read_b64_tr_b16 v[26:27], v240 offset:51232
    v_mfma_f32_16x16x32_bf16 v[68:71], v[220:223], a[132:135], v[68:71]
    ds_read_b64_tr_b16 v[28:29], v240 offset:52512
    s_waitcnt lgkmcnt(10)
    v_mfma_f32_16x16x32_bf16 v[32:35], v[184:187], a[136:139], v[32:35]
    ds_read_b64_tr_b16 v[204:205], v240 offset:56320
    v_mfma_f32_16x16x32_bf16 v[52:55], v[184:187], a[140:143], v[52:55]
    ds_read_b64_tr_b16 v[206:207], v240 offset:57600
    buffer_load_dwordx4 v6, s[12:15], 0 offen offset:3072 sc1 lds
    v_mfma_f32_16x16x32_bf16 v[36:39], v[188:191], a[136:139], v[36:39]
    ds_read_b64_tr_b16 v[208:209], v240 offset:56328
    s_add_u32 m0, s80, 34816
    v_mfma_f32_16x16x32_bf16 v[56:59], v[188:191], a[140:143], v[56:59]
    ds_read_b64_tr_b16 v[210:211], v240 offset:57608
    v_mfma_f32_16x16x32_bf16 v[40:43], v[192:195], a[136:139], v[40:43]
    ds_read_b64_tr_b16 v[212:213], v240 offset:56336
    buffer_load_dwordx4 v249, s[12:15], 0 offen sc1 lds
    v_mfma_f32_16x16x32_bf16 v[60:63], v[192:195], a[140:143], v[60:63]
    ds_read_b64_tr_b16 v[214:215], v240 offset:57616
    s_add_u32 s12, s12, 10240
    s_addc_u32 s13, s13, 0
    v_mfma_f32_16x16x32_bf16 v[44:47], v[196:199], a[136:139], v[44:47]
    ds_read_b64_tr_b16 v[216:217], v240 offset:56344
    v_mfma_f32_16x16x32_bf16 v[64:67], v[196:199], a[140:143], v[64:67]
    ds_read_b64_tr_b16 v[218:219], v240 offset:57624
    v_mfma_f32_16x16x32_bf16 v[48:51], v[200:203], a[136:139], v[48:51]
    ds_read_b64_tr_b16 v[220:221], v240 offset:56352
    v_mfma_f32_16x16x32_bf16 v[68:71], v[200:203], a[140:143], v[68:71]
    ds_read_b64_tr_b16 v[222:223], v240 offset:57632
    s_waitcnt lgkmcnt(10)
    v_mfma_f32_16x16x32_bf16 v[32:35], v[10:13], a[144:147], v[32:35]
    s_waitcnt vmcnt(20)
    s_barrier
    ds_read_b64_tr_b16 v[184:185], v7 offset:0
    v_mfma_f32_16x16x32_bf16 v[52:55], v[10:13], a[148:151], v[52:55]
    ds_read_b64_tr_b16 v[186:187], v7 offset:1280
    s_add_u32 m0, s80, 40960
    v_mfma_f32_16x16x32_bf16 v[36:39], v[14:17], a[144:147], v[36:39]
    ds_read_b64_tr_b16 v[188:189], v7 offset:8
    buffer_load_dwordx4 v6, s[12:15], 0 offen sc1 lds
    v_mfma_f32_16x16x32_bf16 v[56:59], v[14:17], a[148:151], v[56:59]
    ds_read_b64_tr_b16 v[190:191], v7 offset:1288
    v_mfma_f32_16x16x32_bf16 v[40:43], v[18:21], a[144:147], v[40:43]
    ds_read_b64_tr_b16 v[192:193], v7 offset:16
    buffer_load_dwordx4 v6, s[12:15], 0 offen offset:1024 sc1 lds
    v_mfma_f32_16x16x32_bf16 v[60:63], v[18:21], a[148:151], v[60:63]
    ds_read_b64_tr_b16 v[194:195], v7 offset:1296
    v_mfma_f32_16x16x32_bf16 v[44:47], v[22:25], a[144:147], v[44:47]
    ds_read_b64_tr_b16 v[196:197], v7 offset:24
    v_mfma_f32_16x16x32_bf16 v[64:67], v[22:25], a[148:151], v[64:67]
    ds_read_b64_tr_b16 v[198:199], v7 offset:1304
    buffer_load_dwordx4 v6, s[12:15], 0 offen offset:2048 sc1 lds
    v_mfma_f32_16x16x32_bf16 v[48:51], v[26:29], a[144:147], v[48:51]
    ds_read_b64_tr_b16 v[200:201], v7 offset:32
    v_mfma_f32_16x16x32_bf16 v[68:71], v[26:29], a[148:151], v[68:71]
    ds_read_b64_tr_b16 v[202:203], v7 offset:1312
    s_waitcnt lgkmcnt(10)
    v_mfma_f32_16x16x32_bf16 v[32:35], v[204:207], a[152:155], v[32:35]
    ds_read_b64_tr_b16 v[10:11], v7 offset:5120
    v_mfma_f32_16x16x32_bf16 v[52:55], v[204:207], a[156:159], v[52:55]
    ds_read_b64_tr_b16 v[12:13], v7 offset:6400
    buffer_load_dwordx4 v6, s[12:15], 0 offen offset:3072 sc1 lds
    v_mfma_f32_16x16x32_bf16 v[36:39], v[208:211], a[152:155], v[36:39]
    ds_read_b64_tr_b16 v[14:15], v7 offset:5128
    s_add_u32 m0, s80, 45056
    v_mfma_f32_16x16x32_bf16 v[56:59], v[208:211], a[156:159], v[56:59]
    ds_read_b64_tr_b16 v[16:17], v7 offset:6408
    v_mfma_f32_16x16x32_bf16 v[40:43], v[212:215], a[152:155], v[40:43]
    ds_read_b64_tr_b16 v[18:19], v7 offset:5136
    buffer_load_dwordx4 v249, s[12:15], 0 offen sc1 lds
    v_mfma_f32_16x16x32_bf16 v[60:63], v[212:215], a[156:159], v[60:63]
    ds_read_b64_tr_b16 v[20:21], v7 offset:6416
    s_add_u32 s12, s12, s46
    s_addc_u32 s13, s13, s47
    v_mfma_f32_16x16x32_bf16 v[44:47], v[216:219], a[152:155], v[44:47]
    ds_read_b64_tr_b16 v[22:23], v7 offset:5144
    v_mfma_f32_16x16x32_bf16 v[64:67], v[216:219], a[156:159], v[64:67]
    ds_read_b64_tr_b16 v[24:25], v7 offset:6424
    v_mfma_f32_16x16x32_bf16 v[48:51], v[220:223], a[152:155], v[48:51]
    ds_read_b64_tr_b16 v[26:27], v7 offset:5152
    v_mfma_f32_16x16x32_bf16 v[68:71], v[220:223], a[156:159], v[68:71]
    ds_read_b64_tr_b16 v[28:29], v7 offset:6432
    s_waitcnt lgkmcnt(10)
    v_mfma_f32_16x16x32_bf16 v[32:35], v[184:187], a[160:163], v[32:35]
    s_waitcnt vmcnt(20)
    s_barrier
    ds_read_b64_tr_b16 v[204:205], v240 offset:0
    v_mfma_f32_16x16x32_bf16 v[52:55], v[184:187], a[164:167], v[52:55]
    ds_read_b64_tr_b16 v[206:207], v240 offset:1280
    s_add_u32 m0, s80, 51200
    v_mfma_f32_16x16x32_bf16 v[36:39], v[188:191], a[160:163], v[36:39]
    ds_read_b64_tr_b16 v[208:209], v240 offset:8
    buffer_load_dwordx4 v6, s[12:15], 0 offen sc1 lds
    v_mfma_f32_16x16x32_bf16 v[56:59], v[188:191], a[164:167], v[56:59]
    ds_read_b64_tr_b16 v[210:211], v240 offset:1288
    v_mfma_f32_16x16x32_bf16 v[40:43], v[192:195], a[160:163], v[40:43]
    ds_read_b64_tr_b16 v[212:213], v240 offset:16
    buffer_load_dwordx4 v6, s[12:15], 0 offen offset:1024 sc1 lds
    v_mfma_f32_16x16x32_bf16 v[60:63], v[192:195], a[164:167], v[60:63]
    ds_read_b64_tr_b16 v[214:215], v240 offset:1296
    v_mfma_f32_16x16x32_bf16 v[44:47], v[196:199], a[160:163], v[44:47]
    ds_read_b64_tr_b16 v[216:217], v240 offset:24
    v_mfma_f32_16x16x32_bf16 v[64:67], v[196:199], a[164:167], v[64:67]
    ds_read_b64_tr_b16 v[218:219], v240 offset:1304
    buffer_load_dwordx4 v6, s[12:15], 0 offen offset:2048 sc1 lds
    v_mfma_f32_16x16x32_bf16 v[48:51], v[200:203], a[160:163], v[48:51]
    ds_read_b64_tr_b16 v[220:221], v240 offset:32
    v_mfma_f32_16x16x32_bf16 v[68:71], v[200:203], a[164:167], v[68:71]
    ds_read_b64_tr_b16 v[222:223], v240 offset:1312
    s_waitcnt lgkmcnt(10)
    v_mfma_f32_16x16x32_bf16 v[32:35], v[10:13], a[168:171], v[32:35]
    ds_read_b64_tr_b16 v[184:185], v240 offset:5120
    v_mfma_f32_16x16x32_bf16 v[52:55], v[10:13], a[172:175], v[52:55]
    ds_read_b64_tr_b16 v[186:187], v240 offset:6400
    buffer_load_dwordx4 v6, s[12:15], 0 offen offset:3072 sc1 lds
    v_mfma_f32_16x16x32_bf16 v[36:39], v[14:17], a[168:171], v[36:39]
    ds_read_b64_tr_b16 v[188:189], v240 offset:5128
    s_add_u32 m0, s80, 55296
    v_mfma_f32_16x16x32_bf16 v[56:59], v[14:17], a[172:175], v[56:59]
    ds_read_b64_tr_b16 v[190:191], v240 offset:6408
    v_mfma_f32_16x16x32_bf16 v[40:43], v[18:21], a[168:171], v[40:43]
    ds_read_b64_tr_b16 v[192:193], v240 offset:5136
    buffer_load_dwordx4 v249, s[12:15], 0 offen sc1 lds
    v_mfma_f32_16x16x32_bf16 v[60:63], v[18:21], a[172:175], v[60:63]
    ds_read_b64_tr_b16 v[194:195], v240 offset:6416
    s_add_u32 s12, s12, 10240
    s_addc_u32 s13, s13, 0
    v_mfma_f32_16x16x32_bf16 v[44:47], v[22:25], a[168:171], v[44:47]
    ds_read_b64_tr_b16 v[196:197], v240 offset:5144
    v_mfma_f32_16x16x32_bf16 v[64:67], v[22:25], a[172:175], v[64:67]
    ds_read_b64_tr_b16 v[198:199], v240 offset:6424
    v_mfma_f32_16x16x32_bf16 v[48:51], v[26:29], a[168:171], v[48:51]
    ds_read_b64_tr_b16 v[200:201], v240 offset:5152
    v_mfma_f32_16x16x32_bf16 v[68:71], v[26:29], a[172:175], v[68:71]
    ds_read_b64_tr_b16 v[202:203], v240 offset:6432
    s_waitcnt lgkmcnt(10)
    v_mfma_f32_16x16x32_bf16 v[32:35], v[204:207], a[176:179], v[32:35]
    s_waitcnt vmcnt(20)
    s_barrier
    ds_read_b64_tr_b16 v[10:11], v240 offset:10240
    v_mfma_f32_16x16x32_bf16 v[52:55], v[204:207], a[180:183], v[52:55]
    ds_read_b64_tr_b16 v[12:13], v240 offset:11520
    buffer_load_dwordx4 v[92:95], off, s[20:23], s87 sc1
    v_mfma_f32_16x16x32_bf16 v[36:39], v[208:211], a[176:179], v[36:39]
    ds_read_b64_tr_b16 v[14:15], v240 offset:10248
    s_add_u32 m0, s82, 0
    v_mfma_f32_16x16x32_bf16 v[56:59], v[208:211], a[180:183], v[56:59]
    ds_read_b64_tr_b16 v[16:17], v240 offset:11528
    v_mfma_f32_16x16x32_bf16 v[40:43], v[212:215], a[176:179], v[40:43]
    ds_read_b64_tr_b16 v[18:19], v240 offset:10256
    buffer_load_dwordx4 v6, s[12:15], 0 offen sc1 lds
    v_mfma_f32_16x16x32_bf16 v[60:63], v[212:215], a[180:183], v[60:63]
    ds_read_b64_tr_b16 v[20:21], v240 offset:11536
    v_mfma_f32_16x16x32_bf16 v[44:47], v[216:219], a[176:179], v[44:47]
    ds_read_b64_tr_b16 v[22:23], v240 offset:10264
    v_mfma_f32_16x16x32_bf16 v[64:67], v[216:219], a[180:183], v[64:67]
    ds_read_b64_tr_b16 v[24:25], v240 offset:11544
    buffer_load_dwordx4 v6, s[12:15], 0 offen offset:1024 sc1 lds
    v_mfma_f32_16x16x32_bf16 v[48:51], v[220:223], a[176:179], v[48:51]
    ds_read_b64_tr_b16 v[26:27], v240 offset:10272
    v_mfma_f32_16x16x32_bf16 v[68:71], v[220:223], a[180:183], v[68:71]
    ds_read_b64_tr_b16 v[28:29], v240 offset:11552
    s_waitcnt lgkmcnt(10)
    v_mfma_f32_16x16x32_bf16 v[32:35], v[184:187], a[184:187], v[32:35]
    ds_read_b64_tr_b16 v[204:205], v240 offset:15360
    v_mfma_f32_16x16x32_bf16 v[52:55], v[184:187], a[188:191], v[52:55]
    ds_read_b64_tr_b16 v[206:207], v240 offset:16640
    buffer_load_dwordx4 v6, s[12:15], 0 offen offset:2048 sc1 lds
    v_mfma_f32_16x16x32_bf16 v[36:39], v[188:191], a[184:187], v[36:39]
    ds_read_b64_tr_b16 v[208:209], v240 offset:15368
    v_mfma_f32_16x16x32_bf16 v[56:59], v[188:191], a[188:191], v[56:59]
    ds_read_b64_tr_b16 v[210:211], v240 offset:16648
    v_mfma_f32_16x16x32_bf16 v[40:43], v[192:195], a[184:187], v[40:43]
    ds_read_b64_tr_b16 v[212:213], v240 offset:15376
    buffer_load_dwordx4 v6, s[12:15], 0 offen offset:3072 sc1 lds
    v_mfma_f32_16x16x32_bf16 v[60:63], v[192:195], a[188:191], v[60:63]
    ds_read_b64_tr_b16 v[214:215], v240 offset:16656
    s_add_u32 m0, s82, 4096
    v_mfma_f32_16x16x32_bf16 v[44:47], v[196:199], a[184:187], v[44:47]
    ds_read_b64_tr_b16 v[216:217], v240 offset:15384
    v_mfma_f32_16x16x32_bf16 v[64:67], v[196:199], a[188:191], v[64:67]
    ds_read_b64_tr_b16 v[218:219], v240 offset:16664
    buffer_load_dwordx4 v249, s[12:15], 0 offen sc1 lds
    v_mfma_f32_16x16x32_bf16 v[48:51], v[200:203], a[184:187], v[48:51]
    ds_read_b64_tr_b16 v[220:221], v240 offset:15392
    s_add_u32 s12, s12, 10240
    s_addc_u32 s13, s13, 0
    v_mfma_f32_16x16x32_bf16 v[68:71], v[200:203], a[188:191], v[68:71]
    ds_read_b64_tr_b16 v[222:223], v240 offset:16672
    s_waitcnt lgkmcnt(10)
    v_mfma_f32_16x16x32_bf16 v[32:35], v[10:13], a[192:195], v[32:35]
    s_waitcnt vmcnt(21)
    s_barrier
    ds_read_b64_tr_b16 v[184:185], v240 offset:20480
    v_mfma_f32_16x16x32_bf16 v[52:55], v[10:13], a[196:199], v[52:55]
    ds_read_b64_tr_b16 v[186:187], v240 offset:21760
    s_add_u32 m0, s80, 0
    v_mfma_f32_16x16x32_bf16 v[36:39], v[14:17], a[192:195], v[36:39]
    ds_read_b64_tr_b16 v[188:189], v240 offset:20488
    buffer_load_dwordx4 v6, s[12:15], 0 offen sc1 lds
    v_mfma_f32_16x16x32_bf16 v[56:59], v[14:17], a[196:199], v[56:59]
    ds_read_b64_tr_b16 v[190:191], v240 offset:21768
    v_mfma_f32_16x16x32_bf16 v[40:43], v[18:21], a[192:195], v[40:43]
    ds_read_b64_tr_b16 v[192:193], v240 offset:20496
    buffer_load_dwordx4 v6, s[12:15], 0 offen offset:1024 sc1 lds
    v_mfma_f32_16x16x32_bf16 v[60:63], v[18:21], a[196:199], v[60:63]
    ds_read_b64_tr_b16 v[194:195], v240 offset:21776
    v_mfma_f32_16x16x32_bf16 v[44:47], v[22:25], a[192:195], v[44:47]
    ds_read_b64_tr_b16 v[196:197], v240 offset:20504
    v_mfma_f32_16x16x32_bf16 v[64:67], v[22:25], a[196:199], v[64:67]
    ds_read_b64_tr_b16 v[198:199], v240 offset:21784
    buffer_load_dwordx4 v6, s[12:15], 0 offen offset:2048 sc1 lds
    v_mfma_f32_16x16x32_bf16 v[48:51], v[26:29], a[192:195], v[48:51]
    ds_read_b64_tr_b16 v[200:201], v240 offset:20512
    v_mfma_f32_16x16x32_bf16 v[68:71], v[26:29], a[196:199], v[68:71]
    ds_read_b64_tr_b16 v[202:203], v240 offset:21792
    s_waitcnt lgkmcnt(10)
    v_mfma_f32_16x16x32_bf16 v[32:35], v[204:207], a[200:203], v[32:35]
    ds_read_b64_tr_b16 v[10:11], v240 offset:25600
    v_mfma_f32_16x16x32_bf16 v[52:55], v[204:207], a[204:207], v[52:55]
    ds_read_b64_tr_b16 v[12:13], v240 offset:26880
    buffer_load_dwordx4 v6, s[12:15], 0 offen offset:3072 sc1 lds
    v_mfma_f32_16x16x32_bf16 v[36:39], v[208:211], a[200:203], v[36:39]
    ds_read_b64_tr_b16 v[14:15], v240 offset:25608
    s_add_u32 m0, s80, 4096
    v_mfma_f32_16x16x32_bf16 v[56:59], v[208:211], a[204:207], v[56:59]
    ds_read_b64_tr_b16 v[16:17], v240 offset:26888
    v_mfma_f32_16x16x32_bf16 v[40:43], v[212:215], a[200:203], v[40:43]
    ds_read_b64_tr_b16 v[18:19], v240 offset:25616
    buffer_load_dwordx4 v249, s[12:15], 0 offen sc1 lds
    v_mfma_f32_16x16x32_bf16 v[60:63], v[212:215], a[204:207], v[60:63]
    ds_read_b64_tr_b16 v[20:21], v240 offset:26896
    s_add_u32 s12, s12, 10240
    s_addc_u32 s13, s13, 0
    v_mfma_f32_16x16x32_bf16 v[44:47], v[216:219], a[200:203], v[44:47]
    ds_read_b64_tr_b16 v[22:23], v240 offset:25624
    v_mfma_f32_16x16x32_bf16 v[64:67], v[216:219], a[204:207], v[64:67]
    ds_read_b64_tr_b16 v[24:25], v240 offset:26904
    v_mfma_f32_16x16x32_bf16 v[48:51], v[220:223], a[200:203], v[48:51]
    ds_read_b64_tr_b16 v[26:27], v240 offset:25632
    v_mfma_f32_16x16x32_bf16 v[68:71], v[220:223], a[204:207], v[68:71]
    ds_read_b64_tr_b16 v[28:29], v240 offset:26912
    s_waitcnt vmcnt(10)
    v_and_b32 v92, v92, v93
    v_and_b32 v94, v94, v95
    v_and_b32 v92, v92, v94
    v_cmp_ne_u32 vcc, 1, v92
    s_nop 4
    s_cbranch_vccz L_opoll_done
    buffer_load_dwordx4 v[92:95], off, s[20:23], s87 sc1
    s_mov_b32 s84, 0
L_opoll:
    s_waitcnt vmcnt(0)
    v_and_b32 v92, v92, v93
    v_and_b32 v94, v94, v95
    v_and_b32 v92, v92, v94
    v_cmp_ne_u32 vcc, 1, v92
    s_nop 4
    s_cbranch_vccz L_opoll_ok
    s_add_u32 s84, s84, 1
    s_cmp_ge_u32 s84, 1048576
    s_cbranch_scc1 L_opoll_ok
    s_sleep 4
    buffer_load_dwordx4 v[92:95], off, s[20:23], s87 sc1
    s_branch L_opoll
L_opoll_ok:
L_opoll_done:
    s_waitcnt lgkmcnt(10)
    v_mfma_f32_16x16x32_bf16 v[32:35], v[184:187], a[208:211], v[32:35]
    s_barrier
    ds_read_b64_tr_b16 v[204:205], v240 offset:30720
    v_mfma_f32_16x16x32_bf16 v[52:55], v[184:187], a[212:215], v[52:55]
    ds_read_b64_tr_b16 v[206:207], v240 offset:32000
    buffer_load_dwordx4 v[96:99], v247, s[32:35], 0 offen sc1
    v_mfma_f32_16x16x32_bf16 v[36:39], v[188:191], a[208:211], v[36:39]
    ds_read_b64_tr_b16 v[208:209], v240 offset:30728
    v_mfma_f32_16x16x32_bf16 v[56:59], v[188:191], a[212:215], v[56:59]
    ds_read_b64_tr_b16 v[210:211], v240 offset:32008
    v_mfma_f32_16x16x32_bf16 v[40:43], v[192:195], a[208:211], v[40:43]
    ds_read_b64_tr_b16 v[212:213], v240 offset:30736
    buffer_load_dwordx4 v[100:103], v248, s[32:35], 0 offen sc1
    v_mfma_f32_16x16x32_bf16 v[60:63], v[192:195], a[212:215], v[60:63]
    ds_read_b64_tr_b16 v[214:215], v240 offset:32016
    v_mfma_f32_16x16x32_bf16 v[44:47], v[196:199], a[208:211], v[44:47]
    ds_read_b64_tr_b16 v[216:217], v240 offset:30744
    v_mfma_f32_16x16x32_bf16 v[64:67], v[196:199], a[212:215], v[64:67]
    ds_read_b64_tr_b16 v[218:219], v240 offset:32024
    buffer_load_dwordx4 v[104:107], v247, s[32:35], 0 offen offset:1024 sc1
    v_mfma_f32_16x16x32_bf16 v[48:51], v[200:203], a[208:211], v[48:51]
    ds_read_b64_tr_b16 v[220:221], v240 offset:30752
    v_mfma_f32_16x16x32_bf16 v[68:71], v[200:203], a[212:215], v[68:71]
    ds_read_b64_tr_b16 v[222:223], v240 offset:32032
    s_waitcnt lgkmcnt(10)
    v_mfma_f32_16x16x32_bf16 v[32:35], v[10:13], a[216:219], v[32:35]
    ds_read_b64_tr_b16 v[184:185], v240 offset:35840
    v_mfma_f32_16x16x32_bf16 v[52:55], v[10:13], a[220:223], v[52:55]
    ds_read_b64_tr_b16 v[186:187], v240 offset:37120
    buffer_load_dwordx4 v[108:111], v248, s[32:35], 0 offen offset:1024 sc1
    v_mfma_f32_16x16x32_bf16 v[36:39], v[14:17], a[216:219], v[36:39]
    ds_read_b64_tr_b16 v[188:189], v240 offset:35848
    v_mfma_f32_16x16x32_bf16 v[56:59], v[14:17], a[220:223], v[56:59]
    ds_read_b64_tr_b16 v[190:191], v240 offset:37128
L_pad9:
    s_cbranch_execz L_back
    v_mfma_f32_16x16x32_bf16 v[40:43], v[18:21], a[216:219], v[40:43]
    ds_read_b64_tr_b16 v[192:193], v240 offset:35856
    buffer_load_dwordx4 v[112:115], v247, s[32:35], 0 offen offset:2048 sc1
    v_mfma_f32_16x16x32_bf16 v[60:63], v[18:21], a[220:223], v[60:63]
    ds_read_b64_tr_b16 v[194:195], v240 offset:37136
    v_mfma_f32_16x16x32_bf16 v[44:47], v[22:25], a[216:219], v[44:47]
    ds_read_b64_tr_b16 v[196:197], v240 offset:35864
    v_mfma_f32_16x16x32_bf16 v[64:67], v[22:25], a[220:223], v[64:67]
    ds_read_b64_tr_b16 v[198:199], v240 offset:37144
    buffer_load_dwordx4 v[116:119], v248, s[32:35], 0 offen offset:2048 sc1
    v_mfma_f32_16x16x32_bf16 v[48:51], v[26:29], a[216:219], v[48:51]
    ds_read_b64_tr_b16 v[200:201], v240 offset:35872
    v_mfma_f32_16x16x32_bf16 v[68:71], v[26:29], a[220:223], v[68:71]
    ds_read_b64_tr_b16 v[202:203], v240 offset:37152
    s_waitcnt lgkmcnt(10)
    v_mfma_f32_16x16x32_bf16 v[32:35], v[204:207], a[224:227], v[32:35]
    s_barrier
    ds_read_b64_tr_b16 v[10:11], v240 offset:40960
    v_mfma_f32_16x16x32_bf16 v[52:55], v[204:207], a[228:231], v[52:55]
    ds_read_b64_tr_b16 v[12:13], v240 offset:42240
    buffer_load_dwordx4 v[120:123], v247, s[32:35], 0 offen offset:3072 sc1
    v_mfma_f32_16x16x32_bf16 v[36:39], v[208:211], a[224:227], v[36:39]
    ds_read_b64_tr_b16 v[14:15], v240 offset:40968
    v_mfma_f32_16x16x32_bf16 v[56:59], v[208:211], a[228:231], v[56:59]
    ds_read_b64_tr_b16 v[16:17], v240 offset:42248
    v_mfma_f32_16x16x32_bf16 v[40:43], v[212:215], a[224:227], v[40:43]
    ds_read_b64_tr_b16 v[18:19], v240 offset:40976
    buffer_load_dwordx4 v[124:127], v248, s[32:35], 0 offen offset:3072 sc1
    v_mfma_f32_16x16x32_bf16 v[60:63], v[212:215], a[228:231], v[60:63]
    ds_read_b64_tr_b16 v[20:21], v240 offset:42256
    s_add_u32 s32, s32, 4096
    s_addc_u32 s33, s33, 0
    v_mfma_f32_16x16x32_bf16 v[44:47], v[216:219], a[224:227], v[44:47]
    ds_read_b64_tr_b16 v[22:23], v240 offset:40984
    s_add_u32 m0, s80, 10240
    v_mfma_f32_16x16x32_bf16 v[64:67], v[216:219], a[228:231], v[64:67]
    ds_read_b64_tr_b16 v[24:25], v240 offset:42264
    buffer_load_dwordx4 v6, s[12:15], 0 offen sc1 lds
    v_mfma_f32_16x16x32_bf16 v[48:51], v[220:223], a[224:227], v[48:51]
    ds_read_b64_tr_b16 v[26:27], v240 offset:40992
    v_mfma_f32_16x16x32_bf16 v[68:71], v[220:223], a[228:231], v[68:71]
    ds_read_b64_tr_b16 v[28:29], v240 offset:42272
    s_waitcnt lgkmcnt(10)
    v_mfma_f32_16x16x32_bf16 v[32:35], v[184:187], a[232:235], v[32:35]
    ds_read_b64_tr_b16 v[204:205], v240 offset:46080
    v_mfma_f32_16x16x32_bf16 v[52:55], v[184:187], a[236:239], v[52:55]
    ds_read_b64_tr_b16 v[206:207], v240 offset:47360
    buffer_load_dwordx4 v6, s[12:15], 0 offen offset:1024 sc1 lds
    v_mfma_f32_16x16x32_bf16 v[36:39], v[188:191], a[232:235], v[36:39]
    ds_read_b64_tr_b16 v[208:209], v240 offset:46088
    v_mfma_f32_16x16x32_bf16 v[56:59], v[188:191], a[236:239], v[56:59]
    ds_read_b64_tr_b16 v[210:211], v240 offset:47368
    v_mfma_f32_16x16x32_bf16 v[40:43], v[192:195], a[232:235], v[40:43]
    ds_read_b64_tr_b16 v[212:213], v240 offset:46096
    buffer_load_dwordx4 v6, s[12:15], 0 offen offset:2048 sc1 lds
    v_mfma_f32_16x16x32_bf16 v[60:63], v[192:195], a[236:239], v[60:63]
    ds_read_b64_tr_b16 v[214:215], v240 offset:47376
    v_mfma_f32_16x16x32_bf16 v[44:47], v[196:199], a[232:235], v[44:47]
    ds_read_b64_tr_b16 v[216:217], v240 offset:46104
    v_mfma_f32_16x16x32_bf16 v[64:67], v[196:199], a[236:239], v[64:67]
    ds_read_b64_tr_b16 v[218:219], v240 offset:47384
    buffer_load_dwordx4 v6, s[12:15], 0 offen offset:3072 sc1 lds
    v_mfma_f32_16x16x32_bf16 v[48:51], v[200:203], a[232:235], v[48:51]
    ds_read_b64_tr_b16 v[220:221], v240 offset:46112
    s_add_u32 m0, s80, 14336
    v_mfma_f32_16x16x32_bf16 v[68:71], v[200:203], a[236:239], v[68:71]
    ds_read_b64_tr_b16 v[222:223], v240 offset:47392
    s_waitcnt lgkmcnt(10)
    v_mfma_f32_16x16x32_bf16 v[32:35], v[10:13], a[240:243], v[32:35]
    s_barrier
    ds_read_b64_tr_b16 v[184:185], v240 offset:51200
    v_mfma_f32_16x16x32_bf16 v[52:55], v[10:13], a[244:247], v[52:55]
    ds_read_b64_tr_b16 v[186:187], v240 offset:52480
    buffer_load_dwordx4 v249, s[12:15], 0 offen sc1 lds
    v_mfma_f32_16x16x32_bf16 v[36:39], v[14:17], a[240:243], v[36:39]
    ds_read_b64_tr_b16 v[188:189], v240 offset:51208
    s_add_u32 s12, s12, 10240
    s_addc_u32 s13, s13, 0
    v_mfma_f32_16x16x32_bf16 v[56:59], v[14:17], a[244:247], v[56:59]
    ds_read_b64_tr_b16 v[190:191], v240 offset:52488
    v_mfma_f32_16x16x32_bf16 v[40:43], v[18:21], a[240:243], v[40:43]
    ds_read_b64_tr_b16 v[192:193], v240 offset:51216
    buffer_load_dwordx4 v[128:131], v247, s[32:35], 0 offen sc1
    v_mfma_f32_16x16x32_bf16 v[60:63], v[18:21], a[244:247], v[60:63]
    ds_read_b64_tr_b16 v[194:195], v240 offset:52496
    v_mfma_f32_16x16x32_bf16 v[44:47], v[22:25], a[240:243], v[44:47]
    ds_read_b64_tr_b16 v[196:197], v240 offset:51224
    v_mfma_f32_16x16x32_bf16 v[64:67], v[22:25], a[244:247], v[64:67]
    ds_read_b64_tr_b16 v[198:199], v240 offset:52504
    buffer_load_dwordx4 v[132:135], v248, s[32:35], 0 offen sc1
    v_mfma_f32_16x16x32_bf16 v[48:51], v[26:29], a[240:243], v[48:51]
    ds_read_b64_tr_b16 v[200:201], v240 offset:51232
    v_mfma_f32_16x16x32_bf16 v[68:71], v[26:29], a[244:247], v[68:71]
    ds_read_b64_tr_b16 v[202:203], v240 offset:52512
    s_waitcnt lgkmcnt(10)
    v_mfma_f32_16x16x32_bf16 v[32:35], v[204:207], a[248:251], v[32:35]
    ds_read_b64_tr_b16 v[10:11], v240 offset:56320
    v_mfma_f32_16x16x32_bf16 v[52:55], v[204:207], a[252:255], v[52:55]
    ds_read_b64_tr_b16 v[12:13], v240 offset:57600
    buffer_load_dwordx4 v[136:139], v247, s[32:35], 0 offen offset:1024 sc1
    v_mfma_f32_16x16x32_bf16 v[36:39], v[208:211], a[248:251], v[36:39]
    ds_read_b64_tr_b16 v[14:15], v240 offset:56328
    v_mfma_f32_16x16x32_bf16 v[56:59], v[208:211], a[252:255], v[56:59]
    ds_read_b64_tr_b16 v[16:17], v240 offset:57608
    v_mfma_f32_16x16x32_bf16 v[40:43], v[212:215], a[248:251], v[40:43]
    ds_read_b64_tr_b16 v[18:19], v240 offset:56336
    buffer_load_dwordx4 v[140:143], v248, s[32:35], 0 offen offset:1024 sc1
    v_mfma_f32_16x16x32_bf16 v[60:63], v[212:215], a[252:255], v[60:63]
    ds_read_b64_tr_b16 v[20:21], v240 offset:57616
    s_add_u32 m0, s80, 20480
    v_mfma_f32_16x16x32_bf16 v[44:47], v[216:219], a[248:251], v[44:47]
    ds_read_b64_tr_b16 v[22:23], v240 offset:56344
    v_mfma_f32_16x16x32_bf16 v[64:67], v[216:219], a[252:255], v[64:67]
    ds_read_b64_tr_b16 v[24:25], v240 offset:57624
    buffer_load_dwordx4 v6, s[12:15], 0 offen sc1 lds
    v_mfma_f32_16x16x32_bf16 v[48:51], v[220:223], a[248:251], v[48:51]
    ds_read_b64_tr_b16 v[26:27], v240 offset:56352
    v_mfma_f32_16x16x32_bf16 v[68:71], v[220:223], a[252:255], v[68:71]
    ds_read_b64_tr_b16 v[28:29], v240 offset:57632
    s_waitcnt vmcnt(16) lgkmcnt(10)
    v_mfma_f32_16x16x32_bf16 v[32:35], v[184:187], v[96:99], v[32:35]
    s_barrier
    ds_read_b64_tr_b16 v[204:205], v7 offset:0
    v_mfma_f32_16x16x32_bf16 v[52:55], v[184:187], v[100:103], v[52:55]
    ds_read_b64_tr_b16 v[206:207], v7 offset:1280
    buffer_load_dwordx4 v6, s[12:15], 0 offen offset:1024 sc1 lds
    v_mfma_f32_16x16x32_bf16 v[36:39], v[188:191], v[96:99], v[36:39]
    ds_read_b64_tr_b16 v[208:209], v7 offset:8
    v_mfma_f32_16x16x32_bf16 v[56:59], v[188:191], v[100:103], v[56:59]
    ds_read_b64_tr_b16 v[210:211], v7 offset:1288
    v_mfma_f32_16x16x32_bf16 v[40:43], v[192:195], v[96:99], v[40:43]
    ds_read_b64_tr_b16 v[212:213], v7 offset:16
    buffer_load_dwordx4 v6, s[12:15], 0 offen offset:2048 sc1 lds
    v_mfma_f32_16x16x32_bf16 v[60:63], v[192:195], v[100:103], v[60:63]
    ds_read_b64_tr_b16 v[214:215], v7 offset:1296
    v_mfma_f32_16x16x32_bf16 v[44:47], v[196:199], v[96:99], v[44:47]
    ds_read_b64_tr_b16 v[216:217], v7 offset:24
    v_mfma_f32_16x16x32_bf16 v[64:67], v[196:199], v[100:103], v[64:67]
    ds_read_b64_tr_b16 v[218:219], v7 offset:1304
    buffer_load_dwordx4 v6, s[12:15], 0 offen offset:3072 sc1 lds
    v_mfma_f32_16x16x32_bf16 v[48:51], v[200:203], v[96:99], v[48:51]
    ds_read_b64_tr_b16 v[220:221], v7 offset:32
    s_add_u32 m0, s80, 24576
    v_mfma_f32_16x16x32_bf16 v[68:71], v[200:203], v[100:103], v[68:71]
    ds_read_b64_tr_b16 v[222:223], v7 offset:1312
    s_waitcnt vmcnt(17) lgkmcnt(10)
    v_mfma_f32_16x16x32_bf16 v[32:35], v[10:13], v[104:107], v[32:35]
    ds_read_b64_tr_b16 v[184:185], v7 offset:5120
    v_mfma_f32_16x16x32_bf16 v[52:55], v[10:13], v[108:111], v[52:55]
    ds_read_b64_tr_b16 v[186:187], v7 offset:6400
    buffer_load_dwordx4 v249, s[12:15], 0 offen sc1 lds
    v_mfma_f32_16x16x32_bf16 v[36:39], v[14:17], v[104:107], v[36:39]
    ds_read_b64_tr_b16 v[188:189], v7 offset:5128
    s_add_u32 s12, s12, 10240
    s_addc_u32 s13, s13, 0
    v_mfma_f32_16x16x32_bf16 v[56:59], v[14:17], v[108:111], v[56:59]
    ds_read_b64_tr_b16 v[190:191], v7 offset:6408
    v_mfma_f32_16x16x32_bf16 v[40:43], v[18:21], v[104:107], v[40:43]
    ds_read_b64_tr_b16 v[192:193], v7 offset:5136
    buffer_load_dwordx4 v[144:147], v247, s[32:35], 0 offen offset:2048 sc1
    v_mfma_f32_16x16x32_bf16 v[60:63], v[18:21], v[108:111], v[60:63]
    ds_read_b64_tr_b16 v[194:195], v7 offset:6416
    v_mfma_f32_16x16x32_bf16 v[44:47], v[22:25], v[104:107], v[44:47]
    ds_read_b64_tr_b16 v[196:197], v7 offset:5144
    v_mfma_f32_16x16x32_bf16 v[64:67], v[22:25], v[108:111], v[64:67]
    ds_read_b64_tr_b16 v[198:199], v7 offset:6424
    buffer_load_dwordx4 v[148:151], v248, s[32:35], 0 offen offset:2048 sc1
    v_mfma_f32_16x16x32_bf16 v[48:51], v[26:29], v[104:107], v[48:51]
    ds_read_b64_tr_b16 v[200:201], v7 offset:5152
    v_mfma_f32_16x16x32_bf16 v[68:71], v[26:29], v[108:111], v[68:71]
    ds_read_b64_tr_b16 v[202:203], v7 offset:6432
    s_waitcnt vmcnt(18) lgkmcnt(10)
    v_mfma_f32_16x16x32_bf16 v[32:35], v[204:207], v[112:115], v[32:35]
    s_barrier
    ds_read_b64_tr_b16 v[10:11], v240 offset:0
    v_mfma_f32_16x16x32_bf16 v[52:55], v[204:207], v[116:119], v[52:55]
    ds_read_b64_tr_b16 v[12:13], v240 offset:1280
    buffer_load_dwordx4 v[152:155], v247, s[32:35], 0 offen offset:3072 sc1
    v_mfma_f32_16x16x32_bf16 v[36:39], v[208:211], v[112:115], v[36:39]
    ds_read_b64_tr_b16 v[14:15], v240 offset:8
    v_mfma_f32_16x16x32_bf16 v[56:59], v[208:211], v[116:119], v[56:59]
    ds_read_b64_tr_b16 v[16:17], v240 offset:1288
    v_mfma_f32_16x16x32_bf16 v[40:43], v[212:215], v[112:115], v[40:43]
    ds_read_b64_tr_b16 v[18:19], v240 offset:16
    buffer_load_dwordx4 v[156:159], v248, s[32:35], 0 offen offset:3072 sc1
    v_mfma_f32_16x16x32_bf16 v[60:63], v[212:215], v[116:119], v[60:63]
    ds_read_b64_tr_b16 v[20:21], v240 offset:1296
    s_add_u32 s32, s32, 4096
    s_addc_u32 s33, s33, 0
    v_mfma_f32_16x16x32_bf16 v[44:47], v[216:219], v[112:115], v[44:47]
    ds_read_b64_tr_b16 v[22:23], v240 offset:24
    v_mfma_f32_16x16x32_bf16 v[64:67], v[216:219], v[116:119], v[64:67]
    ds_read_b64_tr_b16 v[24:25], v240 offset:1304
    buffer_load_dwordx4 v[160:163], v247, s[32:35], 0 offen sc1
    v_mfma_f32_16x16x32_bf16 v[48:51], v[220:223], v[112:115], v[48:51]
    ds_read_b64_tr_b16 v[26:27], v240 offset:32
    v_mfma_f32_16x16x32_bf16 v[68:71], v[220:223], v[116:119], v[68:71]
    ds_read_b64_tr_b16 v[28:29], v240 offset:1312
    s_waitcnt vmcnt(19) lgkmcnt(10)
    v_mfma_f32_16x16x32_bf16 v[32:35], v[184:187], v[120:123], v[32:35]
    ds_read_b64_tr_b16 v[204:205], v240 offset:5120
    v_mfma_f32_16x16x32_bf16 v[52:55], v[184:187], v[124:127], v[52:55]
    ds_read_b64_tr_b16 v[206:207], v240 offset:6400
    buffer_load_dwordx4 v[164:167], v248, s[32:35], 0 offen sc1
    v_mfma_f32_16x16x32_bf16 v[36:39], v[188:191], v[120:123], v[36:39]
    ds_read_b64_tr_b16 v[208:209], v240 offset:5128
    v_mfma_f32_16x16x32_bf16 v[56:59], v[188:191], v[124:127], v[56:59]
    ds_read_b64_tr_b16 v[210:211], v240 offset:6408
    v_mfma_f32_16x16x32_bf16 v[40:43], v[192:195], v[120:123], v[40:43]
    ds_read_b64_tr_b16 v[212:213], v240 offset:5136
    buffer_load_dwordx4 v[168:171], v247, s[32:35], 0 offen offset:1024 sc1
    v_mfma_f32_16x16x32_bf16 v[60:63], v[192:195], v[124:127], v[60:63]
    ds_read_b64_tr_b16 v[214:215], v240 offset:6416
    v_mfma_f32_16x16x32_bf16 v[44:47], v[196:199], v[120:123], v[44:47]
    ds_read_b64_tr_b16 v[216:217], v240 offset:5144
    v_mfma_f32_16x16x32_bf16 v[64:67], v[196:199], v[124:127], v[64:67]
    ds_read_b64_tr_b16 v[218:219], v240 offset:6424
    buffer_load_dwordx4 v[172:175], v248, s[32:35], 0 offen offset:1024 sc1
    v_mfma_f32_16x16x32_bf16 v[48:51], v[200:203], v[120:123], v[48:51]
    ds_read_b64_tr_b16 v[220:221], v240 offset:5152
    v_mfma_f32_16x16x32_bf16 v[68:71], v[200:203], v[124:127], v[68:71]
    ds_read_b64_tr_b16 v[222:223], v240 offset:6432
    s_waitcnt vmcnt(15) lgkmcnt(10)
    v_mfma_f32_16x16x32_bf16 v[32:35], v[10:13], v[128:131], v[32:35]
    s_barrier
    ds_read_b64_tr_b16 v[184:185], v240 offset:10240
    v_mfma_f32_16x16x32_bf16 v[52:55], v[10:13], v[132:135], v[52:55]
    ds_read_b64_tr_b16 v[186:187], v240 offset:11520
    v_mfma_f32_16x16x32_bf16 v[36:39], v[14:17], v[128:131], v[36:39]
    ds_read_b64_tr_b16 v[188:189], v240 offset:10248
    v_mfma_f32_16x16x32_bf16 v[56:59], v[14:17], v[132:135], v[56:59]
    ds_read_b64_tr_b16 v[190:191], v240 offset:11528
    v_mfma_f32_16x16x32_bf16 v[40:43], v[18:21], v[128:131], v[40:43]
    ds_read_b64_tr_b16 v[192:193], v240 offset:10256
    v_mfma_f32_16x16x32_bf16 v[60:63], v[18:21], v[132:135], v[60:63]
    ds_read_b64_tr_b16 v[194:195], v240 offset:11536
    v_mfma_f32_16x16x32_bf16 v[44:47], v[22:25], v[128:131], v[44:47]
    ds_read_b64_tr_b16 v[196:197], v240 offset:10264
    v_mfma_f32_16x16x32_bf16 v[64:67], v[22:25], v[132:135], v[64:67]
    ds_read_b64_tr_b16 v[198:199], v240 offset:11544
    v_mfma_f32_16x16x32_bf16 v[48:51], v[26:29], v[128:131], v[48:51]
    ds_read_b64_tr_b16 v[200:201], v240 offset:10272
    v_mfma_f32_16x16x32_bf16 v[68:71], v[26:29], v[132:135], v[68:71]
    ds_read_b64_tr_b16 v[202:203], v240 offset:11552
    s_waitcnt vmcnt(13) lgkmcnt(10)
    v_mfma_f32_16x16x32_bf16 v[32:35], v[204:207], v[136:139], v[32:35]
    ds_read_b64_tr_b16 v[10:11], v240 offset:15360
    v_mfma_f32_16x16x32_bf16 v[52:55], v[204:207], v[140:143], v[52:55]
    ds_read_b64_tr_b16 v[12:13], v240 offset:16640
    v_mfma_f32_16x16x32_bf16 v[36:39], v[208:211], v[136:139], v[36:39]
    ds_read_b64_tr_b16 v[14:15], v240 offset:15368
    v_mfma_f32_16x16x32_bf16 v[56:59], v[208:211], v[140:143], v[56:59]
    ds_read_b64_tr_b16 v[16:17], v240 offset:16648
    v_mfma_f32_16x16x32_bf16 v[40:43], v[212:215], v[136:139], v[40:43]
    ds_read_b64_tr_b16 v[18:19], v240 offset:15376
    v_mfma_f32_16x16x32_bf16 v[60:63], v[212:215], v[140:143], v[60:63]
    ds_read_b64_tr_b16 v[20:21], v240 offset:16656
    v_mfma_f32_16x16x32_bf16 v[44:47], v[216:219], v[136:139], v[44:47]
    ds_read_b64_tr_b16 v[22:23], v240 offset:15384
    v_mfma_f32_16x16x32_bf16 v[64:67], v[216:219], v[140:143], v[64:67]
    ds_read_b64_tr_b16 v[24:25], v240 offset:16664
    v_mfma_f32_16x16x32_bf16 v[48:51], v[220:223], v[136:139], v[48:51]
    ds_read_b64_tr_b16 v[26:27], v240 offset:15392
    v_mfma_f32_16x16x32_bf16 v[68:71], v[220:223], v[140:143], v[68:71]
    ds_read_b64_tr_b16 v[28:29], v240 offset:16672
    s_waitcnt vmcnt(6) lgkmcnt(10)
    v_mfma_f32_16x16x32_bf16 v[32:35], v[184:187], v[144:147], v[32:35]
    s_barrier
    ds_read_b64_tr_b16 v[204:205], v240 offset:20480
    v_mfma_f32_16x16x32_bf16 v[52:55], v[184:187], v[148:151], v[52:55]
    ds_read_b64_tr_b16 v[206:207], v240 offset:21760
    v_mfma_f32_16x16x32_bf16 v[36:39], v[188:191], v[144:147], v[36:39]
    ds_read_b64_tr_b16 v[208:209], v240 offset:20488
    v_mfma_f32_16x16x32_bf16 v[56:59], v[188:191], v[148:151], v[56:59]
    ds_read_b64_tr_b16 v[210:211], v240 offset:21768
    v_mfma_f32_16x16x32_bf16 v[40:43], v[192:195], v[144:147], v[40:43]
    ds_read_b64_tr_b16 v[212:213], v240 offset:20496
    v_mfma_f32_16x16x32_bf16 v[60:63], v[192:195], v[148:151], v[60:63]
    ds_read_b64_tr_b16 v[214:215], v240 offset:21776
    v_mfma_f32_16x16x32_bf16 v[44:47], v[196:199], v[144:147], v[44:47]
    ds_read_b64_tr_b16 v[216:217], v240 offset:20504
    v_mfma_f32_16x16x32_bf16 v[64:67], v[196:199], v[148:151], v[64:67]
    ds_read_b64_tr_b16 v[218:219], v240 offset:21784
    v_mfma_f32_16x16x32_bf16 v[48:51], v[200:203], v[144:147], v[48:51]
    ds_read_b64_tr_b16 v[220:221], v240 offset:20512
    v_mfma_f32_16x16x32_bf16 v[68:71], v[200:203], v[148:151], v[68:71]
    ds_read_b64_tr_b16 v[222:223], v240 offset:21792
    s_waitcnt vmcnt(4) lgkmcnt(10)
    v_mfma_f32_16x16x32_bf16 v[32:35], v[10:13], v[152:155], v[32:35]
    ds_read_b64_tr_b16 v[184:185], v240 offset:25600
    v_mfma_f32_16x16x32_bf16 v[52:55], v[10:13], v[156:159], v[52:55]
    ds_read_b64_tr_b16 v[186:187], v240 offset:26880
    v_mfma_f32_16x16x32_bf16 v[36:39], v[14:17], v[152:155], v[36:39]
    ds_read_b64_tr_b16 v[188:189], v240 offset:25608
    v_mfma_f32_16x16x32_bf16 v[56:59], v[14:17], v[156:159], v[56:59]
    ds_read_b64_tr_b16 v[190:191], v240 offset:26888
    v_mfma_f32_16x16x32_bf16 v[40:43], v[18:21], v[152:155], v[40:43]
    ds_read_b64_tr_b16 v[192:193], v240 offset:25616
    v_mfma_f32_16x16x32_bf16 v[60:63], v[18:21], v[156:159], v[60:63]
    ds_read_b64_tr_b16 v[194:195], v240 offset:26896
    v_mfma_f32_16x16x32_bf16 v[44:47], v[22:25], v[152:155], v[44:47]
    ds_read_b64_tr_b16 v[196:197], v240 offset:25624
    v_mfma_f32_16x16x32_bf16 v[64:67], v[22:25], v[156:159], v[64:67]
    ds_read_b64_tr_b16 v[198:199], v240 offset:26904
    v_mfma_f32_16x16x32_bf16 v[48:51], v[26:29], v[152:155], v[48:51]
    ds_read_b64_tr_b16 v[200:201], v240 offset:25632
    v_mfma_f32_16x16x32_bf16 v[68:71], v[26:29], v[156:159], v[68:71]
    ds_read_b64_tr_b16 v[202:203], v240 offset:26912
    s_waitcnt vmcnt(0) lgkmcnt(0)
    v_mfma_f32_16x16x32_bf16 v[52:55], v[204:207], v[164:167], v[52:55]
    v_mfma_f32_16x16x32_bf16 v[56:59], v[208:211], v[164:167], v[56:59]
    v_mfma_f32_16x16x32_bf16 v[60:63], v[212:215], v[164:167], v[60:63]
    v_mfma_f32_16x16x32_bf16 v[64:67], v[216:219], v[164:167], v[64:67]
    v_mfma_f32_16x16x32_bf16 v[68:71], v[220:223], v[164:167], v[68:71]
    v_mfma_f32_16x16x32_bf16 v[52:55], v[184:187], v[172:175], v[52:55]
    v_mfma_f32_16x16x32_bf16 v[56:59], v[188:191], v[172:175], v[56:59]
    v_mfma_f32_16x16x32_bf16 v[60:63], v[192:195], v[172:175], v[60:63]
    v_mfma_f32_16x16x32_bf16 v[64:67], v[196:199], v[172:175], v[64:67]
    v_mfma_f32_16x16x32_bf16 v[68:71], v[200:203], v[172:175], v[68:71]
    v_mfma_f32_16x16x32_bf16 v[32:35], v[204:207], v[160:163], v[32:35]
    v_mfma_f32_16x16x32_bf16 v[36:39], v[208:211], v[160:163], v[36:39]
    v_mfma_f32_16x16x32_bf16 v[40:43], v[212:215], v[160:163], v[40:43]
    v_mfma_f32_16x16x32_bf16 v[44:47], v[216:219], v[160:163], v[44:47]
    ds_write_b128 v238, v[52:55] offset:0
    v_mfma_f32_16x16x32_bf16 v[48:51], v[220:223], v[160:163], v[48:51]
    ds_write_b128 v238, v[56:59] offset:1024
    v_mfma_f32_16x16x32_bf16 v[32:35], v[184:187], v[168:171], v[32:35]
    ds_write_b128 v238, v[60:63] offset:2048
    v_mfma_f32_16x16x32_bf16 v[36:39], v[188:191], v[168:171], v[36:39]
    ds_write_b128 v238, v[64:67] offset:3072
    v_mfma_f32_16x16x32_bf16 v[40:43], v[192:195], v[168:171], v[40:43]
    ds_write_b128 v238, v[68:71] offset:4096
    v_mfma_f32_16x16x32_bf16 v[44:47], v[196:199], v[168:171], v[44:47]
    v_mfma_f32_16x16x32_bf16 v[48:51], v[200:203], v[168:171], v[48:51]
    s_waitcnt lgkmcnt(0)
    s_barrier
    ds_read_b128 v[52:55], v239 offset:0
    ds_read_b128 v[56:59], v239 offset:1024
    ds_read_b128 v[60:63], v239 offset:2048
    ds_read_b128 v[64:67], v239 offset:3072
    ds_read_b128 v[68:71], v239 offset:4096
    s_waitcnt lgkmcnt(4)
    v_pk_add_f32 v[32:33], v[32:33], v[52:53]
    v_pk_add_f32 v[34:35], v[34:35], v[54:55]
    v_pk_mul_f32 v[32:33], v[32:33], v[232:233] op_sel_hi:[1,0]
    v_pk_mul_f32 v[34:35], v[34:35], v[232:233] op_sel_hi:[1,0]
    v_cvt_pk_bf16_f32 v72, v32, v33
    v_cvt_pk_bf16_f32 v73, v34, v35
    s_waitcnt lgkmcnt(3)
    v_pk_add_f32 v[36:37], v[36:37], v[56:57]
    v_pk_add_f32 v[38:39], v[38:39], v[58:59]
    v_pk_mul_f32 v[36:37], v[36:37], v[232:233] op_sel_hi:[1,0]
    v_pk_mul_f32 v[38:39], v[38:39], v[232:233] op_sel_hi:[1,0]
    v_cvt_pk_bf16_f32 v74, v36, v37
    v_cvt_pk_bf16_f32 v75, v38, v39
    buffer_store_dwordx4 v[72:75], v241, s[28:31], s79 offen
    s_waitcnt lgkmcnt(2)
    v_pk_add_f32 v[40:41], v[40:41], v[60:61]
    v_pk_add_f32 v[42:43], v[42:43], v[62:63]
    v_pk_mul_f32 v[40:41], v[40:41], v[232:233] op_sel_hi:[1,0]
    v_pk_mul_f32 v[42:43], v[42:43], v[232:233] op_sel_hi:[1,0]
    v_cvt_pk_bf16_f32 v76, v40, v41
    v_cvt_pk_bf16_f32 v77, v42, v43
    s_waitcnt lgkmcnt(1)
    v_pk_add_f32 v[44:45], v[44:45], v[64:65]
    v_pk_add_f32 v[46:47], v[46:47], v[66:67]
    v_pk_mul_f32 v[44:45], v[44:45], v[232:233] op_sel_hi:[1,0]
    v_pk_mul_f32 v[46:47], v[46:47], v[232:233] op_sel_hi:[1,0]
    v_cvt_pk_bf16_f32 v78, v44, v45
    v_cvt_pk_bf16_f32 v79, v46, v47
    buffer_store_dwordx4 v[76:79], v241, s[28:31], s79 offen offset:16
    s_waitcnt lgkmcnt(0)
    v_pk_add_f32 v[48:49], v[48:49], v[68:69]
    v_pk_add_f32 v[50:51], v[50:51], v[70:71]
    v_pk_mul_f32 v[48:49], v[48:49], v[232:233] op_sel_hi:[1,0]
    v_pk_mul_f32 v[50:51], v[50:51], v[232:233] op_sel_hi:[1,0]
    v_cvt_pk_bf16_f32 v80, v48, v49
    v_cvt_pk_bf16_f32 v81, v50, v51
    buffer_store_dwordx2 v[80:81], v241, s[28:31], s79 offen offset:32
L_end:
    s_endpgm
L_slow:
    s_waitcnt vmcnt(0) lgkmcnt(0)
    s_mov_b32 s76, -1
    v_mov_b32 v162, 0xff800000
    v_mov_b32 v163, 0xff800000
    s_mov_b32 s83, 0
    s_mov_b64 s[4:5], s[20:21]
L_slow_max:
    buffer_load_dwordx4 a[0:3], v6, s[4:7], 0 offen sc1
    buffer_load_dwordx2 a[12:13], v4, s[4:7], 0 offen offset:3072 sc1
    s_add_u32 s83, s83, 4096
    s_and_b32 s83, s83, 0x3ffff
    s_add_u32 s4, s20, s83
    s_addc_u32 s5, s21, 0
    s_waitcnt vmcnt(0) lgkmcnt(0)
    v_mfma_f32_32x32x8_bf16 v[64:79], a[12:13], v[224:225], 0
    v_mfma_f32_32x32x16_bf16 v[64:79], a[0:3], v[220:223], v[64:79]
    v_mfma_f32_32x32x8_bf16 v[80:95], a[12:13], v[230:231], 0
    v_mfma_f32_32x32x16_bf16 v[80:95], a[0:3], v[226:229], v[80:95]
    s_nop 15
    v_max3_f32 v162, v64, v65, v162
    v_max3_f32 v162, v66, v67, v162
    v_max3_f32 v162, v68, v69, v162
    v_max3_f32 v162, v70, v71, v162
    v_max3_f32 v162, v72, v73, v162
    v_max3_f32 v162, v74, v75, v162
    v_max3_f32 v162, v76, v77, v162
    v_max3_f32 v162, v78, v79, v162
    v_max3_f32 v163, v80, v81, v163
    v_max3_f32 v163, v82, v83, v163
    v_max3_f32 v163, v84, v85, v163
    v_max3_f32 v163, v86, v87, v163
    v_max3_f32 v163, v88, v89, v163
    v_max3_f32 v163, v90, v91, v163
    v_max3_f32 v163, v92, v93, v163
    v_max3_f32 v163, v94, v95, v163
    s_cmp_lg_u32 s83, 0
    s_cbranch_scc1 L_slow_max
    v_mov_b32 v166, v162
    v_mov_b32 v167, v163
    s_nop 1
    v_permlane32_swap_b32 v162, v166
    v_permlane32_swap_b32 v163, v167
    v_max_f32 v162, v162, v166
    v_max_f32 v163, v163, v167
    v_sub_f32 v162, 0, v162
    v_and_b32 v168, 0xffff0000, v162
    v_sub_f32 v162, v162, v168
    v_and_b32 v169, 0xffff0000, v162
    v_sub_f32 v162, v162, v169
    v_lshrrev_b32 v170, 16, v162
    v_lshrrev_b32 v168, 16, v168
    v_or_b32 v168, v168, v169
    v_cndmask_b32_e64 v224, v224, v168, s[90:91]
    v_cndmask_b32_e64 v225, v225, v170, s[90:91]
    v_sub_f32 v163, 0, v163
    v_and_b32 v168, 0xffff0000, v163
    v_sub_f32 v163, v163, v168
    v_and_b32 v169, 0xffff0000, v163
    v_sub_f32 v163, v163, v169
    v_lshrrev_b32 v170, 16, v163
    v_lshrrev_b32 v168, 16, v168
    v_or_b32 v168, v168, v169
    v_cndmask_b32_e64 v230, v230, v168, s[90:91]
    v_cndmask_b32_e64 v231, v231, v170, s[90:91]
    v_mov_b32 v128, 0
    v_mov_b32 v129, 0
    v_mov_b32 v130, 0
    v_mov_b32 v131, 0
    v_mov_b32 v132, 0
    v_mov_b32 v133, 0
    v_mov_b32 v134, 0
    v_mov_b32 v135, 0
    v_mov_b32 v136, 0
    v_mov_b32 v137, 0
    v_mov_b32 v138, 0
    v_mov_b32 v139, 0
    v_mov_b32 v140, 0
    v_mov_b32 v141, 0
    v_mov_b32 v142, 0
    v_mov_b32 v143, 0
    v_mov_b32 v144, 0
    v_mov_b32 v145, 0
    v_mov_b32 v146, 0
    v_mov_b32 v147, 0
    v_mov_b32 v148, 0
    v_mov_b32 v149, 0
    v_mov_b32 v150, 0
    v_mov_b32 v151, 0
    v_mov_b32 v152, 0
    v_mov_b32 v153, 0
    v_mov_b32 v154, 0
    v_mov_b32 v155, 0
    v_mov_b32 v156, 0
    v_mov_b32 v157, 0
    v_mov_b32 v158, 0
    v_mov_b32 v159, 0
    v_mov_b32 v160, 0
    v_mov_b32 v161, 0
    v_mov_b32 v162, 0
    v_mov_b32 v163, 0
    v_mov_b32 v164, 0
    v_mov_b32 v165, 0
    v_mov_b32 v166, 0
    v_mov_b32 v167, 0
    v_mov_b32 v168, 0
    v_mov_b32 v169, 0
    v_mov_b32 v170, 0
    v_mov_b32 v171, 0
    v_mov_b32 v172, 0
    v_mov_b32 v173, 0
    v_mov_b32 v174, 0
    v_mov_b32 v175, 0
    v_mov_b32 v176, 0
    v_mov_b32 v177, 0
    v_mov_b32 v178, 0
    v_mov_b32 v179, 0
    v_mov_b32 v180, 0
    v_mov_b32 v181, 0
    v_mov_b32 v182, 0
    v_mov_b32 v183, 0
L_slow_pv:
    buffer_load_dwordx4 a[0:3], v6, s[4:7], 0 offen sc1
    buffer_load_dwordx2 a[12:13], v4, s[4:7], 0 offen offset:3072 sc1
    buffer_load_dwordx4 a[4:7], v3, s[4:7], 0 offen offset:1024 sc1
    buffer_load_dwordx4 a[8:11], v3, s[4:7], 0 offen offset:2048 sc1
    s_add_u32 s83, s83, 4096
    s_and_b32 s83, s83, 0x3ffff
    s_add_u32 s4, s20, s83
    s_addc_u32 s5, s21, 0
    s_waitcnt vmcnt(0) lgkmcnt(0)
    v_mfma_f32_32x32x8_bf16 v[64:79], a[12:13], v[224:225], 0
    v_mfma_f32_32x32x16_bf16 v[64:79], a[0:3], v[220:223], v[64:79]
    v_mfma_f32_32x32x8_bf16 v[80:95], a[12:13], v[230:231], 0
    v_mfma_f32_32x32x16_bf16 v[80:95], a[0:3], v[226:229], v[80:95]
    s_nop 15
    v_exp_f32 v64, v64
    v_exp_f32 v65, v65
    v_exp_f32 v66, v66
    v_exp_f32 v67, v67
    v_exp_f32 v68, v68
    v_exp_f32 v69, v69
    v_exp_f32 v70, v70
    v_exp_f32 v71, v71
    v_exp_f32 v72, v72
    v_exp_f32 v73, v73
    v_exp_f32 v74, v74
    v_exp_f32 v75, v75
    v_exp_f32 v76, v76
    v_exp_f32 v77, v77
    v_exp_f32 v78, v78
    v_exp_f32 v79, v79
    v_exp_f32 v80, v80
    v_exp_f32 v81, v81
    v_exp_f32 v82, v82
    v_exp_f32 v83, v83
    v_exp_f32 v84, v84
    v_exp_f32 v85, v85
    v_exp_f32 v86, v86
    v_exp_f32 v87, v87
    v_exp_f32 v88, v88
    v_exp_f32 v89, v89
    v_exp_f32 v90, v90
    v_exp_f32 v91, v91
    v_exp_f32 v92, v92
    v_exp_f32 v93, v93
    v_exp_f32 v94, v94
    v_exp_f32 v95, v95
    s_nop 1
    v_smfmac_f32_32x32x32_bf16 v[128:143], a[4:7], v[64:71], v2
    v_smfmac_f32_32x32x32_bf16 v[128:143], a[8:11], v[72:79], v2
    v_smfmac_f32_32x32x32_bf16 v[144:159], a[4:7], v[80:87], v2
    v_smfmac_f32_32x32x32_bf16 v[144:159], a[8:11], v[88:95], v2
    s_cmp_lg_u32 s83, 0
    s_cbranch_scc1 L_slow_pv
    s_nop 15
    s_branch L_fin
L_code_end:
.section .rodata,"a"
.p2align 6
.amdhsa_kernel gated_mix__grouped_kv_mqa__dense_activation_relu__prompt_kernel
  .amdhsa_next_free_vgpr 512
  .amdhsa_next_free_sgpr 102
  .amdhsa_accum_offset 256
  .amdhsa_group_segment_fixed_size 0
  .amdhsa_kernarg_size 96
  .amdhsa_user_sgpr_count 2
  .amdhsa_user_sgpr_kernarg_segment_ptr 1
  .amdhsa_system_sgpr_workgroup_id_x 1
.end_amdhsa_kernel
```
